```python
import torch

def _softmax(x, axis=-1):
    return torch.softmax(x, dim=axis)

def _gelu(x):
    return torch.nn.functional.gelu(x, approximate='tanh')

def _silu(x):
    return torch.nn.functional.silu(x)

def _sigmoid(x):
    return torch.sigmoid(x)

def _layernorm(x, axis=-1, eps=1e-05):
    m = x.mean(dim=axis, keepdim=True)
    v = x.var(dim=axis, keepdim=True, unbiased=False)
    return (x - m) / torch.sqrt(v + eps)

def _scatter_add(tgt, idx, src, axis=0):
    return tgt.clone().index_add_(axis, idx, src)

def _segment_sum(src, seg, n):
    out = torch.zeros((n,) + src.shape[1:], dtype=src.dtype)
    return out.index_add_(0, seg, src)

def _pad(x, pw):
    flat = tuple((v for pair in reversed(pw) for v in pair))
    return torch.nn.functional.pad(x, flat)
kernel_name = 'standalone__kv_cache_quant_pre_rope_vs_post_rope__prompt'

def setup_inputs():

    _w = lambda a: (lambda t: t.to(torch.bfloat16) if t.is_floating_point() else t)(torch.as_tensor(a))
    B, Sq, Skv = (1, 2048, 2048)
    H, Dh0 = (16, 128)
    G = -1 if -1 > 0 else Dh0
    G = max(2, G // 2 * 2)
    Dh = max(G, Dh0 // G * G)
    Skv = max(Skv, Sq)
    ng = Dh // G
    bits = 3 if 3 > 1 else 4
    bits = max(2, min(8, bits))
    qmax = (1 << bits) - 1
    half = Dh // 2
    inv = 1.0 / 10000.0 ** (torch.arange(half) / max(1, half))
    ang_k = torch.arange(Skv)[:, None] * inv[None, :]
    ang_q = torch.arange(Skv - Sq, Skv)[:, None] * inv[None, :]
    kc = torch.cat([torch.cos(ang_k), torch.cos(ang_k)], dim=-1)
    ks = torch.cat([torch.sin(ang_k), torch.sin(ang_k)], dim=-1)
    qc = torch.cat([torch.cos(ang_q), torch.cos(ang_q)], dim=-1)
    qs = torch.cat([torch.sin(ang_q), torch.sin(ang_q)], dim=-1)
    qk_i = torch.randint(0, qmax + 1, (B, H, Skv, Dh)).to(torch.int32)
    qv_i = torch.randint(0, qmax + 1, (B, H, Skv, Dh)).to(torch.int32)
    ksc = torch.abs((lambda *s: torch.randn(*s, dtype=torch.bfloat16) * 0.4)(B, H, Skv, ng)) * 0.1 + 0.01
    kzp = torch.full((B, H, Skv, ng), qmax / 2.0)
    vsc = torch.abs((lambda *s: torch.randn(*s, dtype=torch.bfloat16) * 0.4)(B, H, Skv, ng)) * 0.1 + 0.01
    vzp = torch.full((B, H, Skv, ng), qmax / 2.0)
    return {'q': _w((lambda *s: torch.randn(*s, dtype=torch.bfloat16) * 6.4)(B, H, Sq, Dh) * 0.5), 'qk': _w(qk_i), 'k_scales': _w(ksc), 'k_zeros': _w(kzp), 'qv': _w(qv_i), 'v_scales': _w(vsc), 'v_zeros': _w(vzp), 'q_cos': _w(qc), 'q_sin': _w(qs), 'k_cos': _w(kc), 'k_sin': _w(ks)}

def reference(q, qk, k_scales, k_zeros, qv, v_scales, v_zeros, q_cos, q_sin, k_cos, k_sin):
    B, H, Sq, Dh = q.shape
    ng = k_scales.shape[-1]
    G = Dh // ng
    half = Dh // 2
    ks = (lambda x, n, axis: torch.repeat_interleave(x, n, dim=axis))(k_scales, G, axis=-1)
    kz = (lambda x, n, axis: torch.repeat_interleave(x, n, dim=axis))(k_zeros, G, axis=-1)
    k = ((lambda x, dt: x.to(dt))(qk, q.dtype) - kz) * ks
    vs = (lambda x, n, axis: torch.repeat_interleave(x, n, dim=axis))(v_scales, G, axis=-1)
    vz = (lambda x, n, axis: torch.repeat_interleave(x, n, dim=axis))(v_zeros, G, axis=-1)
    v = ((lambda x, dt: x.to(dt))(qv, q.dtype) - vz) * vs
    k1 = k[..., :half].clone()
    k2 = k[..., half:].clone()
    krh = torch.concatenate([-k2, k1], axis=-1)
    kr = k * k_cos[None, None, :, :] + krh * k_sin[None, None, :, :]
    q1 = q[..., :half].clone()
    q2 = q[..., half:].clone()
    qrh = torch.concatenate([-q2, q1], axis=-1)
    qr = q * q_cos[None, None, :, :] + qrh * q_sin[None, None, :, :]
    logits = torch.einsum('bhqd,bhkd->bhqk', qr, kr) * float(Dh) ** (-0.5)
    attn = _softmax(logits, axis=-1)
    out = torch.einsum('bhqk,bhkd->bhqd', attn, v)
    return out
```

```asm
; @launch grid=(256,1,1) block=(256,1,1) lds=163840
.amdgcn_target "amdgcn-amd-amdhsa--gfx950"
.text
.globl standalone__kv_cache_quant_pre_rope_vs_post_rope__prompt_kernel
.p2align 8
.type standalone__kv_cache_quant_pre_rope_vs_post_rope__prompt_kernel,@function
standalone__kv_cache_quant_pre_rope_vs_post_rope__prompt_kernel:
s_cmp_ge_u32 s2, 256
s_cbranch_scc1 A_end
s_load_dwordx16 s[76:91], s[0:1], 0
s_load_dwordx8 s[92:99], s[0:1], 64
s_load_dwordx4 s[40:43], s[0:1], 96
v_lshrrev_b32 v4, 6, v0
v_and_b32 v0, 63, v0
s_and_b32 s55, s2, 7
s_lshl_b32 s55, s55, 1
s_lshr_b32 s72, s2, 3
s_and_b32 s72, s72, 1
s_or_b32 s55, s55, s72
s_lshr_b32 s56, s2, 4
v_readfirstlane_b32 s52, v4
v_lshlrev_b32 v1, 4, v0
v_and_b32 v6, 15, v0
v_lshrrev_b32 v7, 4, v0
s_and_b32 s53, s52, 1
s_lshr_b32 s54, s52, 1
s_lshl_b32 s59, s54, 15
s_lshl_b32 s72, s53, 12
s_add_u32 s59, s59, s72
s_add_u32 s60, s59, 0x10000
s_lshl_b32 s73, s54, 15
v_add_u32 v2, s73, v1
v_add_u32 v3, 0x10000, v2
s_lshl_b32 s57, s53, 12
s_add_u32 s58, s57, 0x2000
s_mov_b32 s68, 0x01010101
s_lshl_b32 s70, s55, 4
s_add_u32 s72, s70, s56
v_mov_b32 v245, 0x40000000
v_mov_b32 v4, s72
s_cmp_eq_u32 s52, 2
s_cselect_b32 s72, 0, -1
v_or_b32 v5, s72, v0
v_cmp_eq_u32 vcc, 0, v5
v_cndmask_b32 v245, v245, v4, vcc
s_waitcnt lgkmcnt(0)
s_lshl_b32 s72, s55, 20
s_add_u32 s12, s42, s72
s_addc_u32 s13, s43, 0
s_and_b32 s13, s13, 0xffff
s_mov_b32 s14, 0x100000
s_mov_b32 s15, 0x20000
s_lshl_b32 s72, s54, 19
s_add_u32 s4, s12, s72
s_addc_u32 s5, s13, 0
s_mov_b32 s6, 0x80000
s_mov_b32 s7, 0x20000
s_mov_b32 s32, s40
s_and_b32 s33, s41, 0xffff
s_mov_b32 s34, 0x100
s_mov_b32 s35, 0x20000
s_lshl_b32 s72, s55, 19
s_add_u32 s36, s98, s72
s_addc_u32 s37, s99, 0
s_and_b32 s37, s37, 0xffff
s_mov_b32 s38, 0x80000
s_mov_b32 s39, 0x20000
s_cmp_ge_u32 s52, 2
s_cbranch_scc1 L_proV
L_proK:
s_mov_b32 s8, s78
s_and_b32 s9, s79, 0xffff
s_mov_b32 s10, 0x1000000
s_mov_b32 s11, 0x20000
s_mov_b32 s16, s94
s_and_b32 s17, s95, 0xffff
s_mov_b32 s18, 0x80000
s_mov_b32 s19, 0x20000
s_mov_b32 s20, s96
s_and_b32 s21, s97, 0xffff
s_mov_b32 s22, 0x80000
s_mov_b32 s23, 0x20000
s_mov_b32 s24, s80
s_and_b32 s25, s81, 0xffff
s_mov_b32 s26, 0x10000
s_mov_b32 s27, 0x20000
s_mov_b32 s28, s82
s_and_b32 s29, s83, 0xffff
s_mov_b32 s30, 0x10000
s_mov_b32 s31, 0x20000
s_lshl_b32 s72, s56, 7
s_lshl_b32 s73, s52, 4
s_add_u32 s72, s72, s73
s_lshl_b32 s62, s55, 20
s_lshl_b32 s73, s72, 9
s_add_u32 s62, s62, s73
s_add_u32 s63, s62, 4096
s_lshl_b32 s64, s72, 8
s_lshl_b32 s65, s55, 12
s_lshl_b32 s73, s72, 1
s_add_u32 s65, s65, s73
v_and_b32 v4, 7, v0
v_lshrrev_b32 v5, 3, v0
v_lshlrev_b32 v236, 9, v5
v_lshl_add_u32 v236, v4, 4, v236
v_lshlrev_b32 v237, 8, v5
v_lshl_add_u32 v237, v4, 3, v237
v_lshlrev_b32 v238, 1, v5
buffer_load_dwordx4 v[140:143], v236, s[8:11], s62 offen offset:0 nt
buffer_load_dwordx4 v[144:147], v236, s[8:11], s62 offen offset:256 nt
buffer_load_ushort v204, v238, s[24:27], s65 offen offset:0
buffer_load_ushort v205, v238, s[28:31], s65 offen offset:0
buffer_load_dwordx2 v[172:173], v237, s[16:19], s64 offen offset:0
buffer_load_dwordx2 v[174:175], v237, s[16:19], s64 offen offset:128
buffer_load_dwordx2 v[176:177], v237, s[20:23], s64 offen offset:0
buffer_load_dwordx2 v[178:179], v237, s[20:23], s64 offen offset:128
buffer_load_dwordx4 v[148:151], v236, s[8:11], s63 offen offset:0 nt
buffer_load_dwordx4 v[152:155], v236, s[8:11], s63 offen offset:256 nt
buffer_load_ushort v206, v238, s[24:27], s65 offen offset:16
buffer_load_ushort v207, v238, s[28:31], s65 offen offset:16
buffer_load_dwordx2 v[180:181], v237, s[16:19], s64 offen offset:2048
buffer_load_dwordx2 v[182:183], v237, s[16:19], s64 offen offset:2176
buffer_load_dwordx2 v[184:185], v237, s[20:23], s64 offen offset:2048
buffer_load_dwordx2 v[186:187], v237, s[20:23], s64 offen offset:2176
buffer_load_dwordx4 v[156:159], v236, s[8:11], s62 offen offset:128 nt
buffer_load_dwordx4 v[160:163], v236, s[8:11], s62 offen offset:384 nt
buffer_load_ushort v208, v238, s[24:27], s65 offen offset:0
buffer_load_ushort v209, v238, s[28:31], s65 offen offset:0
buffer_load_dwordx2 v[188:189], v237, s[16:19], s64 offen offset:64
buffer_load_dwordx2 v[190:191], v237, s[16:19], s64 offen offset:192
buffer_load_dwordx2 v[192:193], v237, s[20:23], s64 offen offset:64
buffer_load_dwordx2 v[194:195], v237, s[20:23], s64 offen offset:192
buffer_load_dwordx4 v[164:167], v236, s[8:11], s63 offen offset:128 nt
buffer_load_dwordx4 v[168:171], v236, s[8:11], s63 offen offset:384 nt
buffer_load_ushort v210, v238, s[24:27], s65 offen offset:16
buffer_load_ushort v211, v238, s[28:31], s65 offen offset:16
buffer_load_dwordx2 v[196:197], v237, s[16:19], s64 offen offset:2112
buffer_load_dwordx2 v[198:199], v237, s[16:19], s64 offen offset:2240
buffer_load_dwordx2 v[200:201], v237, s[20:23], s64 offen offset:2112
buffer_load_dwordx2 v[202:203], v237, s[20:23], s64 offen offset:2240
v_lshrrev_b32 v239, 2, v4
v_lshlrev_b32 v239, 10, v239
v_and_b32 v4, 3, v4
v_lshl_add_u32 v239, v4, 8, v239
v_lshl_add_u32 v239, v5, 4, v239
s_lshl_b32 s73, s52, 12
s_and_b32 s72, s56, 1
s_lshl_b32 s72, s72, 19
s_add_u32 s66, s72, s73
s_lshr_b32 s72, s56, 1
s_lshl_b32 s72, s72, 14
s_add_u32 s66, s66, s72
s_add_u32 s62, s62, 0x4000
s_add_u32 s63, s63, 0x4000
s_add_u32 s65, s65, 64
s_add_u32 s64, s64, 0x2000
buffer_load_dwordx4 a[0:3], v236, s[8:11], s62 offen offset:0 nt
buffer_load_dwordx4 a[4:7], v236, s[8:11], s62 offen offset:256 nt
buffer_load_ushort a64, v238, s[24:27], s65 offen offset:0
buffer_load_ushort a65, v238, s[28:31], s65 offen offset:0
buffer_load_dwordx2 a[32:33], v237, s[16:19], s64 offen offset:0
buffer_load_dwordx2 a[34:35], v237, s[16:19], s64 offen offset:128
buffer_load_dwordx2 a[36:37], v237, s[20:23], s64 offen offset:0
buffer_load_dwordx2 a[38:39], v237, s[20:23], s64 offen offset:128
buffer_load_dwordx4 a[8:11], v236, s[8:11], s63 offen offset:0 nt
buffer_load_dwordx4 a[12:15], v236, s[8:11], s63 offen offset:256 nt
buffer_load_ushort a66, v238, s[24:27], s65 offen offset:16
buffer_load_ushort a67, v238, s[28:31], s65 offen offset:16
buffer_load_dwordx2 a[40:41], v237, s[16:19], s64 offen offset:2048
buffer_load_dwordx2 a[42:43], v237, s[16:19], s64 offen offset:2176
buffer_load_dwordx2 a[44:45], v237, s[20:23], s64 offen offset:2048
buffer_load_dwordx2 a[46:47], v237, s[20:23], s64 offen offset:2176
buffer_load_dwordx4 a[16:19], v236, s[8:11], s62 offen offset:128 nt
buffer_load_dwordx4 a[20:23], v236, s[8:11], s62 offen offset:384 nt
buffer_load_ushort a68, v238, s[24:27], s65 offen offset:0
buffer_load_ushort a69, v238, s[28:31], s65 offen offset:0
buffer_load_dwordx2 a[48:49], v237, s[16:19], s64 offen offset:64
buffer_load_dwordx2 a[50:51], v237, s[16:19], s64 offen offset:192
buffer_load_dwordx2 a[52:53], v237, s[20:23], s64 offen offset:64
buffer_load_dwordx2 a[54:55], v237, s[20:23], s64 offen offset:192
buffer_load_dwordx4 a[24:27], v236, s[8:11], s63 offen offset:128 nt
buffer_load_dwordx4 a[28:31], v236, s[8:11], s63 offen offset:384 nt
buffer_load_ushort a70, v238, s[24:27], s65 offen offset:16
buffer_load_ushort a71, v238, s[28:31], s65 offen offset:16
buffer_load_dwordx2 a[56:57], v237, s[16:19], s64 offen offset:2112
buffer_load_dwordx2 a[58:59], v237, s[16:19], s64 offen offset:2240
buffer_load_dwordx2 a[60:61], v237, s[20:23], s64 offen offset:2112
buffer_load_dwordx2 a[62:63], v237, s[20:23], s64 offen offset:2240
s_add_u32 s62, s62, 0x4000
s_add_u32 s63, s63, 0x4000
s_add_u32 s65, s65, 64
s_add_u32 s64, s64, 0x2000
s_waitcnt vmcnt(56)
v_lshlrev_b32 v204, 16, v204
v_lshlrev_b32 v205, 16, v205
v_cvt_f32_i32 v140, v140
v_cvt_f32_i32 v141, v141
v_cvt_f32_i32 v142, v142
v_cvt_f32_i32 v143, v143
v_mul_f32 v205, v205, v204
v_cvt_f32_i32 v144, v144
v_cvt_f32_i32 v145, v145
v_cvt_f32_i32 v146, v146
v_cvt_f32_i32 v147, v147
v_fma_f32 v140, v140, v204, -v205
v_fma_f32 v141, v141, v204, -v205
v_fma_f32 v142, v142, v204, -v205
v_fma_f32 v143, v143, v204, -v205
v_fma_f32 v144, v144, v204, -v205
v_fma_f32 v145, v145, v204, -v205
v_fma_f32 v146, v146, v204, -v205
v_fma_f32 v147, v147, v204, -v205
v_lshlrev_b32 v212, 16, v172
v_and_b32 v213, 0xffff0000, v172
v_lshlrev_b32 v214, 16, v173
v_and_b32 v215, 0xffff0000, v173
v_lshlrev_b32 v216, 16, v174
v_and_b32 v217, 0xffff0000, v174
v_lshlrev_b32 v218, 16, v175
v_and_b32 v219, 0xffff0000, v175
v_lshlrev_b32 v220, 16, v176
v_and_b32 v221, 0xffff0000, v176
v_lshlrev_b32 v222, 16, v177
v_and_b32 v223, 0xffff0000, v177
v_lshlrev_b32 v224, 16, v178
v_and_b32 v225, 0xffff0000, v178
v_lshlrev_b32 v226, 16, v179
v_and_b32 v227, 0xffff0000, v179
v_mul_f32 v212, v140, v212
v_mul_f32 v216, v144, v216
v_mul_f32 v213, v141, v213
v_mul_f32 v217, v145, v217
v_mul_f32 v214, v142, v214
v_mul_f32 v218, v146, v218
v_mul_f32 v215, v143, v215
v_mul_f32 v219, v147, v219
v_fma_f32 v212, -v144, v220, v212
v_fma_f32 v216, v140, v224, v216
v_fma_f32 v213, -v145, v221, v213
v_fma_f32 v217, v141, v225, v217
v_fma_f32 v214, -v146, v222, v214
v_fma_f32 v218, v142, v226, v218
v_fma_f32 v215, -v147, v223, v215
v_fma_f32 v219, v143, v227, v219
v_cvt_pk_bf16_f32 v228, v212, v213
v_cvt_pk_bf16_f32 v229, v214, v215
v_cvt_pk_bf16_f32 v230, v216, v217
v_cvt_pk_bf16_f32 v231, v218, v219
buffer_store_dwordx4 v[228:231], v239, s[12:15], s66 offen offset:0 sc1
s_waitcnt vmcnt(49)
v_lshlrev_b32 v206, 16, v206
v_lshlrev_b32 v207, 16, v207
v_cvt_f32_i32 v148, v148
v_cvt_f32_i32 v149, v149
v_cvt_f32_i32 v150, v150
v_cvt_f32_i32 v151, v151
v_mul_f32 v207, v207, v206
v_cvt_f32_i32 v152, v152
v_cvt_f32_i32 v153, v153
v_cvt_f32_i32 v154, v154
v_cvt_f32_i32 v155, v155
v_fma_f32 v148, v148, v206, -v207
v_fma_f32 v149, v149, v206, -v207
v_fma_f32 v150, v150, v206, -v207
v_fma_f32 v151, v151, v206, -v207
v_fma_f32 v152, v152, v206, -v207
v_fma_f32 v153, v153, v206, -v207
v_fma_f32 v154, v154, v206, -v207
v_fma_f32 v155, v155, v206, -v207
v_lshlrev_b32 v212, 16, v180
v_and_b32 v213, 0xffff0000, v180
v_lshlrev_b32 v214, 16, v181
v_and_b32 v215, 0xffff0000, v181
v_lshlrev_b32 v216, 16, v182
v_and_b32 v217, 0xffff0000, v182
v_lshlrev_b32 v218, 16, v183
v_and_b32 v219, 0xffff0000, v183
v_lshlrev_b32 v220, 16, v184
v_and_b32 v221, 0xffff0000, v184
v_lshlrev_b32 v222, 16, v185
v_and_b32 v223, 0xffff0000, v185
v_lshlrev_b32 v224, 16, v186
v_and_b32 v225, 0xffff0000, v186
v_lshlrev_b32 v226, 16, v187
v_and_b32 v227, 0xffff0000, v187
v_mul_f32 v212, v148, v212
v_mul_f32 v216, v152, v216
v_mul_f32 v213, v149, v213
v_mul_f32 v217, v153, v217
v_mul_f32 v214, v150, v214
v_mul_f32 v218, v154, v218
v_mul_f32 v215, v151, v215
v_mul_f32 v219, v155, v219
v_fma_f32 v212, -v152, v220, v212
v_fma_f32 v216, v148, v224, v216
v_fma_f32 v213, -v153, v221, v213
v_fma_f32 v217, v149, v225, v217
v_fma_f32 v214, -v154, v222, v214
v_fma_f32 v218, v150, v226, v218
v_fma_f32 v215, -v155, v223, v215
v_fma_f32 v219, v151, v227, v219
v_cvt_pk_bf16_f32 v232, v212, v213
v_cvt_pk_bf16_f32 v233, v214, v215
v_cvt_pk_bf16_f32 v234, v216, v217
v_cvt_pk_bf16_f32 v235, v218, v219
buffer_store_dwordx4 v[232:235], v239, s[12:15], s66 offen offset:128 sc1
s_waitcnt vmcnt(42)
v_lshlrev_b32 v208, 16, v208
v_lshlrev_b32 v209, 16, v209
v_cvt_f32_i32 v156, v156
v_cvt_f32_i32 v157, v157
v_cvt_f32_i32 v158, v158
v_cvt_f32_i32 v159, v159
v_mul_f32 v209, v209, v208
v_cvt_f32_i32 v160, v160
v_cvt_f32_i32 v161, v161
v_cvt_f32_i32 v162, v162
v_cvt_f32_i32 v163, v163
v_fma_f32 v156, v156, v208, -v209
v_fma_f32 v157, v157, v208, -v209
v_fma_f32 v158, v158, v208, -v209
v_fma_f32 v159, v159, v208, -v209
v_fma_f32 v160, v160, v208, -v209
v_fma_f32 v161, v161, v208, -v209
v_fma_f32 v162, v162, v208, -v209
v_fma_f32 v163, v163, v208, -v209
v_lshlrev_b32 v212, 16, v188
v_and_b32 v213, 0xffff0000, v188
v_lshlrev_b32 v214, 16, v189
v_and_b32 v215, 0xffff0000, v189
v_lshlrev_b32 v216, 16, v190
v_and_b32 v217, 0xffff0000, v190
v_lshlrev_b32 v218, 16, v191
v_and_b32 v219, 0xffff0000, v191
v_lshlrev_b32 v220, 16, v192
v_and_b32 v221, 0xffff0000, v192
v_lshlrev_b32 v222, 16, v193
v_and_b32 v223, 0xffff0000, v193
v_lshlrev_b32 v224, 16, v194
v_and_b32 v225, 0xffff0000, v194
v_lshlrev_b32 v226, 16, v195
v_and_b32 v227, 0xffff0000, v195
v_mul_f32 v212, v156, v212
v_mul_f32 v216, v160, v216
v_mul_f32 v213, v157, v213
v_mul_f32 v217, v161, v217
v_mul_f32 v214, v158, v214
v_mul_f32 v218, v162, v218
v_mul_f32 v215, v159, v215
v_mul_f32 v219, v163, v219
v_fma_f32 v212, -v160, v220, v212
v_fma_f32 v216, v156, v224, v216
v_fma_f32 v213, -v161, v221, v213
v_fma_f32 v217, v157, v225, v217
v_fma_f32 v214, -v162, v222, v214
v_fma_f32 v218, v158, v226, v218
v_fma_f32 v215, -v163, v223, v215
v_fma_f32 v219, v159, v227, v219
v_cvt_pk_bf16_f32 v228, v212, v213
v_cvt_pk_bf16_f32 v229, v214, v215
v_cvt_pk_bf16_f32 v230, v216, v217
v_cvt_pk_bf16_f32 v231, v218, v219
buffer_store_dwordx4 v[228:231], v239, s[12:15], s66 offen offset:2048 sc1
s_waitcnt vmcnt(35)
v_lshlrev_b32 v210, 16, v210
v_lshlrev_b32 v211, 16, v211
v_cvt_f32_i32 v164, v164
v_cvt_f32_i32 v165, v165
v_cvt_f32_i32 v166, v166
v_cvt_f32_i32 v167, v167
v_mul_f32 v211, v211, v210
v_cvt_f32_i32 v168, v168
v_cvt_f32_i32 v169, v169
v_cvt_f32_i32 v170, v170
v_cvt_f32_i32 v171, v171
v_fma_f32 v164, v164, v210, -v211
v_fma_f32 v165, v165, v210, -v211
v_fma_f32 v166, v166, v210, -v211
v_fma_f32 v167, v167, v210, -v211
v_fma_f32 v168, v168, v210, -v211
v_fma_f32 v169, v169, v210, -v211
v_fma_f32 v170, v170, v210, -v211
v_fma_f32 v171, v171, v210, -v211
v_lshlrev_b32 v212, 16, v196
v_and_b32 v213, 0xffff0000, v196
v_lshlrev_b32 v214, 16, v197
v_and_b32 v215, 0xffff0000, v197
v_lshlrev_b32 v216, 16, v198
v_and_b32 v217, 0xffff0000, v198
v_lshlrev_b32 v218, 16, v199
v_and_b32 v219, 0xffff0000, v199
v_lshlrev_b32 v220, 16, v200
v_and_b32 v221, 0xffff0000, v200
v_lshlrev_b32 v222, 16, v201
v_and_b32 v223, 0xffff0000, v201
v_lshlrev_b32 v224, 16, v202
v_and_b32 v225, 0xffff0000, v202
v_lshlrev_b32 v226, 16, v203
v_and_b32 v227, 0xffff0000, v203
v_mul_f32 v212, v164, v212
v_mul_f32 v216, v168, v216
v_mul_f32 v213, v165, v213
v_mul_f32 v217, v169, v217
v_mul_f32 v214, v166, v214
v_mul_f32 v218, v170, v218
v_mul_f32 v215, v167, v215
v_mul_f32 v219, v171, v219
v_fma_f32 v212, -v168, v220, v212
v_fma_f32 v216, v164, v224, v216
v_fma_f32 v213, -v169, v221, v213
v_fma_f32 v217, v165, v225, v217
v_fma_f32 v214, -v170, v222, v214
v_fma_f32 v218, v166, v226, v218
v_fma_f32 v215, -v171, v223, v215
v_fma_f32 v219, v167, v227, v219
v_cvt_pk_bf16_f32 v232, v212, v213
v_cvt_pk_bf16_f32 v233, v214, v215
v_cvt_pk_bf16_f32 v234, v216, v217
v_cvt_pk_bf16_f32 v235, v218, v219
buffer_store_dwordx4 v[232:235], v239, s[12:15], s66 offen offset:2176 sc1
s_add_u32 s66, s66, 0x20000
s_mov_b32 s48, s90
s_mov_b32 s49, s91
s_mov_b32 s50, s92
s_mov_b32 s51, s93
s_mov_b32 s76, s76
s_and_b32 s77, s77, 0xffff
s_mov_b32 s78, 0x800000
s_mov_b32 s79, 0x20000
s_mov_b32 s80, s48
s_and_b32 s81, s49, 0xffff
s_mov_b32 s82, 0x80000
s_mov_b32 s83, 0x20000
s_mov_b32 s84, s50
s_and_b32 s85, s51, 0xffff
s_mov_b32 s86, 0x80000
s_mov_b32 s87, 0x20000
s_lshl_b32 s46, s56, 15
s_lshl_b32 s47, s52, 13
s_add_u32 s46, s46, s47
s_lshl_b32 s44, s55, 19
s_add_u32 s44, s44, s46
s_add_u32 s45, s44, 4096
s_add_u32 s47, s46, 4096
v_lshrrev_b32 v4, 3, v0
v_lshlrev_b32 v4, 8, v4
v_and_b32 v5, 7, v0
v_lshl_add_u32 v4, v5, 4, v4
buffer_load_dwordx4 v[8:11], v4, s[76:79], s44 offen offset:0 nt
buffer_load_dwordx4 v[12:15], v4, s[76:79], s44 offen offset:128 nt
buffer_load_dwordx4 v[16:19], v4, s[80:83], s46 offen offset:0
buffer_load_dwordx4 v[20:23], v4, s[80:83], s46 offen offset:128
buffer_load_dwordx4 v[24:27], v4, s[84:87], s46 offen offset:0
buffer_load_dwordx4 v[28:31], v4, s[84:87], s46 offen offset:128
buffer_load_dwordx4 v[32:35], v4, s[76:79], s44 offen offset:2048 nt
buffer_load_dwordx4 v[36:39], v4, s[76:79], s44 offen offset:2176 nt
buffer_load_dwordx4 v[40:43], v4, s[80:83], s46 offen offset:2048
buffer_load_dwordx4 v[44:47], v4, s[80:83], s46 offen offset:2176
buffer_load_dwordx4 v[48:51], v4, s[84:87], s46 offen offset:2048
buffer_load_dwordx4 v[52:55], v4, s[84:87], s46 offen offset:2176
buffer_load_dwordx4 v[56:59], v4, s[76:79], s45 offen offset:0 nt
buffer_load_dwordx4 v[60:63], v4, s[76:79], s45 offen offset:128 nt
buffer_load_dwordx4 v[64:67], v4, s[80:83], s47 offen offset:0
buffer_load_dwordx4 v[68:71], v4, s[80:83], s47 offen offset:128
buffer_load_dwordx4 v[72:75], v4, s[84:87], s47 offen offset:0
buffer_load_dwordx4 v[76:79], v4, s[84:87], s47 offen offset:128
buffer_load_dwordx4 v[80:83], v4, s[76:79], s45 offen offset:2048 nt
buffer_load_dwordx4 v[84:87], v4, s[76:79], s45 offen offset:2176 nt
buffer_load_dwordx4 v[88:91], v4, s[80:83], s47 offen offset:2048
buffer_load_dwordx4 v[92:95], v4, s[80:83], s47 offen offset:2176
buffer_load_dwordx4 v[96:99], v4, s[84:87], s47 offen offset:2048
buffer_load_dwordx4 v[100:103], v4, s[84:87], s47 offen offset:2176
v_bfe_u32 v5, v0, 1, 2
v_lshlrev_b32 v5, 10, v5
v_and_b32 v244, 1, v0
v_lshl_add_u32 v5, v244, 9, v5
v_lshrrev_b32 v244, 3, v0
v_lshl_add_u32 v5, v244, 4, v5
s_lshl_b32 s72, s52, 13
s_add_u32 s72, s72, 0x20000
v_add_u32 v5, s72, v5
s_waitcnt vmcnt(52)
v_accvgpr_read_b32 v140, a0
v_accvgpr_read_b32 v141, a1
v_accvgpr_read_b32 v142, a2
v_accvgpr_read_b32 v143, a3
v_accvgpr_read_b32 v144, a4
v_accvgpr_read_b32 v145, a5
v_accvgpr_read_b32 v146, a6
v_accvgpr_read_b32 v147, a7
v_accvgpr_read_b32 v172, a32
v_accvgpr_read_b32 v173, a33
v_accvgpr_read_b32 v174, a34
v_accvgpr_read_b32 v175, a35
v_accvgpr_read_b32 v176, a36
v_accvgpr_read_b32 v177, a37
v_accvgpr_read_b32 v178, a38
v_accvgpr_read_b32 v179, a39
v_accvgpr_read_b32 v204, a64
v_accvgpr_read_b32 v205, a65
v_lshlrev_b32 v204, 16, v204
v_lshlrev_b32 v205, 16, v205
v_cvt_f32_i32 v140, v140
v_cvt_f32_i32 v141, v141
v_cvt_f32_i32 v142, v142
v_cvt_f32_i32 v143, v143
v_mul_f32 v205, v205, v204
v_cvt_f32_i32 v144, v144
v_cvt_f32_i32 v145, v145
v_cvt_f32_i32 v146, v146
v_cvt_f32_i32 v147, v147
v_fma_f32 v140, v140, v204, -v205
v_fma_f32 v141, v141, v204, -v205
v_fma_f32 v142, v142, v204, -v205
v_fma_f32 v143, v143, v204, -v205
v_fma_f32 v144, v144, v204, -v205
v_fma_f32 v145, v145, v204, -v205
v_fma_f32 v146, v146, v204, -v205
v_fma_f32 v147, v147, v204, -v205
v_lshlrev_b32 v212, 16, v172
v_and_b32 v213, 0xffff0000, v172
v_lshlrev_b32 v214, 16, v173
v_and_b32 v215, 0xffff0000, v173
v_lshlrev_b32 v216, 16, v174
v_and_b32 v217, 0xffff0000, v174
v_lshlrev_b32 v218, 16, v175
v_and_b32 v219, 0xffff0000, v175
v_lshlrev_b32 v220, 16, v176
v_and_b32 v221, 0xffff0000, v176
v_lshlrev_b32 v222, 16, v177
v_and_b32 v223, 0xffff0000, v177
v_lshlrev_b32 v224, 16, v178
v_and_b32 v225, 0xffff0000, v178
v_lshlrev_b32 v226, 16, v179
v_and_b32 v227, 0xffff0000, v179
v_mul_f32 v212, v140, v212
v_mul_f32 v216, v144, v216
v_mul_f32 v213, v141, v213
v_mul_f32 v217, v145, v217
v_mul_f32 v214, v142, v214
v_mul_f32 v218, v146, v218
v_mul_f32 v215, v143, v215
v_mul_f32 v219, v147, v219
v_fma_f32 v212, -v144, v220, v212
v_fma_f32 v216, v140, v224, v216
v_fma_f32 v213, -v145, v221, v213
v_fma_f32 v217, v141, v225, v217
v_fma_f32 v214, -v146, v222, v214
v_fma_f32 v218, v142, v226, v218
v_fma_f32 v215, -v147, v223, v215
v_fma_f32 v219, v143, v227, v219
v_cvt_pk_bf16_f32 v228, v212, v213
v_cvt_pk_bf16_f32 v229, v214, v215
v_cvt_pk_bf16_f32 v230, v216, v217
v_cvt_pk_bf16_f32 v231, v218, v219
buffer_store_dwordx4 v[228:231], v239, s[12:15], s66 offen offset:0 sc1
s_waitcnt vmcnt(45)
v_accvgpr_read_b32 v148, a8
v_accvgpr_read_b32 v149, a9
v_accvgpr_read_b32 v150, a10
v_accvgpr_read_b32 v151, a11
v_accvgpr_read_b32 v152, a12
v_accvgpr_read_b32 v153, a13
v_accvgpr_read_b32 v154, a14
v_accvgpr_read_b32 v155, a15
v_accvgpr_read_b32 v180, a40
v_accvgpr_read_b32 v181, a41
v_accvgpr_read_b32 v182, a42
v_accvgpr_read_b32 v183, a43
v_accvgpr_read_b32 v184, a44
v_accvgpr_read_b32 v185, a45
v_accvgpr_read_b32 v186, a46
v_accvgpr_read_b32 v187, a47
v_accvgpr_read_b32 v206, a66
v_accvgpr_read_b32 v207, a67
v_lshlrev_b32 v206, 16, v206
v_lshlrev_b32 v207, 16, v207
v_cvt_f32_i32 v148, v148
v_cvt_f32_i32 v149, v149
v_cvt_f32_i32 v150, v150
v_cvt_f32_i32 v151, v151
v_mul_f32 v207, v207, v206
v_cvt_f32_i32 v152, v152
v_cvt_f32_i32 v153, v153
v_cvt_f32_i32 v154, v154
v_cvt_f32_i32 v155, v155
v_fma_f32 v148, v148, v206, -v207
v_fma_f32 v149, v149, v206, -v207
v_fma_f32 v150, v150, v206, -v207
v_fma_f32 v151, v151, v206, -v207
v_fma_f32 v152, v152, v206, -v207
v_fma_f32 v153, v153, v206, -v207
v_fma_f32 v154, v154, v206, -v207
v_fma_f32 v155, v155, v206, -v207
v_lshlrev_b32 v212, 16, v180
v_and_b32 v213, 0xffff0000, v180
v_lshlrev_b32 v214, 16, v181
v_and_b32 v215, 0xffff0000, v181
v_lshlrev_b32 v216, 16, v182
v_and_b32 v217, 0xffff0000, v182
v_lshlrev_b32 v218, 16, v183
v_and_b32 v219, 0xffff0000, v183
v_lshlrev_b32 v220, 16, v184
v_and_b32 v221, 0xffff0000, v184
v_lshlrev_b32 v222, 16, v185
v_and_b32 v223, 0xffff0000, v185
v_lshlrev_b32 v224, 16, v186
v_and_b32 v225, 0xffff0000, v186
v_lshlrev_b32 v226, 16, v187
v_and_b32 v227, 0xffff0000, v187
v_mul_f32 v212, v148, v212
v_mul_f32 v216, v152, v216
v_mul_f32 v213, v149, v213
v_mul_f32 v217, v153, v217
v_mul_f32 v214, v150, v214
v_mul_f32 v218, v154, v218
v_mul_f32 v215, v151, v215
v_mul_f32 v219, v155, v219
v_fma_f32 v212, -v152, v220, v212
v_fma_f32 v216, v148, v224, v216
v_fma_f32 v213, -v153, v221, v213
v_fma_f32 v217, v149, v225, v217
v_fma_f32 v214, -v154, v222, v214
v_fma_f32 v218, v150, v226, v218
v_fma_f32 v215, -v155, v223, v215
v_fma_f32 v219, v151, v227, v219
v_cvt_pk_bf16_f32 v232, v212, v213
v_cvt_pk_bf16_f32 v233, v214, v215
v_cvt_pk_bf16_f32 v234, v216, v217
v_cvt_pk_bf16_f32 v235, v218, v219
buffer_store_dwordx4 v[232:235], v239, s[12:15], s66 offen offset:128 sc1
s_waitcnt vmcnt(38)
v_accvgpr_read_b32 v156, a16
v_accvgpr_read_b32 v157, a17
v_accvgpr_read_b32 v158, a18
v_accvgpr_read_b32 v159, a19
v_accvgpr_read_b32 v160, a20
v_accvgpr_read_b32 v161, a21
v_accvgpr_read_b32 v162, a22
v_accvgpr_read_b32 v163, a23
v_accvgpr_read_b32 v188, a48
v_accvgpr_read_b32 v189, a49
v_accvgpr_read_b32 v190, a50
v_accvgpr_read_b32 v191, a51
v_accvgpr_read_b32 v192, a52
v_accvgpr_read_b32 v193, a53
v_accvgpr_read_b32 v194, a54
v_accvgpr_read_b32 v195, a55
v_accvgpr_read_b32 v208, a68
v_accvgpr_read_b32 v209, a69
v_lshlrev_b32 v208, 16, v208
v_lshlrev_b32 v209, 16, v209
v_cvt_f32_i32 v156, v156
v_cvt_f32_i32 v157, v157
v_cvt_f32_i32 v158, v158
v_cvt_f32_i32 v159, v159
v_mul_f32 v209, v209, v208
v_cvt_f32_i32 v160, v160
v_cvt_f32_i32 v161, v161
v_cvt_f32_i32 v162, v162
v_cvt_f32_i32 v163, v163
v_fma_f32 v156, v156, v208, -v209
v_fma_f32 v157, v157, v208, -v209
v_fma_f32 v158, v158, v208, -v209
v_fma_f32 v159, v159, v208, -v209
v_fma_f32 v160, v160, v208, -v209
v_fma_f32 v161, v161, v208, -v209
v_fma_f32 v162, v162, v208, -v209
v_fma_f32 v163, v163, v208, -v209
v_lshlrev_b32 v212, 16, v188
v_and_b32 v213, 0xffff0000, v188
v_lshlrev_b32 v214, 16, v189
v_and_b32 v215, 0xffff0000, v189
v_lshlrev_b32 v216, 16, v190
v_and_b32 v217, 0xffff0000, v190
v_lshlrev_b32 v218, 16, v191
v_and_b32 v219, 0xffff0000, v191
v_lshlrev_b32 v220, 16, v192
v_and_b32 v221, 0xffff0000, v192
v_lshlrev_b32 v222, 16, v193
v_and_b32 v223, 0xffff0000, v193
v_lshlrev_b32 v224, 16, v194
v_and_b32 v225, 0xffff0000, v194
v_lshlrev_b32 v226, 16, v195
v_and_b32 v227, 0xffff0000, v195
v_mul_f32 v212, v156, v212
v_mul_f32 v216, v160, v216
v_mul_f32 v213, v157, v213
v_mul_f32 v217, v161, v217
v_mul_f32 v214, v158, v214
v_mul_f32 v218, v162, v218
v_mul_f32 v215, v159, v215
v_mul_f32 v219, v163, v219
v_fma_f32 v212, -v160, v220, v212
v_fma_f32 v216, v156, v224, v216
v_fma_f32 v213, -v161, v221, v213
v_fma_f32 v217, v157, v225, v217
v_fma_f32 v214, -v162, v222, v214
v_fma_f32 v218, v158, v226, v218
v_fma_f32 v215, -v163, v223, v215
v_fma_f32 v219, v159, v227, v219
v_cvt_pk_bf16_f32 v228, v212, v213
v_cvt_pk_bf16_f32 v229, v214, v215
v_cvt_pk_bf16_f32 v230, v216, v217
v_cvt_pk_bf16_f32 v231, v218, v219
buffer_store_dwordx4 v[228:231], v239, s[12:15], s66 offen offset:2048 sc1
s_waitcnt vmcnt(31)
v_accvgpr_read_b32 v164, a24
v_accvgpr_read_b32 v165, a25
v_accvgpr_read_b32 v166, a26
v_accvgpr_read_b32 v167, a27
v_accvgpr_read_b32 v168, a28
v_accvgpr_read_b32 v169, a29
v_accvgpr_read_b32 v170, a30
v_accvgpr_read_b32 v171, a31
v_accvgpr_read_b32 v196, a56
v_accvgpr_read_b32 v197, a57
v_accvgpr_read_b32 v198, a58
v_accvgpr_read_b32 v199, a59
v_accvgpr_read_b32 v200, a60
v_accvgpr_read_b32 v201, a61
v_accvgpr_read_b32 v202, a62
v_accvgpr_read_b32 v203, a63
v_accvgpr_read_b32 v210, a70
v_accvgpr_read_b32 v211, a71
v_lshlrev_b32 v210, 16, v210
v_lshlrev_b32 v211, 16, v211
v_cvt_f32_i32 v164, v164
v_cvt_f32_i32 v165, v165
v_cvt_f32_i32 v166, v166
v_cvt_f32_i32 v167, v167
v_mul_f32 v211, v211, v210
v_cvt_f32_i32 v168, v168
v_cvt_f32_i32 v169, v169
v_cvt_f32_i32 v170, v170
v_cvt_f32_i32 v171, v171
v_fma_f32 v164, v164, v210, -v211
v_fma_f32 v165, v165, v210, -v211
v_fma_f32 v166, v166, v210, -v211
v_fma_f32 v167, v167, v210, -v211
v_fma_f32 v168, v168, v210, -v211
v_fma_f32 v169, v169, v210, -v211
v_fma_f32 v170, v170, v210, -v211
v_fma_f32 v171, v171, v210, -v211
v_lshlrev_b32 v212, 16, v196
v_and_b32 v213, 0xffff0000, v196
v_lshlrev_b32 v214, 16, v197
v_and_b32 v215, 0xffff0000, v197
v_lshlrev_b32 v216, 16, v198
v_and_b32 v217, 0xffff0000, v198
v_lshlrev_b32 v218, 16, v199
v_and_b32 v219, 0xffff0000, v199
v_lshlrev_b32 v220, 16, v200
v_and_b32 v221, 0xffff0000, v200
v_lshlrev_b32 v222, 16, v201
v_and_b32 v223, 0xffff0000, v201
v_lshlrev_b32 v224, 16, v202
v_and_b32 v225, 0xffff0000, v202
v_lshlrev_b32 v226, 16, v203
v_and_b32 v227, 0xffff0000, v203
v_mul_f32 v212, v164, v212
v_mul_f32 v216, v168, v216
v_mul_f32 v213, v165, v213
v_mul_f32 v217, v169, v217
v_mul_f32 v214, v166, v214
v_mul_f32 v218, v170, v218
v_mul_f32 v215, v167, v215
v_mul_f32 v219, v171, v219
v_fma_f32 v212, -v168, v220, v212
v_fma_f32 v216, v164, v224, v216
v_fma_f32 v213, -v169, v221, v213
v_fma_f32 v217, v165, v225, v217
v_fma_f32 v214, -v170, v222, v214
v_fma_f32 v218, v166, v226, v218
v_fma_f32 v215, -v171, v223, v215
v_fma_f32 v219, v167, v227, v219
v_cvt_pk_bf16_f32 v232, v212, v213
v_cvt_pk_bf16_f32 v233, v214, v215
v_cvt_pk_bf16_f32 v234, v216, v217
v_cvt_pk_bf16_f32 v235, v218, v219
buffer_store_dwordx4 v[232:235], v239, s[12:15], s66 offen offset:2176 sc1
s_add_u32 s66, s66, 0x20000
v_mov_b32 v136, 0x3f803f80
v_mov_b32 v137, 0x3f803f80
v_mov_b32 v138, 0x3f803f80
v_mov_b32 v139, 0x3f803f80
v_accvgpr_write_b32 a0, 0
v_accvgpr_write_b32 a1, 0
v_accvgpr_write_b32 a2, 0
v_accvgpr_write_b32 a3, 0
v_accvgpr_write_b32 a4, 0
v_accvgpr_write_b32 a5, 0
v_accvgpr_write_b32 a6, 0
v_accvgpr_write_b32 a7, 0
v_accvgpr_write_b32 a8, 0
v_accvgpr_write_b32 a9, 0
v_accvgpr_write_b32 a10, 0
v_accvgpr_write_b32 a11, 0
v_accvgpr_write_b32 a12, 0
v_accvgpr_write_b32 a13, 0
v_accvgpr_write_b32 a14, 0
v_accvgpr_write_b32 a15, 0
v_accvgpr_write_b32 a16, 0
v_accvgpr_write_b32 a17, 0
v_accvgpr_write_b32 a18, 0
v_accvgpr_write_b32 a19, 0
v_accvgpr_write_b32 a20, 0
v_accvgpr_write_b32 a21, 0
v_accvgpr_write_b32 a22, 0
v_accvgpr_write_b32 a23, 0
v_accvgpr_write_b32 a24, 0
v_accvgpr_write_b32 a25, 0
v_accvgpr_write_b32 a26, 0
v_accvgpr_write_b32 a27, 0
v_accvgpr_write_b32 a28, 0
v_accvgpr_write_b32 a29, 0
v_accvgpr_write_b32 a30, 0
v_accvgpr_write_b32 a31, 0
v_accvgpr_write_b32 a32, 0
v_accvgpr_write_b32 a33, 0
v_accvgpr_write_b32 a34, 0
v_accvgpr_write_b32 a35, 0
v_accvgpr_write_b32 a36, 0
v_accvgpr_write_b32 a37, 0
v_accvgpr_write_b32 a38, 0
v_accvgpr_write_b32 a39, 0
v_accvgpr_write_b32 a40, 0
v_accvgpr_write_b32 a41, 0
v_accvgpr_write_b32 a42, 0
v_accvgpr_write_b32 a43, 0
v_accvgpr_write_b32 a44, 0
v_accvgpr_write_b32 a45, 0
v_accvgpr_write_b32 a46, 0
v_accvgpr_write_b32 a47, 0
v_accvgpr_write_b32 a48, 0
v_accvgpr_write_b32 a49, 0
v_accvgpr_write_b32 a50, 0
v_accvgpr_write_b32 a51, 0
v_accvgpr_write_b32 a52, 0
v_accvgpr_write_b32 a53, 0
v_accvgpr_write_b32 a54, 0
v_accvgpr_write_b32 a55, 0
v_accvgpr_write_b32 a56, 0
v_accvgpr_write_b32 a57, 0
v_accvgpr_write_b32 a58, 0
v_accvgpr_write_b32 a59, 0
v_accvgpr_write_b32 a60, 0
v_accvgpr_write_b32 a61, 0
v_accvgpr_write_b32 a62, 0
v_accvgpr_write_b32 a63, 0
v_accvgpr_write_b32 a64, 0
v_accvgpr_write_b32 a65, 0
v_accvgpr_write_b32 a66, 0
v_accvgpr_write_b32 a67, 0
v_accvgpr_write_b32 a68, 0
v_accvgpr_write_b32 a69, 0
v_accvgpr_write_b32 a70, 0
v_accvgpr_write_b32 a71, 0
v_accvgpr_write_b32 a72, 0
v_accvgpr_write_b32 a73, 0
v_accvgpr_write_b32 a74, 0
v_accvgpr_write_b32 a75, 0
v_accvgpr_write_b32 a76, 0
v_accvgpr_write_b32 a77, 0
v_accvgpr_write_b32 a78, 0
v_accvgpr_write_b32 a79, 0
v_accvgpr_write_b32 a80, 0
v_accvgpr_write_b32 a81, 0
v_accvgpr_write_b32 a82, 0
v_accvgpr_write_b32 a83, 0
v_accvgpr_write_b32 a84, 0
v_accvgpr_write_b32 a85, 0
v_accvgpr_write_b32 a86, 0
v_accvgpr_write_b32 a87, 0
v_accvgpr_write_b32 a88, 0
v_accvgpr_write_b32 a89, 0
v_accvgpr_write_b32 a90, 0
v_accvgpr_write_b32 a91, 0
v_accvgpr_write_b32 a92, 0
v_accvgpr_write_b32 a93, 0
v_accvgpr_write_b32 a94, 0
v_accvgpr_write_b32 a95, 0
v_accvgpr_write_b32 a96, 0
v_accvgpr_write_b32 a97, 0
v_accvgpr_write_b32 a98, 0
v_accvgpr_write_b32 a99, 0
v_accvgpr_write_b32 a100, 0
v_accvgpr_write_b32 a101, 0
v_accvgpr_write_b32 a102, 0
v_accvgpr_write_b32 a103, 0
v_accvgpr_write_b32 a104, 0
v_accvgpr_write_b32 a105, 0
v_accvgpr_write_b32 a106, 0
v_accvgpr_write_b32 a107, 0
v_accvgpr_write_b32 a108, 0
v_accvgpr_write_b32 a109, 0
v_accvgpr_write_b32 a110, 0
v_accvgpr_write_b32 a111, 0
v_accvgpr_write_b32 a112, 0
v_accvgpr_write_b32 a113, 0
v_accvgpr_write_b32 a114, 0
v_accvgpr_write_b32 a115, 0
v_accvgpr_write_b32 a116, 0
v_accvgpr_write_b32 a117, 0
v_accvgpr_write_b32 a118, 0
v_accvgpr_write_b32 a119, 0
v_accvgpr_write_b32 a120, 0
v_accvgpr_write_b32 a121, 0
v_accvgpr_write_b32 a122, 0
v_accvgpr_write_b32 a123, 0
v_accvgpr_write_b32 a124, 0
v_accvgpr_write_b32 a125, 0
v_accvgpr_write_b32 a126, 0
v_accvgpr_write_b32 a127, 0
v_accvgpr_write_b32 a128, 0
v_accvgpr_write_b32 a129, 0
v_accvgpr_write_b32 a130, 0
v_accvgpr_write_b32 a131, 0
v_accvgpr_write_b32 a132, 0
v_accvgpr_write_b32 a133, 0
v_accvgpr_write_b32 a134, 0
v_accvgpr_write_b32 a135, 0
v_accvgpr_write_b32 a136, 0
v_accvgpr_write_b32 a137, 0
v_accvgpr_write_b32 a138, 0
v_accvgpr_write_b32 a139, 0
v_accvgpr_write_b32 a140, 0
v_accvgpr_write_b32 a141, 0
v_accvgpr_write_b32 a142, 0
v_accvgpr_write_b32 a143, 0
s_waitcnt vmcnt(0) lgkmcnt(0)
s_barrier
v_mov_b32 v244, 3
buffer_store_byte v244, v245, s[32:35], 0 offen sc1
buffer_load_dwordx4 v[140:143], v236, s[8:11], s62 offen offset:0 nt
buffer_load_dwordx4 v[144:147], v236, s[8:11], s62 offen offset:256 nt
buffer_load_ushort v204, v238, s[24:27], s65 offen offset:0
buffer_load_ushort v205, v238, s[28:31], s65 offen offset:0
buffer_load_dwordx2 v[172:173], v237, s[16:19], s64 offen offset:0
buffer_load_dwordx2 v[174:175], v237, s[16:19], s64 offen offset:128
buffer_load_dwordx2 v[176:177], v237, s[20:23], s64 offen offset:0
buffer_load_dwordx2 v[178:179], v237, s[20:23], s64 offen offset:128
buffer_load_dwordx4 v[148:151], v236, s[8:11], s63 offen offset:0 nt
buffer_load_dwordx4 v[152:155], v236, s[8:11], s63 offen offset:256 nt
buffer_load_ushort v206, v238, s[24:27], s65 offen offset:16
buffer_load_ushort v207, v238, s[28:31], s65 offen offset:16
buffer_load_dwordx2 v[180:181], v237, s[16:19], s64 offen offset:2048
buffer_load_dwordx2 v[182:183], v237, s[16:19], s64 offen offset:2176
buffer_load_dwordx2 v[184:185], v237, s[20:23], s64 offen offset:2048
buffer_load_dwordx2 v[186:187], v237, s[20:23], s64 offen offset:2176
buffer_load_dwordx4 v[156:159], v236, s[8:11], s62 offen offset:128 nt
buffer_load_dwordx4 v[160:163], v236, s[8:11], s62 offen offset:384 nt
buffer_load_ushort v208, v238, s[24:27], s65 offen offset:0
buffer_load_ushort v209, v238, s[28:31], s65 offen offset:0
buffer_load_dwordx2 v[188:189], v237, s[16:19], s64 offen offset:64
buffer_load_dwordx2 v[190:191], v237, s[16:19], s64 offen offset:192
buffer_load_dwordx2 v[192:193], v237, s[20:23], s64 offen offset:64
buffer_load_dwordx2 v[194:195], v237, s[20:23], s64 offen offset:192
buffer_load_dwordx4 v[164:167], v236, s[8:11], s63 offen offset:128 nt
buffer_load_dwordx4 v[168:171], v236, s[8:11], s63 offen offset:384 nt
buffer_load_ushort v210, v238, s[24:27], s65 offen offset:16
buffer_load_ushort v211, v238, s[28:31], s65 offen offset:16
buffer_load_dwordx2 v[196:197], v237, s[16:19], s64 offen offset:2112
buffer_load_dwordx2 v[198:199], v237, s[16:19], s64 offen offset:2240
buffer_load_dwordx2 v[200:201], v237, s[20:23], s64 offen offset:2112
buffer_load_dwordx2 v[202:203], v237, s[20:23], s64 offen offset:2240
s_add_u32 s62, s62, 0x4000
s_add_u32 s63, s63, 0x4000
s_add_u32 s65, s65, 64
s_add_u32 s64, s64, 0x2000
s_waitcnt vmcnt(55)
v_lshlrev_b32 v104, 16, v8
v_and_b32 v105, 0xffff0000, v8
v_lshlrev_b32 v108, 16, v12
v_and_b32 v109, 0xffff0000, v12
v_lshlrev_b32 v106, 16, v9
v_and_b32 v107, 0xffff0000, v9
v_lshlrev_b32 v110, 16, v13
v_and_b32 v111, 0xffff0000, v13
v_lshlrev_b32 v112, 16, v16
v_and_b32 v113, 0xffff0000, v16
v_lshlrev_b32 v114, 16, v17
v_and_b32 v115, 0xffff0000, v17
v_lshlrev_b32 v116, 16, v20
v_and_b32 v117, 0xffff0000, v20
v_lshlrev_b32 v118, 16, v21
v_and_b32 v119, 0xffff0000, v21
v_lshlrev_b32 v120, 16, v24
v_and_b32 v121, 0xffff0000, v24
v_lshlrev_b32 v122, 16, v25
v_and_b32 v123, 0xffff0000, v25
v_lshlrev_b32 v124, 16, v28
v_and_b32 v125, 0xffff0000, v28
v_lshlrev_b32 v126, 16, v29
v_and_b32 v127, 0xffff0000, v29
v_mul_f32 v112, v104, v112
v_mul_f32 v116, v108, v116
v_mul_f32 v113, v105, v113
v_mul_f32 v117, v109, v117
v_mul_f32 v114, v106, v114
v_mul_f32 v118, v110, v118
v_mul_f32 v115, v107, v115
v_mul_f32 v119, v111, v119
v_fma_f32 v112, -v108, v120, v112
v_fma_f32 v116, v104, v124, v116
v_fma_f32 v113, -v109, v121, v113
v_fma_f32 v117, v105, v125, v117
v_fma_f32 v114, -v110, v122, v114
v_fma_f32 v118, v106, v126, v118
v_fma_f32 v115, -v111, v123, v115
v_fma_f32 v119, v107, v127, v119
v_mul_f32 v112, 0x3e0293ee, v112
v_mul_f32 v113, 0x3e0293ee, v113
v_mul_f32 v114, 0x3e0293ee, v114
v_mul_f32 v115, 0x3e0293ee, v115
v_mul_f32 v116, 0x3e0293ee, v116
v_mul_f32 v117, 0x3e0293ee, v117
v_mul_f32 v118, 0x3e0293ee, v118
v_mul_f32 v119, 0x3e0293ee, v119
v_cvt_pk_bf16_f32 v128, v112, v113
v_cvt_pk_bf16_f32 v129, v114, v115
v_cvt_pk_bf16_f32 v130, v116, v117
v_cvt_pk_bf16_f32 v131, v118, v119
ds_write_b128 v5, v[128:131] offset:0
v_lshlrev_b32 v104, 16, v10
v_and_b32 v105, 0xffff0000, v10
v_lshlrev_b32 v108, 16, v14
v_and_b32 v109, 0xffff0000, v14
v_lshlrev_b32 v106, 16, v11
v_and_b32 v107, 0xffff0000, v11
v_lshlrev_b32 v110, 16, v15
v_and_b32 v111, 0xffff0000, v15
v_lshlrev_b32 v112, 16, v18
v_and_b32 v113, 0xffff0000, v18
v_lshlrev_b32 v114, 16, v19
v_and_b32 v115, 0xffff0000, v19
v_lshlrev_b32 v116, 16, v22
v_and_b32 v117, 0xffff0000, v22
v_lshlrev_b32 v118, 16, v23
v_and_b32 v119, 0xffff0000, v23
v_lshlrev_b32 v120, 16, v26
v_and_b32 v121, 0xffff0000, v26
v_lshlrev_b32 v122, 16, v27
v_and_b32 v123, 0xffff0000, v27
v_lshlrev_b32 v124, 16, v30
v_and_b32 v125, 0xffff0000, v30
v_lshlrev_b32 v126, 16, v31
v_and_b32 v127, 0xffff0000, v31
v_mul_f32 v112, v104, v112
v_mul_f32 v116, v108, v116
v_mul_f32 v113, v105, v113
v_mul_f32 v117, v109, v117
v_mul_f32 v114, v106, v114
v_mul_f32 v118, v110, v118
v_mul_f32 v115, v107, v115
v_mul_f32 v119, v111, v119
v_fma_f32 v112, -v108, v120, v112
v_fma_f32 v116, v104, v124, v116
v_fma_f32 v113, -v109, v121, v113
v_fma_f32 v117, v105, v125, v117
v_fma_f32 v114, -v110, v122, v114
v_fma_f32 v118, v106, v126, v118
v_fma_f32 v115, -v111, v123, v115
v_fma_f32 v119, v107, v127, v119
v_mul_f32 v112, 0x3e0293ee, v112
v_mul_f32 v113, 0x3e0293ee, v113
v_mul_f32 v114, 0x3e0293ee, v114
v_mul_f32 v115, 0x3e0293ee, v115
v_mul_f32 v116, 0x3e0293ee, v116
v_mul_f32 v117, 0x3e0293ee, v117
v_mul_f32 v118, 0x3e0293ee, v118
v_mul_f32 v119, 0x3e0293ee, v119
v_cvt_pk_bf16_f32 v132, v112, v113
v_cvt_pk_bf16_f32 v133, v114, v115
v_cvt_pk_bf16_f32 v134, v116, v117
v_cvt_pk_bf16_f32 v135, v118, v119
ds_write_b128 v5, v[132:135] offset:256
s_waitcnt vmcnt(49)
v_lshlrev_b32 v104, 16, v32
v_and_b32 v105, 0xffff0000, v32
v_lshlrev_b32 v108, 16, v36
v_and_b32 v109, 0xffff0000, v36
v_lshlrev_b32 v106, 16, v33
v_and_b32 v107, 0xffff0000, v33
v_lshlrev_b32 v110, 16, v37
v_and_b32 v111, 0xffff0000, v37
v_lshlrev_b32 v112, 16, v40
v_and_b32 v113, 0xffff0000, v40
v_lshlrev_b32 v114, 16, v41
v_and_b32 v115, 0xffff0000, v41
v_lshlrev_b32 v116, 16, v44
v_and_b32 v117, 0xffff0000, v44
v_lshlrev_b32 v118, 16, v45
v_and_b32 v119, 0xffff0000, v45
v_lshlrev_b32 v120, 16, v48
v_and_b32 v121, 0xffff0000, v48
v_lshlrev_b32 v122, 16, v49
v_and_b32 v123, 0xffff0000, v49
v_lshlrev_b32 v124, 16, v52
v_and_b32 v125, 0xffff0000, v52
v_lshlrev_b32 v126, 16, v53
v_and_b32 v127, 0xffff0000, v53
v_mul_f32 v112, v104, v112
v_mul_f32 v116, v108, v116
v_mul_f32 v113, v105, v113
v_mul_f32 v117, v109, v117
v_mul_f32 v114, v106, v114
v_mul_f32 v118, v110, v118
v_mul_f32 v115, v107, v115
v_mul_f32 v119, v111, v119
v_fma_f32 v112, -v108, v120, v112
v_fma_f32 v116, v104, v124, v116
v_fma_f32 v113, -v109, v121, v113
v_fma_f32 v117, v105, v125, v117
v_fma_f32 v114, -v110, v122, v114
v_fma_f32 v118, v106, v126, v118
v_fma_f32 v115, -v111, v123, v115
v_fma_f32 v119, v107, v127, v119
v_mul_f32 v112, 0x3e0293ee, v112
v_mul_f32 v113, 0x3e0293ee, v113
v_mul_f32 v114, 0x3e0293ee, v114
v_mul_f32 v115, 0x3e0293ee, v115
v_mul_f32 v116, 0x3e0293ee, v116
v_mul_f32 v117, 0x3e0293ee, v117
v_mul_f32 v118, 0x3e0293ee, v118
v_mul_f32 v119, 0x3e0293ee, v119
v_cvt_pk_bf16_f32 v128, v112, v113
v_cvt_pk_bf16_f32 v129, v114, v115
v_cvt_pk_bf16_f32 v130, v116, v117
v_cvt_pk_bf16_f32 v131, v118, v119
ds_write_b128 v5, v[128:131] offset:128
v_lshlrev_b32 v104, 16, v34
v_and_b32 v105, 0xffff0000, v34
v_lshlrev_b32 v108, 16, v38
v_and_b32 v109, 0xffff0000, v38
v_lshlrev_b32 v106, 16, v35
v_and_b32 v107, 0xffff0000, v35
v_lshlrev_b32 v110, 16, v39
v_and_b32 v111, 0xffff0000, v39
v_lshlrev_b32 v112, 16, v42
v_and_b32 v113, 0xffff0000, v42
v_lshlrev_b32 v114, 16, v43
v_and_b32 v115, 0xffff0000, v43
v_lshlrev_b32 v116, 16, v46
v_and_b32 v117, 0xffff0000, v46
v_lshlrev_b32 v118, 16, v47
v_and_b32 v119, 0xffff0000, v47
v_lshlrev_b32 v120, 16, v50
v_and_b32 v121, 0xffff0000, v50
v_lshlrev_b32 v122, 16, v51
v_and_b32 v123, 0xffff0000, v51
v_lshlrev_b32 v124, 16, v54
v_and_b32 v125, 0xffff0000, v54
v_lshlrev_b32 v126, 16, v55
v_and_b32 v127, 0xffff0000, v55
v_mul_f32 v112, v104, v112
v_mul_f32 v116, v108, v116
v_mul_f32 v113, v105, v113
v_mul_f32 v117, v109, v117
v_mul_f32 v114, v106, v114
v_mul_f32 v118, v110, v118
v_mul_f32 v115, v107, v115
v_mul_f32 v119, v111, v119
v_fma_f32 v112, -v108, v120, v112
v_fma_f32 v116, v104, v124, v116
v_fma_f32 v113, -v109, v121, v113
v_fma_f32 v117, v105, v125, v117
v_fma_f32 v114, -v110, v122, v114
v_fma_f32 v118, v106, v126, v118
v_fma_f32 v115, -v111, v123, v115
v_fma_f32 v119, v107, v127, v119
v_mul_f32 v112, 0x3e0293ee, v112
v_mul_f32 v113, 0x3e0293ee, v113
v_mul_f32 v114, 0x3e0293ee, v114
v_mul_f32 v115, 0x3e0293ee, v115
v_mul_f32 v116, 0x3e0293ee, v116
v_mul_f32 v117, 0x3e0293ee, v117
v_mul_f32 v118, 0x3e0293ee, v118
v_mul_f32 v119, 0x3e0293ee, v119
v_cvt_pk_bf16_f32 v132, v112, v113
v_cvt_pk_bf16_f32 v133, v114, v115
v_cvt_pk_bf16_f32 v134, v116, v117
v_cvt_pk_bf16_f32 v135, v118, v119
ds_write_b128 v5, v[132:135] offset:384
s_waitcnt vmcnt(43)
v_lshlrev_b32 v104, 16, v56
v_and_b32 v105, 0xffff0000, v56
v_lshlrev_b32 v108, 16, v60
v_and_b32 v109, 0xffff0000, v60
v_lshlrev_b32 v106, 16, v57
v_and_b32 v107, 0xffff0000, v57
v_lshlrev_b32 v110, 16, v61
v_and_b32 v111, 0xffff0000, v61
v_lshlrev_b32 v112, 16, v64
v_and_b32 v113, 0xffff0000, v64
v_lshlrev_b32 v114, 16, v65
v_and_b32 v115, 0xffff0000, v65
v_lshlrev_b32 v116, 16, v68
v_and_b32 v117, 0xffff0000, v68
v_lshlrev_b32 v118, 16, v69
v_and_b32 v119, 0xffff0000, v69
v_lshlrev_b32 v120, 16, v72
v_and_b32 v121, 0xffff0000, v72
v_lshlrev_b32 v122, 16, v73
v_and_b32 v123, 0xffff0000, v73
v_lshlrev_b32 v124, 16, v76
v_and_b32 v125, 0xffff0000, v76
v_lshlrev_b32 v126, 16, v77
v_and_b32 v127, 0xffff0000, v77
v_mul_f32 v112, v104, v112
v_mul_f32 v116, v108, v116
v_mul_f32 v113, v105, v113
v_mul_f32 v117, v109, v117
v_mul_f32 v114, v106, v114
v_mul_f32 v118, v110, v118
v_mul_f32 v115, v107, v115
v_mul_f32 v119, v111, v119
v_fma_f32 v112, -v108, v120, v112
v_fma_f32 v116, v104, v124, v116
v_fma_f32 v113, -v109, v121, v113
v_fma_f32 v117, v105, v125, v117
v_fma_f32 v114, -v110, v122, v114
v_fma_f32 v118, v106, v126, v118
v_fma_f32 v115, -v111, v123, v115
v_fma_f32 v119, v107, v127, v119
v_mul_f32 v112, 0x3e0293ee, v112
v_mul_f32 v113, 0x3e0293ee, v113
v_mul_f32 v114, 0x3e0293ee, v114
v_mul_f32 v115, 0x3e0293ee, v115
v_mul_f32 v116, 0x3e0293ee, v116
v_mul_f32 v117, 0x3e0293ee, v117
v_mul_f32 v118, 0x3e0293ee, v118
v_mul_f32 v119, 0x3e0293ee, v119
v_cvt_pk_bf16_f32 v128, v112, v113
v_cvt_pk_bf16_f32 v129, v114, v115
v_cvt_pk_bf16_f32 v130, v116, v117
v_cvt_pk_bf16_f32 v131, v118, v119
ds_write_b128 v5, v[128:131] offset:4096
v_lshlrev_b32 v104, 16, v58
v_and_b32 v105, 0xffff0000, v58
v_lshlrev_b32 v108, 16, v62
v_and_b32 v109, 0xffff0000, v62
v_lshlrev_b32 v106, 16, v59
v_and_b32 v107, 0xffff0000, v59
v_lshlrev_b32 v110, 16, v63
v_and_b32 v111, 0xffff0000, v63
v_lshlrev_b32 v112, 16, v66
v_and_b32 v113, 0xffff0000, v66
v_lshlrev_b32 v114, 16, v67
v_and_b32 v115, 0xffff0000, v67
v_lshlrev_b32 v116, 16, v70
v_and_b32 v117, 0xffff0000, v70
v_lshlrev_b32 v118, 16, v71
v_and_b32 v119, 0xffff0000, v71
v_lshlrev_b32 v120, 16, v74
v_and_b32 v121, 0xffff0000, v74
v_lshlrev_b32 v122, 16, v75
v_and_b32 v123, 0xffff0000, v75
v_lshlrev_b32 v124, 16, v78
v_and_b32 v125, 0xffff0000, v78
v_lshlrev_b32 v126, 16, v79
v_and_b32 v127, 0xffff0000, v79
v_mul_f32 v112, v104, v112
v_mul_f32 v116, v108, v116
v_mul_f32 v113, v105, v113
v_mul_f32 v117, v109, v117
v_mul_f32 v114, v106, v114
v_mul_f32 v118, v110, v118
v_mul_f32 v115, v107, v115
v_mul_f32 v119, v111, v119
v_fma_f32 v112, -v108, v120, v112
v_fma_f32 v116, v104, v124, v116
v_fma_f32 v113, -v109, v121, v113
v_fma_f32 v117, v105, v125, v117
v_fma_f32 v114, -v110, v122, v114
v_fma_f32 v118, v106, v126, v118
v_fma_f32 v115, -v111, v123, v115
v_fma_f32 v119, v107, v127, v119
v_mul_f32 v112, 0x3e0293ee, v112
v_mul_f32 v113, 0x3e0293ee, v113
v_mul_f32 v114, 0x3e0293ee, v114
v_mul_f32 v115, 0x3e0293ee, v115
v_mul_f32 v116, 0x3e0293ee, v116
v_mul_f32 v117, 0x3e0293ee, v117
v_mul_f32 v118, 0x3e0293ee, v118
v_mul_f32 v119, 0x3e0293ee, v119
v_cvt_pk_bf16_f32 v132, v112, v113
v_cvt_pk_bf16_f32 v133, v114, v115
v_cvt_pk_bf16_f32 v134, v116, v117
v_cvt_pk_bf16_f32 v135, v118, v119
ds_write_b128 v5, v[132:135] offset:4352
s_waitcnt vmcnt(37)
v_lshlrev_b32 v104, 16, v80
v_and_b32 v105, 0xffff0000, v80
v_lshlrev_b32 v108, 16, v84
v_and_b32 v109, 0xffff0000, v84
v_lshlrev_b32 v106, 16, v81
v_and_b32 v107, 0xffff0000, v81
v_lshlrev_b32 v110, 16, v85
v_and_b32 v111, 0xffff0000, v85
v_lshlrev_b32 v112, 16, v88
v_and_b32 v113, 0xffff0000, v88
v_lshlrev_b32 v114, 16, v89
v_and_b32 v115, 0xffff0000, v89
v_lshlrev_b32 v116, 16, v92
v_and_b32 v117, 0xffff0000, v92
v_lshlrev_b32 v118, 16, v93
v_and_b32 v119, 0xffff0000, v93
v_lshlrev_b32 v120, 16, v96
v_and_b32 v121, 0xffff0000, v96
v_lshlrev_b32 v122, 16, v97
v_and_b32 v123, 0xffff0000, v97
v_lshlrev_b32 v124, 16, v100
v_and_b32 v125, 0xffff0000, v100
v_lshlrev_b32 v126, 16, v101
v_and_b32 v127, 0xffff0000, v101
v_mul_f32 v112, v104, v112
v_mul_f32 v116, v108, v116
v_mul_f32 v113, v105, v113
v_mul_f32 v117, v109, v117
v_mul_f32 v114, v106, v114
v_mul_f32 v118, v110, v118
v_mul_f32 v115, v107, v115
v_mul_f32 v119, v111, v119
v_fma_f32 v112, -v108, v120, v112
v_fma_f32 v116, v104, v124, v116
v_fma_f32 v113, -v109, v121, v113
v_fma_f32 v117, v105, v125, v117
v_fma_f32 v114, -v110, v122, v114
v_fma_f32 v118, v106, v126, v118
v_fma_f32 v115, -v111, v123, v115
v_fma_f32 v119, v107, v127, v119
v_mul_f32 v112, 0x3e0293ee, v112
v_mul_f32 v113, 0x3e0293ee, v113
v_mul_f32 v114, 0x3e0293ee, v114
v_mul_f32 v115, 0x3e0293ee, v115
v_mul_f32 v116, 0x3e0293ee, v116
v_mul_f32 v117, 0x3e0293ee, v117
v_mul_f32 v118, 0x3e0293ee, v118
v_mul_f32 v119, 0x3e0293ee, v119
v_cvt_pk_bf16_f32 v128, v112, v113
v_cvt_pk_bf16_f32 v129, v114, v115
v_cvt_pk_bf16_f32 v130, v116, v117
v_cvt_pk_bf16_f32 v131, v118, v119
ds_write_b128 v5, v[128:131] offset:4224
v_lshlrev_b32 v104, 16, v82
v_and_b32 v105, 0xffff0000, v82
v_lshlrev_b32 v108, 16, v86
v_and_b32 v109, 0xffff0000, v86
v_lshlrev_b32 v106, 16, v83
v_and_b32 v107, 0xffff0000, v83
v_lshlrev_b32 v110, 16, v87
v_and_b32 v111, 0xffff0000, v87
v_lshlrev_b32 v112, 16, v90
v_and_b32 v113, 0xffff0000, v90
v_lshlrev_b32 v114, 16, v91
v_and_b32 v115, 0xffff0000, v91
v_lshlrev_b32 v116, 16, v94
v_and_b32 v117, 0xffff0000, v94
v_lshlrev_b32 v118, 16, v95
v_and_b32 v119, 0xffff0000, v95
v_lshlrev_b32 v120, 16, v98
v_and_b32 v121, 0xffff0000, v98
v_lshlrev_b32 v122, 16, v99
v_and_b32 v123, 0xffff0000, v99
v_lshlrev_b32 v124, 16, v102
v_and_b32 v125, 0xffff0000, v102
v_lshlrev_b32 v126, 16, v103
v_and_b32 v127, 0xffff0000, v103
v_mul_f32 v112, v104, v112
v_mul_f32 v116, v108, v116
v_mul_f32 v113, v105, v113
v_mul_f32 v117, v109, v117
v_mul_f32 v114, v106, v114
v_mul_f32 v118, v110, v118
v_mul_f32 v115, v107, v115
v_mul_f32 v119, v111, v119
v_fma_f32 v112, -v108, v120, v112
v_fma_f32 v116, v104, v124, v116
v_fma_f32 v113, -v109, v121, v113
v_fma_f32 v117, v105, v125, v117
v_fma_f32 v114, -v110, v122, v114
v_fma_f32 v118, v106, v126, v118
v_fma_f32 v115, -v111, v123, v115
v_fma_f32 v119, v107, v127, v119
v_mul_f32 v112, 0x3e0293ee, v112
v_mul_f32 v113, 0x3e0293ee, v113
v_mul_f32 v114, 0x3e0293ee, v114
v_mul_f32 v115, 0x3e0293ee, v115
v_mul_f32 v116, 0x3e0293ee, v116
v_mul_f32 v117, 0x3e0293ee, v117
v_mul_f32 v118, 0x3e0293ee, v118
v_mul_f32 v119, 0x3e0293ee, v119
v_cvt_pk_bf16_f32 v132, v112, v113
v_cvt_pk_bf16_f32 v133, v114, v115
v_cvt_pk_bf16_f32 v134, v116, v117
v_cvt_pk_bf16_f32 v135, v118, v119
ds_write_b128 v5, v[132:135] offset:4480
s_waitcnt lgkmcnt(0)
s_barrier
s_lshl_b32 s72, s53, 14
s_add_u32 s72, s72, 0x20000
s_lshl_b32 s73, s54, 13
s_add_u32 s44, s72, s73
s_xor_b32 s73, s73, 0x2000
s_add_u32 s45, s72, s73
v_add_u32 v4, s44, v1
v_add_u32 v5, s45, v1
ds_read_b128 a[144:147], v4 offset:0
ds_read_b128 a[148:151], v4 offset:1024
ds_read_b128 a[152:155], v4 offset:2048
ds_read_b128 a[156:159], v4 offset:3072
ds_read_b128 a[160:163], v4 offset:4096
ds_read_b128 a[164:167], v4 offset:5120
ds_read_b128 a[168:171], v4 offset:6144
ds_read_b128 a[172:175], v4 offset:7168
ds_read_b128 a[176:179], v5 offset:0
ds_read_b128 a[180:183], v5 offset:1024
ds_read_b128 a[184:187], v5 offset:2048
ds_read_b128 a[188:191], v5 offset:3072
ds_read_b128 a[192:195], v5 offset:4096
ds_read_b128 a[196:199], v5 offset:5120
ds_read_b128 a[200:203], v5 offset:6144
ds_read_b128 a[204:207], v5 offset:7168
v_mov_b32 v120, 0
v_mov_b32 v121, 0
v_mov_b32 v122, 0
v_mov_b32 v123, 0
v_mov_b32 v124, 0
v_mov_b32 v125, 0
v_mov_b32 v126, 0
v_mov_b32 v127, 0
v_mov_b32 v128, 0
v_mov_b32 v129, 0
v_mov_b32 v130, 0
v_mov_b32 v131, 0
v_mov_b32 v132, 0
v_mov_b32 v133, 0
v_mov_b32 v134, 0
v_mov_b32 v135, 0
s_lshl_b32 s72, s53, 12
v_add_u32 v4, s72, v3
ds_write_b128 v4, v[120:123] offset:24576
ds_write_b128 v4, v[120:123] offset:25600
ds_write_b128 v4, v[120:123] offset:26624
ds_write_b128 v4, v[120:123] offset:27648
s_cmp_eq_u32 s52, 3
s_cselect_b32 s70, s70, 0x7f000000
s_cselect_b32 s68, 0x03030303, 0
L_back_pK:
s_and_b32 s68, s68, 0x02020202
s_barrier
s_mov_b32 m0, s59
s_nop 0
buffer_load_dwordx4 v1, s[4:7], s57 offen offset:0 sc1 lds
buffer_load_dwordx4 v1, s[4:7], s57 offen offset:1024 sc1 lds
buffer_load_dwordx4 v1, s[4:7], s57 offen offset:2048 sc1 lds
buffer_load_dwordx4 v1, s[4:7], s57 offen offset:3072 sc1 lds
s_add_u32 s57, s57, 0x4000
s_add_u32 m0, s59, 8192
s_nop 0
buffer_load_dwordx4 v1, s[4:7], s57 offen offset:0 sc1 lds
buffer_load_dwordx4 v1, s[4:7], s57 offen offset:1024 sc1 lds
buffer_load_dwordx4 v1, s[4:7], s57 offen offset:2048 sc1 lds
buffer_load_dwordx4 v1, s[4:7], s57 offen offset:3072 sc1 lds
s_add_u32 m0, s60, 0
s_nop 0
buffer_load_dwordx4 v1, s[4:7], s58 offen offset:0 sc1 lds
buffer_load_dwordx4 v1, s[4:7], s58 offen offset:1024 sc1 lds
buffer_load_dwordx4 v1, s[4:7], s58 offen offset:2048 sc1 lds
buffer_load_dwordx4 v1, s[4:7], s58 offen offset:3072 sc1 lds
s_add_u32 s58, s58, 0x4000
s_add_u32 s57, s57, 0x4000
s_add_u32 m0, s59, 16384
s_nop 0
buffer_load_dwordx4 v1, s[4:7], s57 offen offset:0 sc1 lds
buffer_load_dwordx4 v1, s[4:7], s57 offen offset:1024 sc1 lds
buffer_load_dwordx4 v1, s[4:7], s57 offen offset:2048 sc1 lds
buffer_load_dwordx4 v1, s[4:7], s57 offen offset:3072 sc1 lds
s_add_u32 m0, s60, 8192
s_nop 0
buffer_load_dwordx4 v1, s[4:7], s58 offen offset:0 sc1 lds
buffer_load_dwordx4 v1, s[4:7], s58 offen offset:1024 sc1 lds
buffer_load_dwordx4 v1, s[4:7], s58 offen offset:2048 sc1 lds
buffer_load_dwordx4 v1, s[4:7], s58 offen offset:3072 sc1 lds
s_add_u32 s58, s58, 0x4000
s_add_u32 s57, s57, 0x4000
s_add_u32 m0, s59, 24576
s_nop 0
buffer_load_dwordx4 v1, s[4:7], s57 offen offset:0 sc1 lds
buffer_load_dwordx4 v1, s[4:7], s57 offen offset:1024 sc1 lds
buffer_load_dwordx4 v1, s[4:7], s57 offen offset:2048 sc1 lds
buffer_load_dwordx4 v1, s[4:7], s57 offen offset:3072 sc1 lds
s_add_u32 m0, s60, 16384
s_nop 0
buffer_load_dwordx4 v1, s[4:7], s58 offen offset:0 sc1 lds
buffer_load_dwordx4 v1, s[4:7], s58 offen offset:1024 sc1 lds
buffer_load_dwordx4 v1, s[4:7], s58 offen offset:2048 sc1 lds
buffer_load_dwordx4 v1, s[4:7], s58 offen offset:3072 sc1 lds
s_add_u32 s58, s58, 0x4000
s_add_u32 s57, s57, 0x4000
s_waitcnt vmcnt(24) lgkmcnt(0)
s_barrier
ds_read_b128 v[8:11], v2 offset:0
ds_read_b128 v[12:15], v2 offset:1024
ds_read_b128 v[16:19], v2 offset:2048
ds_read_b128 v[20:23], v2 offset:3072
ds_read_b128 v[24:27], v2 offset:4096
ds_read_b128 v[28:31], v2 offset:5120
ds_read_b128 v[32:35], v2 offset:6144
ds_read_b128 v[36:39], v2 offset:7168
s_mov_b32 s61, 0
s_mov_b32 s69, 3
s_mov_b32 s71, 0
.p2align 6
L_prepK:
s_waitcnt lgkmcnt(0)
v_mfma_f32_16x16x32_bf16 v[72:75], v[8:11], a[144:147], 0
ds_read_b128 v[40:43], v3 offset:24576
s_waitcnt vmcnt(52)
v_mfma_f32_16x16x32_bf16 v[72:75], v[12:15], a[148:151], v[72:75]
v_lshlrev_b32 v204, 16, v204
v_lshlrev_b32 v205, 16, v205
v_mfma_f32_16x16x32_bf16 v[72:75], v[16:19], a[152:155], v[72:75]
v_cvt_f32_i32 v140, v140
v_cvt_f32_i32 v141, v141
v_mfma_f32_16x16x32_bf16 v[72:75], v[20:23], a[156:159], v[72:75]
ds_read_b128 v[44:47], v3 offset:25600
v_cvt_f32_i32 v142, v142
v_mfma_f32_16x16x32_bf16 v[76:79], v[24:27], a[144:147], 0
v_cvt_f32_i32 v143, v143
v_mul_f32 v205, v205, v204
v_mfma_f32_16x16x32_bf16 v[76:79], v[28:31], a[148:151], v[76:79]
v_cvt_f32_i32 v144, v144
v_cvt_f32_i32 v145, v145
v_mfma_f32_16x16x32_bf16 v[76:79], v[32:35], a[152:155], v[76:79]
ds_read_b128 v[48:51], v3 offset:26624
v_cvt_f32_i32 v146, v146
v_mfma_f32_16x16x32_bf16 v[76:79], v[36:39], a[156:159], v[76:79]
v_cvt_f32_i32 v147, v147
v_fma_f32 v140, v140, v204, -v205
v_mfma_f32_16x16x32_bf16 v[80:83], v[8:11], a[160:163], 0
v_fma_f32 v141, v141, v204, -v205
v_fma_f32 v142, v142, v204, -v205
v_mfma_f32_16x16x32_bf16 v[80:83], v[12:15], a[164:167], v[80:83]
ds_read_b128 v[52:55], v3 offset:27648
v_fma_f32 v143, v143, v204, -v205
v_mfma_f32_16x16x32_bf16 v[80:83], v[16:19], a[168:171], v[80:83]
v_exp_f32 v72, v72
v_mfma_f32_16x16x32_bf16 v[80:83], v[20:23], a[172:175], v[80:83]
v_exp_f32 v73, v73
v_mfma_f32_16x16x32_bf16 v[84:87], v[24:27], a[160:163], 0
ds_read_b128 v[56:59], v3 offset:28672
v_cvt_pk_bf16_f32 v104, v72, v73
v_mfma_f32_16x16x32_bf16 v[84:87], v[28:31], a[164:167], v[84:87]
v_exp_f32 v74, v74
v_mfma_f32_16x16x32_bf16 v[84:87], v[32:35], a[168:171], v[84:87]
v_exp_f32 v75, v75
v_mfma_f32_16x16x32_bf16 v[84:87], v[36:39], a[172:175], v[84:87]
ds_read_b128 v[60:63], v3 offset:29696
v_cvt_pk_bf16_f32 v105, v74, v75
v_mfma_f32_16x16x32_bf16 v[88:91], v[8:11], a[176:179], 0
v_exp_f32 v76, v76
v_mfma_f32_16x16x32_bf16 v[88:91], v[12:15], a[180:183], v[88:91]
v_exp_f32 v77, v77
v_mfma_f32_16x16x32_bf16 v[88:91], v[16:19], a[184:187], v[88:91]
ds_read_b128 v[64:67], v3 offset:30720
v_cvt_pk_bf16_f32 v106, v76, v77
v_mfma_f32_16x16x32_bf16 v[88:91], v[20:23], a[188:191], v[88:91]
v_exp_f32 v78, v78
v_mfma_f32_16x16x32_bf16 v[92:95], v[24:27], a[176:179], 0
v_exp_f32 v79, v79
v_fma_f32 v144, v144, v204, -v205
v_mfma_f32_16x16x32_bf16 v[92:95], v[28:31], a[180:183], v[92:95]
ds_read_b128 v[68:71], v3 offset:31744
v_cvt_pk_bf16_f32 v107, v78, v79
v_mfma_f32_16x16x32_bf16 v[92:95], v[32:35], a[184:187], v[92:95]
v_exp_f32 v80, v80
v_fma_f32 v145, v145, v204, -v205
v_mfma_f32_16x16x32_bf16 v[92:95], v[36:39], a[188:191], v[92:95]
v_exp_f32 v81, v81
v_fma_f32 v146, v146, v204, -v205
v_mfma_f32_16x16x32_bf16 v[96:99], v[8:11], a[192:195], 0
v_exp_f32 v82, v82
v_fma_f32 v147, v147, v204, -v205
v_mfma_f32_16x16x32_bf16 v[96:99], v[12:15], a[196:199], v[96:99]
v_exp_f32 v83, v83
v_mfma_f32_16x16x32_bf16 v[96:99], v[16:19], a[200:203], v[96:99]
v_cvt_pk_bf16_f32 v108, v80, v81
v_cvt_pk_bf16_f32 v109, v82, v83
v_lshlrev_b32 v212, 16, v172
v_mfma_f32_16x16x32_bf16 v[96:99], v[20:23], a[204:207], v[96:99]
v_exp_f32 v84, v84
v_and_b32 v213, 0xffff0000, v172
v_mfma_f32_16x16x32_bf16 v[100:103], v[24:27], a[192:195], 0
v_exp_f32 v85, v85
v_lshlrev_b32 v214, 16, v173
v_mfma_f32_16x16x32_bf16 v[100:103], v[28:31], a[196:199], v[100:103]
v_exp_f32 v86, v86
v_mfma_f32_16x16x32_bf16 v[100:103], v[32:35], a[200:203], v[100:103]
v_exp_f32 v87, v87
v_and_b32 v215, 0xffff0000, v173
v_mfma_f32_16x16x32_bf16 v[100:103], v[36:39], a[204:207], v[100:103]
v_cvt_pk_bf16_f32 v110, v84, v85
v_cvt_pk_bf16_f32 v111, v86, v87
v_lshlrev_b32 v216, 16, v174
s_waitcnt vmcnt(16) lgkmcnt(0)
s_barrier
v_mfma_f32_16x16x32_bf16 a[0:3], v[40:43], v[120:123], a[0:3]
ds_read_b128 v[8:11], v2 offset:8192
v_and_b32 v217, 0xffff0000, v174
v_mfma_f32_16x16x32_bf16 a[32:35], v[40:43], v[124:127], a[32:35]
s_add_u32 m0, s59, 0
v_lshlrev_b32 v218, 16, v175
v_mfma_f32_16x16x32_bf16 a[64:67], v[40:43], v[128:131], a[64:67]
buffer_load_dwordx4 v1, s[4:7], s57 offen offset:0 sc1 lds
v_and_b32 v219, 0xffff0000, v175
v_mfma_f32_16x16x32_bf16 a[96:99], v[40:43], v[132:135], a[96:99]
ds_read_b128 v[12:15], v2 offset:9216
v_lshlrev_b32 v220, 16, v176
v_mfma_f32_16x16x32_bf16 a[4:7], v[44:47], v[120:123], a[4:7]
v_mov_b32 v244, s69
v_and_b32 v221, 0xffff0000, v176
v_mfma_f32_16x16x32_bf16 a[36:39], v[44:47], v[124:127], a[36:39]
buffer_store_byte v244, v245, s[32:35], 0 offen sc1
v_lshlrev_b32 v222, 16, v177
v_mfma_f32_16x16x32_bf16 a[68:71], v[44:47], v[128:131], a[68:71]
ds_read_b128 v[16:19], v2 offset:10240
buffer_load_dwordx4 v1, s[4:7], s57 offen offset:1024 sc1 lds
v_exp_f32 v88, v88
v_mfma_f32_16x16x32_bf16 a[100:103], v[44:47], v[132:135], a[100:103]
v_exp_f32 v89, v89
v_mfma_f32_16x16x32_bf16 a[8:11], v[48:51], v[120:123], a[8:11]
v_exp_f32 v90, v90
v_and_b32 v223, 0xffff0000, v177
v_mfma_f32_16x16x32_bf16 a[40:43], v[48:51], v[124:127], a[40:43]
ds_read_b128 v[20:23], v2 offset:11264
v_cvt_pk_bf16_f32 v112, v88, v89
v_lshlrev_b32 v224, 16, v178
v_mfma_f32_16x16x32_bf16 a[72:75], v[48:51], v[128:131], a[72:75]
buffer_load_dwordx4 v1, s[4:7], s57 offen offset:2048 sc1 lds
v_and_b32 v225, 0xffff0000, v178
v_exp_f32 v91, v91
v_mfma_f32_16x16x32_bf16 a[104:107], v[48:51], v[132:135], a[104:107]
v_exp_f32 v92, v92
v_mfma_f32_16x16x32_bf16 a[12:15], v[52:55], v[120:123], a[12:15]
ds_read_b128 v[24:27], v2 offset:12288
v_cvt_pk_bf16_f32 v113, v90, v91
v_lshlrev_b32 v226, 16, v179
v_mfma_f32_16x16x32_bf16 a[44:47], v[52:55], v[124:127], a[44:47]
v_exp_f32 v93, v93
v_and_b32 v227, 0xffff0000, v179
v_mfma_f32_16x16x32_bf16 a[76:79], v[52:55], v[128:131], a[76:79]
buffer_load_dwordx4 v1, s[4:7], s57 offen offset:3072 sc1 lds
v_cvt_pk_bf16_f32 v114, v92, v93
v_mfma_f32_16x16x32_bf16 a[108:111], v[52:55], v[132:135], a[108:111]
ds_read_b128 v[28:31], v2 offset:13312
s_add_u32 s57, s57, 0x4000
v_exp_f32 v94, v94
v_mul_f32 v212, v140, v212
v_mfma_f32_16x16x32_bf16 a[16:19], v[56:59], v[120:123], a[16:19]
v_exp_f32 v95, v95
v_mul_f32 v216, v144, v216
v_mfma_f32_16x16x32_bf16 a[48:51], v[56:59], v[124:127], a[48:51]
s_add_u32 m0, s60, 24576
v_cvt_pk_bf16_f32 v115, v94, v95
v_mul_f32 v213, v141, v213
v_mfma_f32_16x16x32_bf16 a[80:83], v[56:59], v[128:131], a[80:83]
ds_read_b128 v[32:35], v2 offset:14336
buffer_load_dwordx4 v1, s[4:7], s58 offen offset:0 sc1 lds
v_exp_f32 v96, v96
v_mfma_f32_16x16x32_bf16 a[112:115], v[56:59], v[132:135], a[112:115]
v_exp_f32 v97, v97
v_mul_f32 v217, v145, v217
v_mfma_f32_16x16x32_bf16 a[20:23], v[60:63], v[120:123], a[20:23]
v_exp_f32 v98, v98
v_mul_f32 v214, v142, v214
v_mfma_f32_16x16x32_bf16 a[52:55], v[60:63], v[124:127], a[52:55]
ds_read_b128 v[36:39], v2 offset:15360
v_cvt_pk_bf16_f32 v116, v96, v97
v_mul_f32 v218, v146, v218
v_mfma_f32_16x16x32_bf16 a[84:87], v[60:63], v[128:131], a[84:87]
buffer_load_dwordx4 v1, s[4:7], s58 offen offset:1024 sc1 lds
v_mul_f32 v215, v143, v215
v_exp_f32 v99, v99
v_mfma_f32_16x16x32_bf16 a[116:119], v[60:63], v[132:135], a[116:119]
v_exp_f32 v100, v100
v_mfma_f32_16x16x32_bf16 a[24:27], v[64:67], v[120:123], a[24:27]
v_exp_f32 v101, v101
v_mul_f32 v219, v147, v219
v_mfma_f32_16x16x32_bf16 a[56:59], v[64:67], v[124:127], a[56:59]
v_cvt_pk_bf16_f32 v117, v98, v99
v_cvt_pk_bf16_f32 v118, v100, v101
v_fma_f32 v212, -v144, v220, v212
v_mfma_f32_16x16x32_bf16 a[88:91], v[64:67], v[128:131], a[88:91]
buffer_load_dwordx4 v1, s[4:7], s58 offen offset:2048 sc1 lds
v_fma_f32 v216, v140, v224, v216
v_mfma_f32_16x16x32_bf16 a[120:123], v[64:67], v[132:135], a[120:123]
v_exp_f32 v102, v102
v_mfma_f32_16x16x32_bf16 a[28:31], v[68:71], v[120:123], a[28:31]
v_exp_f32 v103, v103
v_fma_f32 v213, -v145, v221, v213
v_mfma_f32_16x16x32_bf16 a[60:63], v[68:71], v[124:127], a[60:63]
v_cvt_pk_bf16_f32 v119, v102, v103
v_fma_f32 v217, v141, v225, v217
v_mfma_f32_16x16x32_bf16 a[92:95], v[68:71], v[128:131], a[92:95]
buffer_load_dwordx4 v1, s[4:7], s58 offen offset:3072 sc1 lds
v_fma_f32 v214, -v146, v222, v214
v_mfma_f32_16x16x32_bf16 a[124:127], v[68:71], v[132:135], a[124:127]
s_add_u32 s58, s58, 0x4000
v_fma_f32 v218, v142, v226, v218
v_mfma_f32_16x16x32_bf16 a[128:131], v[136:139], v[120:123], a[128:131]
v_fma_f32 v215, -v147, v223, v215
v_fma_f32 v219, v143, v227, v219
v_mfma_f32_16x16x32_bf16 a[132:135], v[136:139], v[124:127], a[132:135]
v_mfma_f32_16x16x32_bf16 a[136:139], v[136:139], v[128:131], a[136:139]
v_mfma_f32_16x16x32_bf16 a[140:143], v[136:139], v[132:135], a[140:143]
s_waitcnt lgkmcnt(0)
v_mfma_f32_16x16x32_bf16 v[72:75], v[8:11], a[144:147], 0
ds_read_b128 v[40:43], v3 offset:0
v_cvt_pk_bf16_f32 v228, v212, v213
v_mfma_f32_16x16x32_bf16 v[72:75], v[12:15], a[148:151], v[72:75]
v_cvt_pk_bf16_f32 v229, v214, v215
v_cvt_pk_bf16_f32 v230, v216, v217
v_mfma_f32_16x16x32_bf16 v[72:75], v[16:19], a[152:155], v[72:75]
v_cvt_pk_bf16_f32 v231, v218, v219
s_waitcnt vmcnt(49)
v_mfma_f32_16x16x32_bf16 v[72:75], v[20:23], a[156:159], v[72:75]
ds_read_b128 v[44:47], v3 offset:1024
v_lshlrev_b32 v206, 16, v206
v_mfma_f32_16x16x32_bf16 v[76:79], v[24:27], a[144:147], 0
v_lshlrev_b32 v207, 16, v207
v_cvt_f32_i32 v148, v148
v_mfma_f32_16x16x32_bf16 v[76:79], v[28:31], a[148:151], v[76:79]
v_cvt_f32_i32 v149, v149
v_cvt_f32_i32 v150, v150
v_mfma_f32_16x16x32_bf16 v[76:79], v[32:35], a[152:155], v[76:79]
ds_read_b128 v[48:51], v3 offset:2048
v_cvt_f32_i32 v151, v151
v_mfma_f32_16x16x32_bf16 v[76:79], v[36:39], a[156:159], v[76:79]
v_mul_f32 v207, v207, v206
v_cvt_f32_i32 v152, v152
v_mfma_f32_16x16x32_bf16 v[80:83], v[8:11], a[160:163], 0
v_cvt_f32_i32 v153, v153
v_cvt_f32_i32 v154, v154
v_mfma_f32_16x16x32_bf16 v[80:83], v[12:15], a[164:167], v[80:83]
ds_read_b128 v[52:55], v3 offset:3072
v_cvt_f32_i32 v155, v155
v_mfma_f32_16x16x32_bf16 v[80:83], v[16:19], a[168:171], v[80:83]
v_exp_f32 v72, v72
v_mfma_f32_16x16x32_bf16 v[80:83], v[20:23], a[172:175], v[80:83]
v_exp_f32 v73, v73
v_mfma_f32_16x16x32_bf16 v[84:87], v[24:27], a[160:163], 0
ds_read_b128 v[56:59], v3 offset:4096
v_cvt_pk_bf16_f32 v120, v72, v73
v_mfma_f32_16x16x32_bf16 v[84:87], v[28:31], a[164:167], v[84:87]
v_exp_f32 v74, v74
v_mfma_f32_16x16x32_bf16 v[84:87], v[32:35], a[168:171], v[84:87]
v_exp_f32 v75, v75
v_mfma_f32_16x16x32_bf16 v[84:87], v[36:39], a[172:175], v[84:87]
ds_read_b128 v[60:63], v3 offset:5120
v_cvt_pk_bf16_f32 v121, v74, v75
v_mfma_f32_16x16x32_bf16 v[88:91], v[8:11], a[176:179], 0
v_exp_f32 v76, v76
v_mfma_f32_16x16x32_bf16 v[88:91], v[12:15], a[180:183], v[88:91]
v_exp_f32 v77, v77
v_mfma_f32_16x16x32_bf16 v[88:91], v[16:19], a[184:187], v[88:91]
ds_read_b128 v[64:67], v3 offset:6144
v_cvt_pk_bf16_f32 v122, v76, v77
v_mfma_f32_16x16x32_bf16 v[88:91], v[20:23], a[188:191], v[88:91]
v_exp_f32 v78, v78
v_mfma_f32_16x16x32_bf16 v[92:95], v[24:27], a[176:179], 0
v_exp_f32 v79, v79
v_mfma_f32_16x16x32_bf16 v[92:95], v[28:31], a[180:183], v[92:95]
ds_read_b128 v[68:71], v3 offset:7168
v_cvt_pk_bf16_f32 v123, v78, v79
v_mfma_f32_16x16x32_bf16 v[92:95], v[32:35], a[184:187], v[92:95]
v_exp_f32 v80, v80
v_mfma_f32_16x16x32_bf16 v[92:95], v[36:39], a[188:191], v[92:95]
v_exp_f32 v81, v81
v_mfma_f32_16x16x32_bf16 v[96:99], v[8:11], a[192:195], 0
v_exp_f32 v82, v82
v_mfma_f32_16x16x32_bf16 v[96:99], v[12:15], a[196:199], v[96:99]
v_exp_f32 v83, v83
v_fma_f32 v148, v148, v206, -v207
v_mfma_f32_16x16x32_bf16 v[96:99], v[16:19], a[200:203], v[96:99]
v_cvt_pk_bf16_f32 v124, v80, v81
v_cvt_pk_bf16_f32 v125, v82, v83
v_fma_f32 v149, v149, v206, -v207
v_mfma_f32_16x16x32_bf16 v[96:99], v[20:23], a[204:207], v[96:99]
v_exp_f32 v84, v84
v_mfma_f32_16x16x32_bf16 v[100:103], v[24:27], a[192:195], 0
v_exp_f32 v85, v85
v_fma_f32 v150, v150, v206, -v207
v_mfma_f32_16x16x32_bf16 v[100:103], v[28:31], a[196:199], v[100:103]
v_exp_f32 v86, v86
v_mfma_f32_16x16x32_bf16 v[100:103], v[32:35], a[200:203], v[100:103]
v_exp_f32 v87, v87
v_fma_f32 v151, v151, v206, -v207
v_mfma_f32_16x16x32_bf16 v[100:103], v[36:39], a[204:207], v[100:103]
v_cvt_pk_bf16_f32 v126, v84, v85
v_cvt_pk_bf16_f32 v127, v86, v87
v_fma_f32 v152, v152, v206, -v207
s_waitcnt vmcnt(17) lgkmcnt(0)
s_barrier
v_mfma_f32_16x16x32_bf16 a[0:3], v[40:43], v[104:107], a[0:3]
ds_read_b128 v[8:11], v2 offset:16384
v_fma_f32 v153, v153, v206, -v207
v_mfma_f32_16x16x32_bf16 a[32:35], v[40:43], v[108:111], a[32:35]
s_add_u32 m0, s59, 8192
v_fma_f32 v154, v154, v206, -v207
v_mfma_f32_16x16x32_bf16 a[64:67], v[40:43], v[112:115], a[64:67]
buffer_load_dwordx4 v1, s[4:7], s57 offen offset:0 sc1 lds
v_fma_f32 v155, v155, v206, -v207
v_mfma_f32_16x16x32_bf16 a[96:99], v[40:43], v[116:119], a[96:99]
ds_read_b128 v[12:15], v2 offset:17408
v_lshlrev_b32 v212, 16, v180
v_mfma_f32_16x16x32_bf16 a[4:7], v[44:47], v[104:107], a[4:7]
v_exp_f32 v88, v88
v_mfma_f32_16x16x32_bf16 a[36:39], v[44:47], v[108:111], a[36:39]
v_exp_f32 v89, v89
v_mfma_f32_16x16x32_bf16 a[68:71], v[44:47], v[112:115], a[68:71]
ds_read_b128 v[16:19], v2 offset:18432
buffer_load_dwordx4 v1, s[4:7], s57 offen offset:1024 sc1 lds
v_mfma_f32_16x16x32_bf16 a[100:103], v[44:47], v[116:119], a[100:103]
v_exp_f32 v90, v90
v_and_b32 v213, 0xffff0000, v180
v_mfma_f32_16x16x32_bf16 a[8:11], v[48:51], v[104:107], a[8:11]
v_exp_f32 v91, v91
v_mfma_f32_16x16x32_bf16 a[40:43], v[48:51], v[108:111], a[40:43]
ds_read_b128 v[20:23], v2 offset:19456
v_cvt_pk_bf16_f32 v128, v88, v89
v_lshlrev_b32 v214, 16, v181
v_mfma_f32_16x16x32_bf16 a[72:75], v[48:51], v[112:115], a[72:75]
buffer_load_dwordx4 v1, s[4:7], s57 offen offset:2048 sc1 lds
v_cvt_pk_bf16_f32 v129, v90, v91
v_and_b32 v215, 0xffff0000, v181
v_mfma_f32_16x16x32_bf16 a[104:107], v[48:51], v[116:119], a[104:107]
v_exp_f32 v92, v92
v_mfma_f32_16x16x32_bf16 a[12:15], v[52:55], v[104:107], a[12:15]
ds_read_b128 v[24:27], v2 offset:20480
v_lshlrev_b32 v216, 16, v182
v_mfma_f32_16x16x32_bf16 a[44:47], v[52:55], v[108:111], a[44:47]
v_exp_f32 v93, v93
v_and_b32 v217, 0xffff0000, v182
v_mfma_f32_16x16x32_bf16 a[76:79], v[52:55], v[112:115], a[76:79]
buffer_load_dwordx4 v1, s[4:7], s57 offen offset:3072 sc1 lds
v_cvt_pk_bf16_f32 v130, v92, v93
v_mfma_f32_16x16x32_bf16 a[108:111], v[52:55], v[116:119], a[108:111]
ds_read_b128 v[28:31], v2 offset:21504
s_add_u32 s57, s57, 0x4000
v_exp_f32 v94, v94
v_lshlrev_b32 v218, 16, v183
v_mfma_f32_16x16x32_bf16 a[16:19], v[56:59], v[104:107], a[16:19]
v_exp_f32 v95, v95
v_mfma_f32_16x16x32_bf16 a[48:51], v[56:59], v[108:111], a[48:51]
s_add_u32 m0, s60, 0
v_cvt_pk_bf16_f32 v131, v94, v95
v_and_b32 v219, 0xffff0000, v183
v_mfma_f32_16x16x32_bf16 a[80:83], v[56:59], v[112:115], a[80:83]
ds_read_b128 v[32:35], v2 offset:22528
buffer_load_dwordx4 v1, s[4:7], s58 offen offset:0 sc1 lds
v_exp_f32 v96, v96
v_lshlrev_b32 v220, 16, v184
v_mfma_f32_16x16x32_bf16 a[112:115], v[56:59], v[116:119], a[112:115]
v_exp_f32 v97, v97
v_mfma_f32_16x16x32_bf16 a[20:23], v[60:63], v[104:107], a[20:23]
v_exp_f32 v98, v98
v_and_b32 v221, 0xffff0000, v184
v_mfma_f32_16x16x32_bf16 a[52:55], v[60:63], v[108:111], a[52:55]
ds_read_b128 v[36:39], v2 offset:23552
v_cvt_pk_bf16_f32 v132, v96, v97
v_lshlrev_b32 v222, 16, v185
v_mfma_f32_16x16x32_bf16 a[84:87], v[60:63], v[112:115], a[84:87]
buffer_load_dwordx4 v1, s[4:7], s58 offen offset:1024 sc1 lds
v_and_b32 v223, 0xffff0000, v185
v_exp_f32 v99, v99
v_mfma_f32_16x16x32_bf16 a[116:119], v[60:63], v[116:119], a[116:119]
v_exp_f32 v100, v100
v_mfma_f32_16x16x32_bf16 a[24:27], v[64:67], v[104:107], a[24:27]
v_exp_f32 v101, v101
v_lshlrev_b32 v224, 16, v186
v_mfma_f32_16x16x32_bf16 a[56:59], v[64:67], v[108:111], a[56:59]
v_cvt_pk_bf16_f32 v133, v98, v99
v_cvt_pk_bf16_f32 v134, v100, v101
v_mfma_f32_16x16x32_bf16 a[88:91], v[64:67], v[112:115], a[88:91]
buffer_load_dwordx4 v1, s[4:7], s58 offen offset:2048 sc1 lds
v_and_b32 v225, 0xffff0000, v186
v_mfma_f32_16x16x32_bf16 a[120:123], v[64:67], v[116:119], a[120:123]
v_exp_f32 v102, v102
v_mfma_f32_16x16x32_bf16 a[28:31], v[68:71], v[104:107], a[28:31]
v_exp_f32 v103, v103
v_lshlrev_b32 v226, 16, v187
v_mfma_f32_16x16x32_bf16 a[60:63], v[68:71], v[108:111], a[60:63]
v_cvt_pk_bf16_f32 v135, v102, v103
v_and_b32 v227, 0xffff0000, v187
v_mfma_f32_16x16x32_bf16 a[92:95], v[68:71], v[112:115], a[92:95]
buffer_load_dwordx4 v1, s[4:7], s58 offen offset:3072 sc1 lds
v_mul_f32 v212, v148, v212
v_mfma_f32_16x16x32_bf16 a[124:127], v[68:71], v[116:119], a[124:127]
s_add_u32 s58, s58, 0x4000
v_mul_f32 v216, v152, v216
v_mfma_f32_16x16x32_bf16 a[128:131], v[136:139], v[104:107], a[128:131]
v_mul_f32 v213, v149, v213
v_mfma_f32_16x16x32_bf16 a[132:135], v[136:139], v[108:111], a[132:135]
v_mfma_f32_16x16x32_bf16 a[136:139], v[136:139], v[112:115], a[136:139]
v_mfma_f32_16x16x32_bf16 a[140:143], v[136:139], v[116:119], a[140:143]
s_waitcnt lgkmcnt(0)
v_mfma_f32_16x16x32_bf16 v[72:75], v[8:11], a[144:147], 0
ds_read_b128 v[40:43], v3 offset:8192
v_mul_f32 v217, v153, v217
v_mfma_f32_16x16x32_bf16 v[72:75], v[12:15], a[148:151], v[72:75]
buffer_store_dwordx4 v[228:231], v239, s[12:15], s66 offen offset:0 sc1
v_mul_f32 v214, v150, v214
v_mfma_f32_16x16x32_bf16 v[72:75], v[16:19], a[152:155], v[72:75]
v_mul_f32 v218, v154, v218
v_mul_f32 v215, v151, v215
v_mfma_f32_16x16x32_bf16 v[72:75], v[20:23], a[156:159], v[72:75]
ds_read_b128 v[44:47], v3 offset:9216
v_mul_f32 v219, v155, v219
v_mfma_f32_16x16x32_bf16 v[76:79], v[24:27], a[144:147], 0
v_fma_f32 v212, -v152, v220, v212
v_fma_f32 v216, v148, v224, v216
v_mfma_f32_16x16x32_bf16 v[76:79], v[28:31], a[148:151], v[76:79]
v_fma_f32 v213, -v153, v221, v213
v_fma_f32 v217, v149, v225, v217
v_mfma_f32_16x16x32_bf16 v[76:79], v[32:35], a[152:155], v[76:79]
ds_read_b128 v[48:51], v3 offset:10240
v_fma_f32 v214, -v154, v222, v214
v_mfma_f32_16x16x32_bf16 v[76:79], v[36:39], a[156:159], v[76:79]
buffer_load_dwordx4 v[140:143], v236, s[8:11], s62 offen offset:0 nt
v_fma_f32 v218, v150, v226, v218
v_mfma_f32_16x16x32_bf16 v[80:83], v[8:11], a[160:163], 0
v_fma_f32 v215, -v155, v223, v215
v_fma_f32 v219, v151, v227, v219
v_mfma_f32_16x16x32_bf16 v[80:83], v[12:15], a[164:167], v[80:83]
ds_read_b128 v[52:55], v3 offset:11264
v_cvt_pk_bf16_f32 v232, v212, v213
v_mfma_f32_16x16x32_bf16 v[80:83], v[16:19], a[168:171], v[80:83]
v_exp_f32 v72, v72
v_mfma_f32_16x16x32_bf16 v[80:83], v[20:23], a[172:175], v[80:83]
v_exp_f32 v73, v73
v_mfma_f32_16x16x32_bf16 v[84:87], v[24:27], a[160:163], 0
ds_read_b128 v[56:59], v3 offset:12288
v_cvt_pk_bf16_f32 v104, v72, v73
v_mfma_f32_16x16x32_bf16 v[84:87], v[28:31], a[164:167], v[84:87]
buffer_load_dwordx4 v[144:147], v236, s[8:11], s62 offen offset:256 nt
v_cvt_pk_bf16_f32 v233, v214, v215
v_mfma_f32_16x16x32_bf16 v[84:87], v[32:35], a[168:171], v[84:87]
v_exp_f32 v74, v74
v_mfma_f32_16x16x32_bf16 v[84:87], v[36:39], a[172:175], v[84:87]
ds_read_b128 v[60:63], v3 offset:13312
v_cvt_pk_bf16_f32 v234, v216, v217
v_mfma_f32_16x16x32_bf16 v[88:91], v[8:11], a[176:179], 0
v_exp_f32 v75, v75
v_mfma_f32_16x16x32_bf16 v[88:91], v[12:15], a[180:183], v[88:91]
v_exp_f32 v76, v76
v_mfma_f32_16x16x32_bf16 v[88:91], v[16:19], a[184:187], v[88:91]
ds_read_b128 v[64:67], v3 offset:14336
v_cvt_pk_bf16_f32 v105, v74, v75
v_mfma_f32_16x16x32_bf16 v[88:91], v[20:23], a[188:191], v[88:91]
buffer_load_ushort v204, v238, s[24:27], s65 offen offset:0
v_cvt_pk_bf16_f32 v235, v218, v219
v_mfma_f32_16x16x32_bf16 v[92:95], v[24:27], a[176:179], 0
v_exp_f32 v77, v77
v_mfma_f32_16x16x32_bf16 v[92:95], v[28:31], a[180:183], v[92:95]
ds_read_b128 v[68:71], v3 offset:15360
v_cvt_pk_bf16_f32 v106, v76, v77
v_mfma_f32_16x16x32_bf16 v[92:95], v[32:35], a[184:187], v[92:95]
v_exp_f32 v78, v78
v_mfma_f32_16x16x32_bf16 v[92:95], v[36:39], a[188:191], v[92:95]
v_exp_f32 v79, v79
v_mfma_f32_16x16x32_bf16 v[96:99], v[8:11], a[192:195], 0
v_exp_f32 v80, v80
v_mfma_f32_16x16x32_bf16 v[96:99], v[12:15], a[196:199], v[96:99]
buffer_load_ushort v205, v238, s[28:31], s65 offen offset:0
v_cvt_pk_bf16_f32 v107, v78, v79
v_mfma_f32_16x16x32_bf16 v[96:99], v[16:19], a[200:203], v[96:99]
v_exp_f32 v81, v81
s_waitcnt vmcnt(46)
v_mfma_f32_16x16x32_bf16 v[96:99], v[20:23], a[204:207], v[96:99]
v_exp_f32 v82, v82
v_mfma_f32_16x16x32_bf16 v[100:103], v[24:27], a[192:195], 0
v_exp_f32 v83, v83
v_lshlrev_b32 v208, 16, v208
v_mfma_f32_16x16x32_bf16 v[100:103], v[28:31], a[196:199], v[100:103]
v_cvt_pk_bf16_f32 v108, v80, v81
v_cvt_pk_bf16_f32 v109, v82, v83
v_mfma_f32_16x16x32_bf16 v[100:103], v[32:35], a[200:203], v[100:103]
buffer_load_dwordx2 v[172:173], v237, s[16:19], s64 offen offset:0
v_lshlrev_b32 v209, 16, v209
v_mfma_f32_16x16x32_bf16 v[100:103], v[36:39], a[204:207], v[100:103]
v_exp_f32 v84, v84
v_cvt_f32_i32 v156, v156
s_waitcnt vmcnt(23) lgkmcnt(0)
s_barrier
v_mfma_f32_16x16x32_bf16 a[0:3], v[40:43], v[120:123], a[0:3]
ds_read_b128 v[8:11], v2 offset:24576
v_cvt_f32_i32 v157, v157
v_mfma_f32_16x16x32_bf16 a[32:35], v[40:43], v[124:127], a[32:35]
s_add_u32 m0, s59, 16384
v_cvt_f32_i32 v158, v158
v_exp_f32 v85, v85
v_mfma_f32_16x16x32_bf16 a[64:67], v[40:43], v[128:131], a[64:67]
buffer_load_dwordx4 v1, s[4:7], s57 offen offset:0 sc1 lds
v_cvt_pk_bf16_f32 v110, v84, v85
v_mfma_f32_16x16x32_bf16 a[96:99], v[40:43], v[132:135], a[96:99]
ds_read_b128 v[12:15], v2 offset:25600
v_cvt_f32_i32 v159, v159
v_exp_f32 v86, v86
v_mfma_f32_16x16x32_bf16 a[4:7], v[44:47], v[120:123], a[4:7]
v_exp_f32 v87, v87
v_mfma_f32_16x16x32_bf16 a[36:39], v[44:47], v[124:127], a[36:39]
v_exp_f32 v88, v88
v_mul_f32 v209, v209, v208
v_mfma_f32_16x16x32_bf16 a[68:71], v[44:47], v[128:131], a[68:71]
ds_read_b128 v[16:19], v2 offset:26624
buffer_load_dwordx4 v1, s[4:7], s57 offen offset:1024 sc1 lds
v_mfma_f32_16x16x32_bf16 a[100:103], v[44:47], v[132:135], a[100:103]
v_exp_f32 v89, v89
v_cvt_f32_i32 v160, v160
v_mfma_f32_16x16x32_bf16 a[8:11], v[48:51], v[120:123], a[8:11]
v_cvt_pk_bf16_f32 v111, v86, v87
v_cvt_pk_bf16_f32 v112, v88, v89
v_mfma_f32_16x16x32_bf16 a[40:43], v[48:51], v[124:127], a[40:43]
ds_read_b128 v[20:23], v2 offset:27648
v_cvt_f32_i32 v161, v161
v_exp_f32 v90, v90
v_mfma_f32_16x16x32_bf16 a[72:75], v[48:51], v[128:131], a[72:75]
buffer_load_dwordx4 v1, s[4:7], s57 offen offset:2048 sc1 lds
v_cvt_f32_i32 v162, v162
v_exp_f32 v91, v91
v_mfma_f32_16x16x32_bf16 a[104:107], v[48:51], v[132:135], a[104:107]
v_exp_f32 v92, v92
v_mfma_f32_16x16x32_bf16 a[12:15], v[52:55], v[120:123], a[12:15]
ds_read_b128 v[24:27], v2 offset:28672
v_cvt_pk_bf16_f32 v113, v90, v91
v_cvt_f32_i32 v163, v163
v_mfma_f32_16x16x32_bf16 a[44:47], v[52:55], v[124:127], a[44:47]
v_exp_f32 v93, v93
v_fma_f32 v156, v156, v208, -v209
v_mfma_f32_16x16x32_bf16 a[76:79], v[52:55], v[128:131], a[76:79]
buffer_load_dwordx4 v1, s[4:7], s57 offen offset:3072 sc1 lds
v_cvt_pk_bf16_f32 v114, v92, v93
v_mfma_f32_16x16x32_bf16 a[108:111], v[52:55], v[132:135], a[108:111]
ds_read_b128 v[28:31], v2 offset:29696
s_add_u32 s57, s57, 0x4000
v_exp_f32 v94, v94
v_fma_f32 v157, v157, v208, -v209
v_mfma_f32_16x16x32_bf16 a[16:19], v[56:59], v[120:123], a[16:19]
v_exp_f32 v95, v95
v_mfma_f32_16x16x32_bf16 a[48:51], v[56:59], v[124:127], a[48:51]
s_add_u32 m0, s60, 8192
v_cvt_pk_bf16_f32 v115, v94, v95
v_fma_f32 v158, v158, v208, -v209
v_mfma_f32_16x16x32_bf16 a[80:83], v[56:59], v[128:131], a[80:83]
ds_read_b128 v[32:35], v2 offset:30720
buffer_load_dwordx4 v1, s[4:7], s58 offen offset:0 sc1 lds
v_exp_f32 v96, v96
v_fma_f32 v159, v159, v208, -v209
v_mfma_f32_16x16x32_bf16 a[112:115], v[56:59], v[132:135], a[112:115]
v_exp_f32 v97, v97
v_mfma_f32_16x16x32_bf16 a[20:23], v[60:63], v[120:123], a[20:23]
v_exp_f32 v98, v98
v_fma_f32 v160, v160, v208, -v209
v_mfma_f32_16x16x32_bf16 a[52:55], v[60:63], v[124:127], a[52:55]
ds_read_b128 v[36:39], v2 offset:31744
v_cvt_pk_bf16_f32 v116, v96, v97
v_fma_f32 v161, v161, v208, -v209
v_mfma_f32_16x16x32_bf16 a[84:87], v[60:63], v[128:131], a[84:87]
buffer_load_dwordx4 v1, s[4:7], s58 offen offset:1024 sc1 lds
v_fma_f32 v162, v162, v208, -v209
v_exp_f32 v99, v99
v_mfma_f32_16x16x32_bf16 a[116:119], v[60:63], v[132:135], a[116:119]
v_exp_f32 v100, v100
v_mfma_f32_16x16x32_bf16 a[24:27], v[64:67], v[120:123], a[24:27]
v_exp_f32 v101, v101
v_fma_f32 v163, v163, v208, -v209
v_mfma_f32_16x16x32_bf16 a[56:59], v[64:67], v[124:127], a[56:59]
v_cvt_pk_bf16_f32 v117, v98, v99
v_cvt_pk_bf16_f32 v118, v100, v101
v_mfma_f32_16x16x32_bf16 a[88:91], v[64:67], v[128:131], a[88:91]
buffer_load_dwordx4 v1, s[4:7], s58 offen offset:2048 sc1 lds
v_lshlrev_b32 v212, 16, v188
v_mfma_f32_16x16x32_bf16 a[120:123], v[64:67], v[132:135], a[120:123]
v_exp_f32 v102, v102
v_mfma_f32_16x16x32_bf16 a[28:31], v[68:71], v[120:123], a[28:31]
v_exp_f32 v103, v103
v_and_b32 v213, 0xffff0000, v188
v_mfma_f32_16x16x32_bf16 a[60:63], v[68:71], v[124:127], a[60:63]
v_cvt_pk_bf16_f32 v119, v102, v103
v_lshlrev_b32 v214, 16, v189
v_mfma_f32_16x16x32_bf16 a[92:95], v[68:71], v[128:131], a[92:95]
buffer_load_dwordx4 v1, s[4:7], s58 offen offset:3072 sc1 lds
v_and_b32 v215, 0xffff0000, v189
v_mfma_f32_16x16x32_bf16 a[124:127], v[68:71], v[132:135], a[124:127]
s_add_u32 s58, s58, 0x4000
v_lshlrev_b32 v216, 16, v190
v_mfma_f32_16x16x32_bf16 a[128:131], v[136:139], v[120:123], a[128:131]
v_and_b32 v217, 0xffff0000, v190
v_mfma_f32_16x16x32_bf16 a[132:135], v[136:139], v[124:127], a[132:135]
v_mfma_f32_16x16x32_bf16 a[136:139], v[136:139], v[128:131], a[136:139]
v_mfma_f32_16x16x32_bf16 a[140:143], v[136:139], v[132:135], a[140:143]
s_waitcnt lgkmcnt(0)
v_mfma_f32_16x16x32_bf16 v[72:75], v[8:11], a[144:147], 0
ds_read_b128 v[40:43], v3 offset:16384
v_lshlrev_b32 v218, 16, v191
v_mfma_f32_16x16x32_bf16 v[72:75], v[12:15], a[148:151], v[72:75]
buffer_store_dwordx4 v[232:235], v239, s[12:15], s66 offen offset:128 sc1
v_and_b32 v219, 0xffff0000, v191
v_mfma_f32_16x16x32_bf16 v[72:75], v[16:19], a[152:155], v[72:75]
v_lshlrev_b32 v220, 16, v192
v_and_b32 v221, 0xffff0000, v192
v_mfma_f32_16x16x32_bf16 v[72:75], v[20:23], a[156:159], v[72:75]
ds_read_b128 v[44:47], v3 offset:17408
v_lshlrev_b32 v222, 16, v193
v_mfma_f32_16x16x32_bf16 v[76:79], v[24:27], a[144:147], 0
v_and_b32 v223, 0xffff0000, v193
v_lshlrev_b32 v224, 16, v194
v_mfma_f32_16x16x32_bf16 v[76:79], v[28:31], a[148:151], v[76:79]
buffer_load_dwordx4 v[240:243], off, s[32:35], s70 sc1
v_and_b32 v225, 0xffff0000, v194
v_mfma_f32_16x16x32_bf16 v[76:79], v[32:35], a[152:155], v[76:79]
ds_read_b128 v[48:51], v3 offset:18432
v_lshlrev_b32 v226, 16, v195
v_mfma_f32_16x16x32_bf16 v[76:79], v[36:39], a[156:159], v[76:79]
buffer_load_dwordx2 v[174:175], v237, s[16:19], s64 offen offset:128
v_and_b32 v227, 0xffff0000, v195
v_mfma_f32_16x16x32_bf16 v[80:83], v[8:11], a[160:163], 0
v_mul_f32 v212, v156, v212
v_mul_f32 v216, v160, v216
v_mfma_f32_16x16x32_bf16 v[80:83], v[12:15], a[164:167], v[80:83]
ds_read_b128 v[52:55], v3 offset:19456
v_mul_f32 v213, v157, v213
v_mfma_f32_16x16x32_bf16 v[80:83], v[16:19], a[168:171], v[80:83]
v_exp_f32 v72, v72
v_mfma_f32_16x16x32_bf16 v[80:83], v[20:23], a[172:175], v[80:83]
v_exp_f32 v73, v73
v_mfma_f32_16x16x32_bf16 v[84:87], v[24:27], a[160:163], 0
ds_read_b128 v[56:59], v3 offset:20480
v_cvt_pk_bf16_f32 v120, v72, v73
v_mfma_f32_16x16x32_bf16 v[84:87], v[28:31], a[164:167], v[84:87]
buffer_load_dwordx2 v[176:177], v237, s[20:23], s64 offen offset:0
v_mul_f32 v217, v161, v217
v_mfma_f32_16x16x32_bf16 v[84:87], v[32:35], a[168:171], v[84:87]
v_exp_f32 v74, v74
v_mfma_f32_16x16x32_bf16 v[84:87], v[36:39], a[172:175], v[84:87]
ds_read_b128 v[60:63], v3 offset:21504
v_mul_f32 v214, v158, v214
v_mfma_f32_16x16x32_bf16 v[88:91], v[8:11], a[176:179], 0
v_exp_f32 v75, v75
v_mfma_f32_16x16x32_bf16 v[88:91], v[12:15], a[180:183], v[88:91]
v_exp_f32 v76, v76
v_mfma_f32_16x16x32_bf16 v[88:91], v[16:19], a[184:187], v[88:91]
ds_read_b128 v[64:67], v3 offset:22528
v_cvt_pk_bf16_f32 v121, v74, v75
v_mfma_f32_16x16x32_bf16 v[88:91], v[20:23], a[188:191], v[88:91]
buffer_load_dwordx2 v[178:179], v237, s[20:23], s64 offen offset:128
v_mul_f32 v218, v162, v218
v_mfma_f32_16x16x32_bf16 v[92:95], v[24:27], a[176:179], 0
v_exp_f32 v77, v77
v_mfma_f32_16x16x32_bf16 v[92:95], v[28:31], a[180:183], v[92:95]
ds_read_b128 v[68:71], v3 offset:23552
v_cvt_pk_bf16_f32 v122, v76, v77
v_mfma_f32_16x16x32_bf16 v[92:95], v[32:35], a[184:187], v[92:95]
v_exp_f32 v78, v78
v_mfma_f32_16x16x32_bf16 v[92:95], v[36:39], a[188:191], v[92:95]
v_exp_f32 v79, v79
v_mfma_f32_16x16x32_bf16 v[96:99], v[8:11], a[192:195], 0
v_exp_f32 v80, v80
v_mfma_f32_16x16x32_bf16 v[96:99], v[12:15], a[196:199], v[96:99]
buffer_load_dwordx4 v[148:151], v236, s[8:11], s63 offen offset:0 nt
v_cvt_pk_bf16_f32 v123, v78, v79
v_mul_f32 v215, v159, v215
v_mfma_f32_16x16x32_bf16 v[96:99], v[16:19], a[200:203], v[96:99]
v_exp_f32 v81, v81
v_mul_f32 v219, v163, v219
v_mfma_f32_16x16x32_bf16 v[96:99], v[20:23], a[204:207], v[96:99]
v_exp_f32 v82, v82
v_mfma_f32_16x16x32_bf16 v[100:103], v[24:27], a[192:195], 0
v_exp_f32 v83, v83
v_fma_f32 v212, -v160, v220, v212
v_mfma_f32_16x16x32_bf16 v[100:103], v[28:31], a[196:199], v[100:103]
v_cvt_pk_bf16_f32 v124, v80, v81
v_cvt_pk_bf16_f32 v125, v82, v83
v_mfma_f32_16x16x32_bf16 v[100:103], v[32:35], a[200:203], v[100:103]
buffer_load_dwordx4 v[152:155], v236, s[8:11], s63 offen offset:256 nt
v_fma_f32 v216, v156, v224, v216
v_mfma_f32_16x16x32_bf16 v[100:103], v[36:39], a[204:207], v[100:103]
v_exp_f32 v84, v84
v_fma_f32 v213, -v161, v221, v213
s_waitcnt vmcnt(29) lgkmcnt(0)
s_barrier
v_mfma_f32_16x16x32_bf16 a[0:3], v[40:43], v[104:107], a[0:3]
ds_read_b128 v[8:11], v2 offset:0
v_fma_f32 v217, v157, v225, v217
v_mfma_f32_16x16x32_bf16 a[32:35], v[40:43], v[108:111], a[32:35]
s_add_u32 m0, s59, 24576
v_fma_f32 v214, -v162, v222, v214
v_exp_f32 v85, v85
v_mfma_f32_16x16x32_bf16 a[64:67], v[40:43], v[112:115], a[64:67]
buffer_load_dwordx4 v1, s[4:7], s57 offen offset:0 sc1 lds
v_cvt_pk_bf16_f32 v126, v84, v85
v_mfma_f32_16x16x32_bf16 a[96:99], v[40:43], v[116:119], a[96:99]
ds_read_b128 v[12:15], v2 offset:1024
v_fma_f32 v218, v158, v226, v218
v_exp_f32 v86, v86
v_mfma_f32_16x16x32_bf16 a[4:7], v[44:47], v[104:107], a[4:7]
v_exp_f32 v87, v87
v_mfma_f32_16x16x32_bf16 a[36:39], v[44:47], v[108:111], a[36:39]
v_exp_f32 v88, v88
v_fma_f32 v215, -v163, v223, v215
v_mfma_f32_16x16x32_bf16 a[68:71], v[44:47], v[112:115], a[68:71]
ds_read_b128 v[16:19], v2 offset:2048
buffer_load_dwordx4 v1, s[4:7], s57 offen offset:1024 sc1 lds
v_mfma_f32_16x16x32_bf16 a[100:103], v[44:47], v[116:119], a[100:103]
v_exp_f32 v89, v89
v_fma_f32 v219, v159, v227, v219
v_mfma_f32_16x16x32_bf16 a[8:11], v[48:51], v[104:107], a[8:11]
v_cvt_pk_bf16_f32 v127, v86, v87
v_cvt_pk_bf16_f32 v128, v88, v89
v_mfma_f32_16x16x32_bf16 a[40:43], v[48:51], v[108:111], a[40:43]
ds_read_b128 v[20:23], v2 offset:3072
v_cvt_pk_bf16_f32 v228, v212, v213
v_exp_f32 v90, v90
v_mfma_f32_16x16x32_bf16 a[72:75], v[48:51], v[112:115], a[72:75]
buffer_load_dwordx4 v1, s[4:7], s57 offen offset:2048 sc1 lds
v_cvt_pk_bf16_f32 v229, v214, v215
v_exp_f32 v91, v91
v_mfma_f32_16x16x32_bf16 a[104:107], v[48:51], v[116:119], a[104:107]
v_exp_f32 v92, v92
v_mfma_f32_16x16x32_bf16 a[12:15], v[52:55], v[104:107], a[12:15]
ds_read_b128 v[24:27], v2 offset:4096
v_cvt_pk_bf16_f32 v129, v90, v91
v_cvt_pk_bf16_f32 v230, v216, v217
v_mfma_f32_16x16x32_bf16 a[44:47], v[52:55], v[108:111], a[44:47]
v_exp_f32 v93, v93
v_cvt_pk_bf16_f32 v231, v218, v219
v_mfma_f32_16x16x32_bf16 a[76:79], v[52:55], v[112:115], a[76:79]
buffer_load_dwordx4 v1, s[4:7], s57 offen offset:3072 sc1 lds
v_cvt_pk_bf16_f32 v130, v92, v93
v_mfma_f32_16x16x32_bf16 a[108:111], v[52:55], v[116:119], a[108:111]
ds_read_b128 v[28:31], v2 offset:5120
s_add_u32 s57, s57, 0x4000
v_exp_f32 v94, v94
s_waitcnt vmcnt(50)
v_mfma_f32_16x16x32_bf16 a[16:19], v[56:59], v[104:107], a[16:19]
v_exp_f32 v95, v95
v_mfma_f32_16x16x32_bf16 a[48:51], v[56:59], v[108:111], a[48:51]
s_add_u32 m0, s60, 16384
v_cvt_pk_bf16_f32 v131, v94, v95
v_lshlrev_b32 v210, 16, v210
v_mfma_f32_16x16x32_bf16 a[80:83], v[56:59], v[112:115], a[80:83]
ds_read_b128 v[32:35], v2 offset:6144
buffer_load_dwordx4 v1, s[4:7], s58 offen offset:0 sc1 lds
v_exp_f32 v96, v96
v_lshlrev_b32 v211, 16, v211
v_mfma_f32_16x16x32_bf16 a[112:115], v[56:59], v[116:119], a[112:115]
v_exp_f32 v97, v97
v_mfma_f32_16x16x32_bf16 a[20:23], v[60:63], v[104:107], a[20:23]
v_exp_f32 v98, v98
v_cvt_f32_i32 v164, v164
v_mfma_f32_16x16x32_bf16 a[52:55], v[60:63], v[108:111], a[52:55]
ds_read_b128 v[36:39], v2 offset:7168
v_cvt_pk_bf16_f32 v132, v96, v97
v_cvt_f32_i32 v165, v165
v_mfma_f32_16x16x32_bf16 a[84:87], v[60:63], v[112:115], a[84:87]
buffer_load_dwordx4 v1, s[4:7], s58 offen offset:1024 sc1 lds
v_cvt_f32_i32 v166, v166
v_exp_f32 v99, v99
v_mfma_f32_16x16x32_bf16 a[116:119], v[60:63], v[116:119], a[116:119]
v_exp_f32 v100, v100
v_mfma_f32_16x16x32_bf16 a[24:27], v[64:67], v[104:107], a[24:27]
v_exp_f32 v101, v101
v_cvt_f32_i32 v167, v167
v_mfma_f32_16x16x32_bf16 a[56:59], v[64:67], v[108:111], a[56:59]
v_cvt_pk_bf16_f32 v133, v98, v99
v_cvt_pk_bf16_f32 v134, v100, v101
v_mfma_f32_16x16x32_bf16 a[88:91], v[64:67], v[112:115], a[88:91]
buffer_load_dwordx4 v1, s[4:7], s58 offen offset:2048 sc1 lds
v_mul_f32 v211, v211, v210
v_mfma_f32_16x16x32_bf16 a[120:123], v[64:67], v[116:119], a[120:123]
v_exp_f32 v102, v102
v_mfma_f32_16x16x32_bf16 a[28:31], v[68:71], v[104:107], a[28:31]
v_exp_f32 v103, v103
v_cvt_f32_i32 v168, v168
v_mfma_f32_16x16x32_bf16 a[60:63], v[68:71], v[108:111], a[60:63]
v_cvt_pk_bf16_f32 v135, v102, v103
v_cvt_f32_i32 v169, v169
v_mfma_f32_16x16x32_bf16 a[92:95], v[68:71], v[112:115], a[92:95]
buffer_load_dwordx4 v1, s[4:7], s58 offen offset:3072 sc1 lds
v_cvt_f32_i32 v170, v170
v_mfma_f32_16x16x32_bf16 a[124:127], v[68:71], v[116:119], a[124:127]
s_add_u32 s58, s58, 0x4000
v_cvt_f32_i32 v171, v171
v_mfma_f32_16x16x32_bf16 a[128:131], v[136:139], v[104:107], a[128:131]
v_fma_f32 v164, v164, v210, -v211
v_mfma_f32_16x16x32_bf16 a[132:135], v[136:139], v[108:111], a[132:135]
v_mfma_f32_16x16x32_bf16 a[136:139], v[136:139], v[112:115], a[136:139]
v_mfma_f32_16x16x32_bf16 a[140:143], v[136:139], v[116:119], a[140:143]
s_waitcnt lgkmcnt(0)
v_mfma_f32_16x16x32_bf16 v[72:75], v[8:11], a[144:147], 0
ds_read_b128 v[40:43], v3 offset:24576
v_fma_f32 v165, v165, v210, -v211
v_mfma_f32_16x16x32_bf16 v[72:75], v[12:15], a[148:151], v[72:75]
buffer_store_dwordx4 v[228:231], v239, s[12:15], s66 offen offset:2048 sc1
v_fma_f32 v166, v166, v210, -v211
v_mfma_f32_16x16x32_bf16 v[72:75], v[16:19], a[152:155], v[72:75]
v_fma_f32 v167, v167, v210, -v211
v_fma_f32 v168, v168, v210, -v211
v_mfma_f32_16x16x32_bf16 v[72:75], v[20:23], a[156:159], v[72:75]
ds_read_b128 v[44:47], v3 offset:25600
v_fma_f32 v169, v169, v210, -v211
v_mfma_f32_16x16x32_bf16 v[76:79], v[24:27], a[144:147], 0
v_fma_f32 v170, v170, v210, -v211
v_fma_f32 v171, v171, v210, -v211
v_mfma_f32_16x16x32_bf16 v[76:79], v[28:31], a[148:151], v[76:79]
v_lshlrev_b32 v212, 16, v196
v_and_b32 v213, 0xffff0000, v196
v_mfma_f32_16x16x32_bf16 v[76:79], v[32:35], a[152:155], v[76:79]
ds_read_b128 v[48:51], v3 offset:26624
v_lshlrev_b32 v214, 16, v197
v_mfma_f32_16x16x32_bf16 v[76:79], v[36:39], a[156:159], v[76:79]
buffer_load_ushort v206, v238, s[24:27], s65 offen offset:16
v_and_b32 v215, 0xffff0000, v197
v_mfma_f32_16x16x32_bf16 v[80:83], v[8:11], a[160:163], 0
v_lshlrev_b32 v216, 16, v198
v_and_b32 v217, 0xffff0000, v198
v_mfma_f32_16x16x32_bf16 v[80:83], v[12:15], a[164:167], v[80:83]
ds_read_b128 v[52:55], v3 offset:27648
v_lshlrev_b32 v218, 16, v199
v_mfma_f32_16x16x32_bf16 v[80:83], v[16:19], a[168:171], v[80:83]
v_exp_f32 v72, v72
v_mfma_f32_16x16x32_bf16 v[80:83], v[20:23], a[172:175], v[80:83]
v_exp_f32 v73, v73
v_mfma_f32_16x16x32_bf16 v[84:87], v[24:27], a[160:163], 0
ds_read_b128 v[56:59], v3 offset:28672
v_cvt_pk_bf16_f32 v104, v72, v73
v_mfma_f32_16x16x32_bf16 v[84:87], v[28:31], a[164:167], v[84:87]
buffer_load_ushort v207, v238, s[28:31], s65 offen offset:16
v_and_b32 v219, 0xffff0000, v199
v_mfma_f32_16x16x32_bf16 v[84:87], v[32:35], a[168:171], v[84:87]
v_exp_f32 v74, v74
v_mfma_f32_16x16x32_bf16 v[84:87], v[36:39], a[172:175], v[84:87]
ds_read_b128 v[60:63], v3 offset:29696
v_lshlrev_b32 v220, 16, v200
v_mfma_f32_16x16x32_bf16 v[88:91], v[8:11], a[176:179], 0
v_exp_f32 v75, v75
v_mfma_f32_16x16x32_bf16 v[88:91], v[12:15], a[180:183], v[88:91]
v_exp_f32 v76, v76
v_mfma_f32_16x16x32_bf16 v[88:91], v[16:19], a[184:187], v[88:91]
ds_read_b128 v[64:67], v3 offset:30720
v_cvt_pk_bf16_f32 v105, v74, v75
v_mfma_f32_16x16x32_bf16 v[88:91], v[20:23], a[188:191], v[88:91]
buffer_load_dwordx2 v[180:181], v237, s[16:19], s64 offen offset:2048
v_and_b32 v221, 0xffff0000, v200
v_mfma_f32_16x16x32_bf16 v[92:95], v[24:27], a[176:179], 0
v_exp_f32 v77, v77
v_mfma_f32_16x16x32_bf16 v[92:95], v[28:31], a[180:183], v[92:95]
ds_read_b128 v[68:71], v3 offset:31744
v_cvt_pk_bf16_f32 v106, v76, v77
v_mfma_f32_16x16x32_bf16 v[92:95], v[32:35], a[184:187], v[92:95]
v_exp_f32 v78, v78
v_mfma_f32_16x16x32_bf16 v[92:95], v[36:39], a[188:191], v[92:95]
s_waitcnt vmcnt(17)
v_and_b32 v240, v240, v241
v_mfma_f32_16x16x32_bf16 v[96:99], v[8:11], a[192:195], 0
v_and_b32 v242, v242, v243
v_lshlrev_b32 v222, 16, v201
v_exp_f32 v79, v79
v_mfma_f32_16x16x32_bf16 v[96:99], v[12:15], a[196:199], v[96:99]
buffer_load_dwordx2 v[182:183], v237, s[16:19], s64 offen offset:2176
v_and_b32 v240, v240, v242
v_mfma_f32_16x16x32_bf16 v[96:99], v[16:19], a[200:203], v[96:99]
v_exp_f32 v80, v80
v_mfma_f32_16x16x32_bf16 v[96:99], v[20:23], a[204:207], v[96:99]
v_readfirstlane_b32 s72, v240
v_cvt_pk_bf16_f32 v107, v78, v79
v_exp_f32 v81, v81
v_mfma_f32_16x16x32_bf16 v[100:103], v[24:27], a[192:195], 0
s_and_b32 s72, s72, s68
v_cvt_pk_bf16_f32 v108, v80, v81
v_and_b32 v223, 0xffff0000, v201
v_mfma_f32_16x16x32_bf16 v[100:103], v[28:31], a[196:199], v[100:103]
s_cmp_eq_u32 s72, s68
s_cbranch_scc0 L_spin_K4
L_back_K4:
v_lshlrev_b32 v224, 16, v202
v_exp_f32 v82, v82
v_mfma_f32_16x16x32_bf16 v[100:103], v[32:35], a[200:203], v[100:103]
buffer_load_dwordx2 v[184:185], v237, s[20:23], s64 offen offset:2048
v_and_b32 v225, 0xffff0000, v202
v_exp_f32 v83, v83
v_mfma_f32_16x16x32_bf16 v[100:103], v[36:39], a[204:207], v[100:103]
v_exp_f32 v84, v84
s_waitcnt vmcnt(35) lgkmcnt(0)
s_barrier
v_mfma_f32_16x16x32_bf16 a[0:3], v[40:43], v[120:123], a[0:3]
ds_read_b128 v[8:11], v2 offset:8192
v_cvt_pk_bf16_f32 v109, v82, v83
v_mfma_f32_16x16x32_bf16 a[32:35], v[40:43], v[124:127], a[32:35]
s_add_u32 m0, s59, 0
v_lshlrev_b32 v226, 16, v203
v_exp_f32 v85, v85
v_mfma_f32_16x16x32_bf16 a[64:67], v[40:43], v[128:131], a[64:67]
buffer_load_dwordx4 v1, s[4:7], s57 offen offset:0 sc1 lds
v_cvt_pk_bf16_f32 v110, v84, v85
v_and_b32 v227, 0xffff0000, v203
v_mfma_f32_16x16x32_bf16 a[96:99], v[40:43], v[132:135], a[96:99]
ds_read_b128 v[12:15], v2 offset:9216
v_mul_f32 v212, v164, v212
v_exp_f32 v86, v86
v_mfma_f32_16x16x32_bf16 a[4:7], v[44:47], v[120:123], a[4:7]
v_exp_f32 v87, v87
v_mfma_f32_16x16x32_bf16 a[36:39], v[44:47], v[124:127], a[36:39]
v_exp_f32 v88, v88
v_mul_f32 v216, v168, v216
v_mfma_f32_16x16x32_bf16 a[68:71], v[44:47], v[128:131], a[68:71]
ds_read_b128 v[16:19], v2 offset:10240
buffer_load_dwordx4 v1, s[4:7], s57 offen offset:1024 sc1 lds
v_mfma_f32_16x16x32_bf16 a[100:103], v[44:47], v[132:135], a[100:103]
v_exp_f32 v89, v89
v_mul_f32 v213, v165, v213
v_mfma_f32_16x16x32_bf16 a[8:11], v[48:51], v[120:123], a[8:11]
v_cvt_pk_bf16_f32 v111, v86, v87
v_cvt_pk_bf16_f32 v112, v88, v89
v_mfma_f32_16x16x32_bf16 a[40:43], v[48:51], v[124:127], a[40:43]
ds_read_b128 v[20:23], v2 offset:11264
v_mul_f32 v217, v169, v217
v_exp_f32 v90, v90
v_mfma_f32_16x16x32_bf16 a[72:75], v[48:51], v[128:131], a[72:75]
buffer_load_dwordx4 v1, s[4:7], s57 offen offset:2048 sc1 lds
v_mul_f32 v214, v166, v214
v_exp_f32 v91, v91
v_mfma_f32_16x16x32_bf16 a[104:107], v[48:51], v[132:135], a[104:107]
v_exp_f32 v92, v92
v_mfma_f32_16x16x32_bf16 a[12:15], v[52:55], v[120:123], a[12:15]
ds_read_b128 v[24:27], v2 offset:12288
v_cvt_pk_bf16_f32 v113, v90, v91
v_mul_f32 v218, v170, v218
v_mfma_f32_16x16x32_bf16 a[44:47], v[52:55], v[124:127], a[44:47]
v_exp_f32 v93, v93
v_mul_f32 v215, v167, v215
v_mfma_f32_16x16x32_bf16 a[76:79], v[52:55], v[128:131], a[76:79]
buffer_load_dwordx4 v1, s[4:7], s57 offen offset:3072 sc1 lds
v_cvt_pk_bf16_f32 v114, v92, v93
v_mfma_f32_16x16x32_bf16 a[108:111], v[52:55], v[132:135], a[108:111]
ds_read_b128 v[28:31], v2 offset:13312
s_add_u32 s57, s57, 0x4000
v_exp_f32 v94, v94
v_mul_f32 v219, v171, v219
v_mfma_f32_16x16x32_bf16 a[16:19], v[56:59], v[120:123], a[16:19]
v_exp_f32 v95, v95
v_mfma_f32_16x16x32_bf16 a[48:51], v[56:59], v[124:127], a[48:51]
s_add_u32 m0, s60, 24576
v_cvt_pk_bf16_f32 v115, v94, v95
v_fma_f32 v212, -v168, v220, v212
v_mfma_f32_16x16x32_bf16 a[80:83], v[56:59], v[128:131], a[80:83]
ds_read_b128 v[32:35], v2 offset:14336
buffer_load_dwordx4 v1, s[4:7], s58 offen offset:0 sc1 lds
v_exp_f32 v96, v96
v_fma_f32 v216, v164, v224, v216
v_mfma_f32_16x16x32_bf16 a[112:115], v[56:59], v[132:135], a[112:115]
v_exp_f32 v97, v97
v_mfma_f32_16x16x32_bf16 a[20:23], v[60:63], v[120:123], a[20:23]
v_exp_f32 v98, v98
v_fma_f32 v213, -v169, v221, v213
v_mfma_f32_16x16x32_bf16 a[52:55], v[60:63], v[124:127], a[52:55]
ds_read_b128 v[36:39], v2 offset:15360
v_cvt_pk_bf16_f32 v116, v96, v97
v_fma_f32 v217, v165, v225, v217
v_mfma_f32_16x16x32_bf16 a[84:87], v[60:63], v[128:131], a[84:87]
buffer_load_dwordx4 v1, s[4:7], s58 offen offset:1024 sc1 lds
v_fma_f32 v214, -v170, v222, v214
v_exp_f32 v99, v99
v_mfma_f32_16x16x32_bf16 a[116:119], v[60:63], v[132:135], a[116:119]
v_exp_f32 v100, v100
v_mfma_f32_16x16x32_bf16 a[24:27], v[64:67], v[120:123], a[24:27]
v_exp_f32 v101, v101
v_fma_f32 v218, v166, v226, v218
v_mfma_f32_16x16x32_bf16 a[56:59], v[64:67], v[124:127], a[56:59]
v_cvt_pk_bf16_f32 v117, v98, v99
v_cvt_pk_bf16_f32 v118, v100, v101
v_mfma_f32_16x16x32_bf16 a[88:91], v[64:67], v[128:131], a[88:91]
buffer_load_dwordx4 v1, s[4:7], s58 offen offset:2048 sc1 lds
v_fma_f32 v215, -v171, v223, v215
v_mfma_f32_16x16x32_bf16 a[120:123], v[64:67], v[132:135], a[120:123]
v_exp_f32 v102, v102
v_mfma_f32_16x16x32_bf16 a[28:31], v[68:71], v[120:123], a[28:31]
v_exp_f32 v103, v103
v_fma_f32 v219, v167, v227, v219
v_mfma_f32_16x16x32_bf16 a[60:63], v[68:71], v[124:127], a[60:63]
v_cvt_pk_bf16_f32 v119, v102, v103
v_cvt_pk_bf16_f32 v232, v212, v213
v_mfma_f32_16x16x32_bf16 a[92:95], v[68:71], v[128:131], a[92:95]
buffer_load_dwordx4 v1, s[4:7], s58 offen offset:3072 sc1 lds
v_cvt_pk_bf16_f32 v233, v214, v215
v_mfma_f32_16x16x32_bf16 a[124:127], v[68:71], v[132:135], a[124:127]
s_add_u32 s58, s58, 0x4000
v_cvt_pk_bf16_f32 v234, v216, v217
v_mfma_f32_16x16x32_bf16 a[128:131], v[136:139], v[120:123], a[128:131]
v_cvt_pk_bf16_f32 v235, v218, v219
v_mfma_f32_16x16x32_bf16 a[132:135], v[136:139], v[124:127], a[132:135]
v_mfma_f32_16x16x32_bf16 a[136:139], v[136:139], v[128:131], a[136:139]
v_mfma_f32_16x16x32_bf16 a[140:143], v[136:139], v[132:135], a[140:143]
s_waitcnt lgkmcnt(0)
v_mfma_f32_16x16x32_bf16 v[72:75], v[8:11], a[144:147], 0
ds_read_b128 v[40:43], v3 offset:0
v_mfma_f32_16x16x32_bf16 v[72:75], v[12:15], a[148:151], v[72:75]
buffer_store_dwordx4 v[232:235], v239, s[12:15], s66 offen offset:2176 sc1
v_mfma_f32_16x16x32_bf16 v[72:75], v[16:19], a[152:155], v[72:75]
v_mfma_f32_16x16x32_bf16 v[72:75], v[20:23], a[156:159], v[72:75]
ds_read_b128 v[44:47], v3 offset:1024
v_mfma_f32_16x16x32_bf16 v[76:79], v[24:27], a[144:147], 0
v_mfma_f32_16x16x32_bf16 v[76:79], v[28:31], a[148:151], v[76:79]
v_mfma_f32_16x16x32_bf16 v[76:79], v[32:35], a[152:155], v[76:79]
ds_read_b128 v[48:51], v3 offset:2048
v_mfma_f32_16x16x32_bf16 v[76:79], v[36:39], a[156:159], v[76:79]
buffer_load_dwordx2 v[186:187], v237, s[20:23], s64 offen offset:2176
v_mfma_f32_16x16x32_bf16 v[80:83], v[8:11], a[160:163], 0
v_mfma_f32_16x16x32_bf16 v[80:83], v[12:15], a[164:167], v[80:83]
ds_read_b128 v[52:55], v3 offset:3072
v_mfma_f32_16x16x32_bf16 v[80:83], v[16:19], a[168:171], v[80:83]
v_mfma_f32_16x16x32_bf16 v[80:83], v[20:23], a[172:175], v[80:83]
v_mfma_f32_16x16x32_bf16 v[84:87], v[24:27], a[160:163], 0
ds_read_b128 v[56:59], v3 offset:4096
v_mfma_f32_16x16x32_bf16 v[84:87], v[28:31], a[164:167], v[84:87]
buffer_load_dwordx4 v[156:159], v236, s[8:11], s62 offen offset:128 nt
v_mfma_f32_16x16x32_bf16 v[84:87], v[32:35], a[168:171], v[84:87]
v_exp_f32 v72, v72
v_mfma_f32_16x16x32_bf16 v[84:87], v[36:39], a[172:175], v[84:87]
ds_read_b128 v[60:63], v3 offset:5120
v_exp_f32 v73, v73
v_mfma_f32_16x16x32_bf16 v[88:91], v[8:11], a[176:179], 0
v_exp_f32 v74, v74
v_mfma_f32_16x16x32_bf16 v[88:91], v[12:15], a[180:183], v[88:91]
v_exp_f32 v75, v75
v_mfma_f32_16x16x32_bf16 v[88:91], v[16:19], a[184:187], v[88:91]
ds_read_b128 v[64:67], v3 offset:6144
v_cvt_pk_bf16_f32 v120, v72, v73
v_mfma_f32_16x16x32_bf16 v[88:91], v[20:23], a[188:191], v[88:91]
buffer_load_dwordx4 v[160:163], v236, s[8:11], s62 offen offset:384 nt
v_cvt_pk_bf16_f32 v121, v74, v75
v_mfma_f32_16x16x32_bf16 v[92:95], v[24:27], a[176:179], 0
v_exp_f32 v76, v76
v_mfma_f32_16x16x32_bf16 v[92:95], v[28:31], a[180:183], v[92:95]
ds_read_b128 v[68:71], v3 offset:7168
v_exp_f32 v77, v77
v_mfma_f32_16x16x32_bf16 v[92:95], v[32:35], a[184:187], v[92:95]
v_exp_f32 v78, v78
v_mfma_f32_16x16x32_bf16 v[92:95], v[36:39], a[188:191], v[92:95]
v_exp_f32 v79, v79
v_mfma_f32_16x16x32_bf16 v[96:99], v[8:11], a[192:195], 0
v_cvt_pk_bf16_f32 v122, v76, v77
v_cvt_pk_bf16_f32 v123, v78, v79
v_mfma_f32_16x16x32_bf16 v[96:99], v[12:15], a[196:199], v[96:99]
buffer_load_ushort v208, v238, s[24:27], s65 offen offset:0
v_mfma_f32_16x16x32_bf16 v[96:99], v[16:19], a[200:203], v[96:99]
v_exp_f32 v80, v80
v_mfma_f32_16x16x32_bf16 v[96:99], v[20:23], a[204:207], v[96:99]
v_exp_f32 v81, v81
v_mfma_f32_16x16x32_bf16 v[100:103], v[24:27], a[192:195], 0
v_exp_f32 v82, v82
v_mfma_f32_16x16x32_bf16 v[100:103], v[28:31], a[196:199], v[100:103]
v_exp_f32 v83, v83
v_mfma_f32_16x16x32_bf16 v[100:103], v[32:35], a[200:203], v[100:103]
buffer_load_ushort v209, v238, s[28:31], s65 offen offset:0
v_cvt_pk_bf16_f32 v124, v80, v81
v_mfma_f32_16x16x32_bf16 v[100:103], v[36:39], a[204:207], v[100:103]
v_exp_f32 v84, v84
s_waitcnt vmcnt(35) lgkmcnt(0)
s_barrier
v_mfma_f32_16x16x32_bf16 a[0:3], v[40:43], v[104:107], a[0:3]
ds_read_b128 v[8:11], v2 offset:16384
v_cvt_pk_bf16_f32 v125, v82, v83
v_mfma_f32_16x16x32_bf16 a[32:35], v[40:43], v[108:111], a[32:35]
s_add_u32 m0, s59, 8192
v_exp_f32 v85, v85
v_mfma_f32_16x16x32_bf16 a[64:67], v[40:43], v[112:115], a[64:67]
buffer_load_dwordx4 v1, s[4:7], s57 offen offset:0 sc1 lds
v_cvt_pk_bf16_f32 v126, v84, v85
v_mfma_f32_16x16x32_bf16 a[96:99], v[40:43], v[116:119], a[96:99]
ds_read_b128 v[12:15], v2 offset:17408
v_exp_f32 v86, v86
v_mfma_f32_16x16x32_bf16 a[4:7], v[44:47], v[104:107], a[4:7]
v_exp_f32 v87, v87
v_mfma_f32_16x16x32_bf16 a[36:39], v[44:47], v[108:111], a[36:39]
v_exp_f32 v88, v88
v_mfma_f32_16x16x32_bf16 a[68:71], v[44:47], v[112:115], a[68:71]
ds_read_b128 v[16:19], v2 offset:18432
buffer_load_dwordx4 v1, s[4:7], s57 offen offset:1024 sc1 lds
v_mfma_f32_16x16x32_bf16 a[100:103], v[44:47], v[116:119], a[100:103]
v_exp_f32 v89, v89
v_mfma_f32_16x16x32_bf16 a[8:11], v[48:51], v[104:107], a[8:11]
v_cvt_pk_bf16_f32 v127, v86, v87
v_cvt_pk_bf16_f32 v128, v88, v89
v_mfma_f32_16x16x32_bf16 a[40:43], v[48:51], v[108:111], a[40:43]
ds_read_b128 v[20:23], v2 offset:19456
v_exp_f32 v90, v90
v_mfma_f32_16x16x32_bf16 a[72:75], v[48:51], v[112:115], a[72:75]
buffer_load_dwordx4 v1, s[4:7], s57 offen offset:2048 sc1 lds
v_exp_f32 v91, v91
v_mfma_f32_16x16x32_bf16 a[104:107], v[48:51], v[116:119], a[104:107]
v_exp_f32 v92, v92
v_mfma_f32_16x16x32_bf16 a[12:15], v[52:55], v[104:107], a[12:15]
ds_read_b128 v[24:27], v2 offset:20480
v_cvt_pk_bf16_f32 v129, v90, v91
v_mfma_f32_16x16x32_bf16 a[44:47], v[52:55], v[108:111], a[44:47]
v_exp_f32 v93, v93
v_mfma_f32_16x16x32_bf16 a[76:79], v[52:55], v[112:115], a[76:79]
buffer_load_dwordx4 v1, s[4:7], s57 offen offset:3072 sc1 lds
v_cvt_pk_bf16_f32 v130, v92, v93
v_mfma_f32_16x16x32_bf16 a[108:111], v[52:55], v[116:119], a[108:111]
ds_read_b128 v[28:31], v2 offset:21504
s_add_u32 s57, s57, 0x4000
v_exp_f32 v94, v94
v_mfma_f32_16x16x32_bf16 a[16:19], v[56:59], v[104:107], a[16:19]
v_exp_f32 v95, v95
v_mfma_f32_16x16x32_bf16 a[48:51], v[56:59], v[108:111], a[48:51]
s_add_u32 m0, s60, 0
v_cvt_pk_bf16_f32 v131, v94, v95
v_mfma_f32_16x16x32_bf16 a[80:83], v[56:59], v[112:115], a[80:83]
ds_read_b128 v[32:35], v2 offset:22528
buffer_load_dwordx4 v1, s[4:7], s58 offen offset:0 sc1 lds
v_exp_f32 v96, v96
v_mfma_f32_16x16x32_bf16 a[112:115], v[56:59], v[116:119], a[112:115]
v_exp_f32 v97, v97
v_mfma_f32_16x16x32_bf16 a[20:23], v[60:63], v[104:107], a[20:23]
v_exp_f32 v98, v98
v_mfma_f32_16x16x32_bf16 a[52:55], v[60:63], v[108:111], a[52:55]
ds_read_b128 v[36:39], v2 offset:23552
v_cvt_pk_bf16_f32 v132, v96, v97
v_mfma_f32_16x16x32_bf16 a[84:87], v[60:63], v[112:115], a[84:87]
buffer_load_dwordx4 v1, s[4:7], s58 offen offset:1024 sc1 lds
v_exp_f32 v99, v99
v_mfma_f32_16x16x32_bf16 a[116:119], v[60:63], v[116:119], a[116:119]
v_exp_f32 v100, v100
v_mfma_f32_16x16x32_bf16 a[24:27], v[64:67], v[104:107], a[24:27]
v_exp_f32 v101, v101
v_mfma_f32_16x16x32_bf16 a[56:59], v[64:67], v[108:111], a[56:59]
v_cvt_pk_bf16_f32 v133, v98, v99
v_cvt_pk_bf16_f32 v134, v100, v101
v_mfma_f32_16x16x32_bf16 a[88:91], v[64:67], v[112:115], a[88:91]
buffer_load_dwordx4 v1, s[4:7], s58 offen offset:2048 sc1 lds
v_mfma_f32_16x16x32_bf16 a[120:123], v[64:67], v[116:119], a[120:123]
v_exp_f32 v102, v102
v_mfma_f32_16x16x32_bf16 a[28:31], v[68:71], v[104:107], a[28:31]
v_exp_f32 v103, v103
v_mfma_f32_16x16x32_bf16 a[60:63], v[68:71], v[108:111], a[60:63]
v_cvt_pk_bf16_f32 v135, v102, v103
v_mfma_f32_16x16x32_bf16 a[92:95], v[68:71], v[112:115], a[92:95]
buffer_load_dwordx4 v1, s[4:7], s58 offen offset:3072 sc1 lds
v_mfma_f32_16x16x32_bf16 a[124:127], v[68:71], v[116:119], a[124:127]
s_add_u32 s58, s58, 0x4000
v_mfma_f32_16x16x32_bf16 a[128:131], v[136:139], v[104:107], a[128:131]
v_mfma_f32_16x16x32_bf16 a[132:135], v[136:139], v[108:111], a[132:135]
v_mfma_f32_16x16x32_bf16 a[136:139], v[136:139], v[112:115], a[136:139]
v_mfma_f32_16x16x32_bf16 a[140:143], v[136:139], v[116:119], a[140:143]
s_waitcnt lgkmcnt(0)
v_mfma_f32_16x16x32_bf16 v[72:75], v[8:11], a[144:147], 0
ds_read_b128 v[40:43], v3 offset:8192
v_mfma_f32_16x16x32_bf16 v[72:75], v[12:15], a[148:151], v[72:75]
buffer_load_dwordx2 v[188:189], v237, s[16:19], s64 offen offset:64
v_mfma_f32_16x16x32_bf16 v[72:75], v[16:19], a[152:155], v[72:75]
v_mfma_f32_16x16x32_bf16 v[72:75], v[20:23], a[156:159], v[72:75]
ds_read_b128 v[44:47], v3 offset:9216
v_mfma_f32_16x16x32_bf16 v[76:79], v[24:27], a[144:147], 0
v_mfma_f32_16x16x32_bf16 v[76:79], v[28:31], a[148:151], v[76:79]
v_mfma_f32_16x16x32_bf16 v[76:79], v[32:35], a[152:155], v[76:79]
ds_read_b128 v[48:51], v3 offset:10240
v_mfma_f32_16x16x32_bf16 v[76:79], v[36:39], a[156:159], v[76:79]
buffer_load_dwordx2 v[190:191], v237, s[16:19], s64 offen offset:192
v_mfma_f32_16x16x32_bf16 v[80:83], v[8:11], a[160:163], 0
v_mfma_f32_16x16x32_bf16 v[80:83], v[12:15], a[164:167], v[80:83]
ds_read_b128 v[52:55], v3 offset:11264
v_mfma_f32_16x16x32_bf16 v[80:83], v[16:19], a[168:171], v[80:83]
v_mfma_f32_16x16x32_bf16 v[80:83], v[20:23], a[172:175], v[80:83]
v_mfma_f32_16x16x32_bf16 v[84:87], v[24:27], a[160:163], 0
ds_read_b128 v[56:59], v3 offset:12288
v_mfma_f32_16x16x32_bf16 v[84:87], v[28:31], a[164:167], v[84:87]
buffer_load_dwordx2 v[192:193], v237, s[20:23], s64 offen offset:64
v_mfma_f32_16x16x32_bf16 v[84:87], v[32:35], a[168:171], v[84:87]
v_exp_f32 v72, v72
v_mfma_f32_16x16x32_bf16 v[84:87], v[36:39], a[172:175], v[84:87]
ds_read_b128 v[60:63], v3 offset:13312
v_exp_f32 v73, v73
v_mfma_f32_16x16x32_bf16 v[88:91], v[8:11], a[176:179], 0
v_exp_f32 v74, v74
v_mfma_f32_16x16x32_bf16 v[88:91], v[12:15], a[180:183], v[88:91]
v_exp_f32 v75, v75
v_mfma_f32_16x16x32_bf16 v[88:91], v[16:19], a[184:187], v[88:91]
ds_read_b128 v[64:67], v3 offset:14336
v_cvt_pk_bf16_f32 v104, v72, v73
v_mfma_f32_16x16x32_bf16 v[88:91], v[20:23], a[188:191], v[88:91]
buffer_load_dwordx2 v[194:195], v237, s[20:23], s64 offen offset:192
v_cvt_pk_bf16_f32 v105, v74, v75
v_mfma_f32_16x16x32_bf16 v[92:95], v[24:27], a[176:179], 0
v_exp_f32 v76, v76
v_mfma_f32_16x16x32_bf16 v[92:95], v[28:31], a[180:183], v[92:95]
ds_read_b128 v[68:71], v3 offset:15360
v_exp_f32 v77, v77
v_mfma_f32_16x16x32_bf16 v[92:95], v[32:35], a[184:187], v[92:95]
v_exp_f32 v78, v78
v_mfma_f32_16x16x32_bf16 v[92:95], v[36:39], a[188:191], v[92:95]
v_exp_f32 v79, v79
v_mfma_f32_16x16x32_bf16 v[96:99], v[8:11], a[192:195], 0
v_cvt_pk_bf16_f32 v106, v76, v77
v_cvt_pk_bf16_f32 v107, v78, v79
v_mfma_f32_16x16x32_bf16 v[96:99], v[12:15], a[196:199], v[96:99]
buffer_load_dwordx4 v[164:167], v236, s[8:11], s63 offen offset:128 nt
v_mfma_f32_16x16x32_bf16 v[96:99], v[16:19], a[200:203], v[96:99]
v_exp_f32 v80, v80
v_mfma_f32_16x16x32_bf16 v[96:99], v[20:23], a[204:207], v[96:99]
v_exp_f32 v81, v81
v_mfma_f32_16x16x32_bf16 v[100:103], v[24:27], a[192:195], 0
v_exp_f32 v82, v82
v_mfma_f32_16x16x32_bf16 v[100:103], v[28:31], a[196:199], v[100:103]
v_exp_f32 v83, v83
v_mfma_f32_16x16x32_bf16 v[100:103], v[32:35], a[200:203], v[100:103]
buffer_load_dwordx4 v[168:171], v236, s[8:11], s63 offen offset:384 nt
v_cvt_pk_bf16_f32 v108, v80, v81
v_mfma_f32_16x16x32_bf16 v[100:103], v[36:39], a[204:207], v[100:103]
v_exp_f32 v84, v84
s_waitcnt vmcnt(34) lgkmcnt(0)
s_barrier
v_mfma_f32_16x16x32_bf16 a[0:3], v[40:43], v[120:123], a[0:3]
ds_read_b128 v[8:11], v2 offset:24576
v_cvt_pk_bf16_f32 v109, v82, v83
v_mfma_f32_16x16x32_bf16 a[32:35], v[40:43], v[124:127], a[32:35]
s_add_u32 m0, s59, 16384
v_exp_f32 v85, v85
v_mfma_f32_16x16x32_bf16 a[64:67], v[40:43], v[128:131], a[64:67]
buffer_load_dwordx4 v1, s[4:7], s57 offen offset:0 sc1 lds
v_cvt_pk_bf16_f32 v110, v84, v85
v_mfma_f32_16x16x32_bf16 a[96:99], v[40:43], v[132:135], a[96:99]
ds_read_b128 v[12:15], v2 offset:25600
v_exp_f32 v86, v86
v_mfma_f32_16x16x32_bf16 a[4:7], v[44:47], v[120:123], a[4:7]
v_exp_f32 v87, v87
v_mfma_f32_16x16x32_bf16 a[36:39], v[44:47], v[124:127], a[36:39]
v_exp_f32 v88, v88
v_mfma_f32_16x16x32_bf16 a[68:71], v[44:47], v[128:131], a[68:71]
ds_read_b128 v[16:19], v2 offset:26624
buffer_load_dwordx4 v1, s[4:7], s57 offen offset:1024 sc1 lds
v_mfma_f32_16x16x32_bf16 a[100:103], v[44:47], v[132:135], a[100:103]
v_exp_f32 v89, v89
v_mfma_f32_16x16x32_bf16 a[8:11], v[48:51], v[120:123], a[8:11]
v_cvt_pk_bf16_f32 v111, v86, v87
v_cvt_pk_bf16_f32 v112, v88, v89
v_mfma_f32_16x16x32_bf16 a[40:43], v[48:51], v[124:127], a[40:43]
ds_read_b128 v[20:23], v2 offset:27648
v_exp_f32 v90, v90
v_mfma_f32_16x16x32_bf16 a[72:75], v[48:51], v[128:131], a[72:75]
buffer_load_dwordx4 v1, s[4:7], s57 offen offset:2048 sc1 lds
v_exp_f32 v91, v91
v_mfma_f32_16x16x32_bf16 a[104:107], v[48:51], v[132:135], a[104:107]
v_exp_f32 v92, v92
v_mfma_f32_16x16x32_bf16 a[12:15], v[52:55], v[120:123], a[12:15]
ds_read_b128 v[24:27], v2 offset:28672
v_cvt_pk_bf16_f32 v113, v90, v91
v_mfma_f32_16x16x32_bf16 a[44:47], v[52:55], v[124:127], a[44:47]
v_exp_f32 v93, v93
v_mfma_f32_16x16x32_bf16 a[76:79], v[52:55], v[128:131], a[76:79]
buffer_load_dwordx4 v1, s[4:7], s57 offen offset:3072 sc1 lds
v_cvt_pk_bf16_f32 v114, v92, v93
v_mfma_f32_16x16x32_bf16 a[108:111], v[52:55], v[132:135], a[108:111]
ds_read_b128 v[28:31], v2 offset:29696
s_add_u32 s57, s57, 0x4000
v_exp_f32 v94, v94
v_mfma_f32_16x16x32_bf16 a[16:19], v[56:59], v[120:123], a[16:19]
v_exp_f32 v95, v95
v_mfma_f32_16x16x32_bf16 a[48:51], v[56:59], v[124:127], a[48:51]
s_add_u32 m0, s60, 8192
v_cvt_pk_bf16_f32 v115, v94, v95
v_mfma_f32_16x16x32_bf16 a[80:83], v[56:59], v[128:131], a[80:83]
ds_read_b128 v[32:35], v2 offset:30720
buffer_load_dwordx4 v1, s[4:7], s58 offen offset:0 sc1 lds
v_exp_f32 v96, v96
v_mfma_f32_16x16x32_bf16 a[112:115], v[56:59], v[132:135], a[112:115]
v_exp_f32 v97, v97
v_mfma_f32_16x16x32_bf16 a[20:23], v[60:63], v[120:123], a[20:23]
v_exp_f32 v98, v98
v_mfma_f32_16x16x32_bf16 a[52:55], v[60:63], v[124:127], a[52:55]
ds_read_b128 v[36:39], v2 offset:31744
v_cvt_pk_bf16_f32 v116, v96, v97
v_mfma_f32_16x16x32_bf16 a[84:87], v[60:63], v[128:131], a[84:87]
buffer_load_dwordx4 v1, s[4:7], s58 offen offset:1024 sc1 lds
v_exp_f32 v99, v99
v_mfma_f32_16x16x32_bf16 a[116:119], v[60:63], v[132:135], a[116:119]
v_exp_f32 v100, v100
v_mfma_f32_16x16x32_bf16 a[24:27], v[64:67], v[120:123], a[24:27]
v_exp_f32 v101, v101
v_mfma_f32_16x16x32_bf16 a[56:59], v[64:67], v[124:127], a[56:59]
v_cvt_pk_bf16_f32 v117, v98, v99
v_cvt_pk_bf16_f32 v118, v100, v101
v_mfma_f32_16x16x32_bf16 a[88:91], v[64:67], v[128:131], a[88:91]
buffer_load_dwordx4 v1, s[4:7], s58 offen offset:2048 sc1 lds
v_mfma_f32_16x16x32_bf16 a[120:123], v[64:67], v[132:135], a[120:123]
v_exp_f32 v102, v102
v_mfma_f32_16x16x32_bf16 a[28:31], v[68:71], v[120:123], a[28:31]
v_exp_f32 v103, v103
v_mfma_f32_16x16x32_bf16 a[60:63], v[68:71], v[124:127], a[60:63]
v_cvt_pk_bf16_f32 v119, v102, v103
v_mfma_f32_16x16x32_bf16 a[92:95], v[68:71], v[128:131], a[92:95]
buffer_load_dwordx4 v1, s[4:7], s58 offen offset:3072 sc1 lds
v_mfma_f32_16x16x32_bf16 a[124:127], v[68:71], v[132:135], a[124:127]
s_add_u32 s58, s58, 0x4000
v_mfma_f32_16x16x32_bf16 a[128:131], v[136:139], v[120:123], a[128:131]
v_mfma_f32_16x16x32_bf16 a[132:135], v[136:139], v[124:127], a[132:135]
v_mfma_f32_16x16x32_bf16 a[136:139], v[136:139], v[128:131], a[136:139]
v_mfma_f32_16x16x32_bf16 a[140:143], v[136:139], v[132:135], a[140:143]
s_waitcnt lgkmcnt(0)
v_mfma_f32_16x16x32_bf16 v[72:75], v[8:11], a[144:147], 0
ds_read_b128 v[40:43], v3 offset:16384
v_mfma_f32_16x16x32_bf16 v[72:75], v[12:15], a[148:151], v[72:75]
buffer_load_ushort v210, v238, s[24:27], s65 offen offset:16
v_mfma_f32_16x16x32_bf16 v[72:75], v[16:19], a[152:155], v[72:75]
v_mfma_f32_16x16x32_bf16 v[72:75], v[20:23], a[156:159], v[72:75]
ds_read_b128 v[44:47], v3 offset:17408
v_mfma_f32_16x16x32_bf16 v[76:79], v[24:27], a[144:147], 0
v_mfma_f32_16x16x32_bf16 v[76:79], v[28:31], a[148:151], v[76:79]
v_mfma_f32_16x16x32_bf16 v[76:79], v[32:35], a[152:155], v[76:79]
ds_read_b128 v[48:51], v3 offset:18432
v_mfma_f32_16x16x32_bf16 v[76:79], v[36:39], a[156:159], v[76:79]
buffer_load_ushort v211, v238, s[28:31], s65 offen offset:16
v_mfma_f32_16x16x32_bf16 v[80:83], v[8:11], a[160:163], 0
v_mfma_f32_16x16x32_bf16 v[80:83], v[12:15], a[164:167], v[80:83]
ds_read_b128 v[52:55], v3 offset:19456
v_mfma_f32_16x16x32_bf16 v[80:83], v[16:19], a[168:171], v[80:83]
v_mfma_f32_16x16x32_bf16 v[80:83], v[20:23], a[172:175], v[80:83]
v_mfma_f32_16x16x32_bf16 v[84:87], v[24:27], a[160:163], 0
ds_read_b128 v[56:59], v3 offset:20480
v_mfma_f32_16x16x32_bf16 v[84:87], v[28:31], a[164:167], v[84:87]
buffer_load_dwordx2 v[196:197], v237, s[16:19], s64 offen offset:2112
v_mfma_f32_16x16x32_bf16 v[84:87], v[32:35], a[168:171], v[84:87]
v_exp_f32 v72, v72
v_mfma_f32_16x16x32_bf16 v[84:87], v[36:39], a[172:175], v[84:87]
ds_read_b128 v[60:63], v3 offset:21504
v_exp_f32 v73, v73
v_mfma_f32_16x16x32_bf16 v[88:91], v[8:11], a[176:179], 0
v_exp_f32 v74, v74
v_mfma_f32_16x16x32_bf16 v[88:91], v[12:15], a[180:183], v[88:91]
v_exp_f32 v75, v75
v_mfma_f32_16x16x32_bf16 v[88:91], v[16:19], a[184:187], v[88:91]
ds_read_b128 v[64:67], v3 offset:22528
v_cvt_pk_bf16_f32 v120, v72, v73
v_mfma_f32_16x16x32_bf16 v[88:91], v[20:23], a[188:191], v[88:91]
buffer_load_dwordx2 v[198:199], v237, s[16:19], s64 offen offset:2240
v_cvt_pk_bf16_f32 v121, v74, v75
v_mfma_f32_16x16x32_bf16 v[92:95], v[24:27], a[176:179], 0
v_exp_f32 v76, v76
v_mfma_f32_16x16x32_bf16 v[92:95], v[28:31], a[180:183], v[92:95]
ds_read_b128 v[68:71], v3 offset:23552
v_exp_f32 v77, v77
v_mfma_f32_16x16x32_bf16 v[92:95], v[32:35], a[184:187], v[92:95]
v_exp_f32 v78, v78
v_mfma_f32_16x16x32_bf16 v[92:95], v[36:39], a[188:191], v[92:95]
v_exp_f32 v79, v79
v_mfma_f32_16x16x32_bf16 v[96:99], v[8:11], a[192:195], 0
v_cvt_pk_bf16_f32 v122, v76, v77
v_cvt_pk_bf16_f32 v123, v78, v79
v_mfma_f32_16x16x32_bf16 v[96:99], v[12:15], a[196:199], v[96:99]
buffer_load_dwordx2 v[200:201], v237, s[20:23], s64 offen offset:2112
v_mfma_f32_16x16x32_bf16 v[96:99], v[16:19], a[200:203], v[96:99]
v_exp_f32 v80, v80
v_mfma_f32_16x16x32_bf16 v[96:99], v[20:23], a[204:207], v[96:99]
v_exp_f32 v81, v81
v_mfma_f32_16x16x32_bf16 v[100:103], v[24:27], a[192:195], 0
v_exp_f32 v82, v82
v_mfma_f32_16x16x32_bf16 v[100:103], v[28:31], a[196:199], v[100:103]
v_exp_f32 v83, v83
v_mfma_f32_16x16x32_bf16 v[100:103], v[32:35], a[200:203], v[100:103]
buffer_load_dwordx2 v[202:203], v237, s[20:23], s64 offen offset:2240
v_cvt_pk_bf16_f32 v124, v80, v81
v_mfma_f32_16x16x32_bf16 v[100:103], v[36:39], a[204:207], v[100:103]
v_exp_f32 v84, v84
s_waitcnt vmcnt(34) lgkmcnt(0)
s_barrier
v_mfma_f32_16x16x32_bf16 a[0:3], v[40:43], v[104:107], a[0:3]
ds_read_b128 v[8:11], v2 offset:0
v_cvt_pk_bf16_f32 v125, v82, v83
v_mfma_f32_16x16x32_bf16 a[32:35], v[40:43], v[108:111], a[32:35]
s_add_u32 m0, s59, 24576
v_exp_f32 v85, v85
v_mfma_f32_16x16x32_bf16 a[64:67], v[40:43], v[112:115], a[64:67]
buffer_load_dwordx4 v1, s[4:7], s57 offen offset:0 sc1 lds
v_cvt_pk_bf16_f32 v126, v84, v85
v_mfma_f32_16x16x32_bf16 a[96:99], v[40:43], v[116:119], a[96:99]
ds_read_b128 v[12:15], v2 offset:1024
v_exp_f32 v86, v86
v_mfma_f32_16x16x32_bf16 a[4:7], v[44:47], v[104:107], a[4:7]
v_exp_f32 v87, v87
v_mfma_f32_16x16x32_bf16 a[36:39], v[44:47], v[108:111], a[36:39]
v_exp_f32 v88, v88
v_mfma_f32_16x16x32_bf16 a[68:71], v[44:47], v[112:115], a[68:71]
ds_read_b128 v[16:19], v2 offset:2048
buffer_load_dwordx4 v1, s[4:7], s57 offen offset:1024 sc1 lds
v_mfma_f32_16x16x32_bf16 a[100:103], v[44:47], v[116:119], a[100:103]
v_exp_f32 v89, v89
v_mfma_f32_16x16x32_bf16 a[8:11], v[48:51], v[104:107], a[8:11]
v_cvt_pk_bf16_f32 v127, v86, v87
v_cvt_pk_bf16_f32 v128, v88, v89
v_mfma_f32_16x16x32_bf16 a[40:43], v[48:51], v[108:111], a[40:43]
ds_read_b128 v[20:23], v2 offset:3072
v_exp_f32 v90, v90
v_mfma_f32_16x16x32_bf16 a[72:75], v[48:51], v[112:115], a[72:75]
buffer_load_dwordx4 v1, s[4:7], s57 offen offset:2048 sc1 lds
v_exp_f32 v91, v91
v_mfma_f32_16x16x32_bf16 a[104:107], v[48:51], v[116:119], a[104:107]
v_exp_f32 v92, v92
v_mfma_f32_16x16x32_bf16 a[12:15], v[52:55], v[104:107], a[12:15]
ds_read_b128 v[24:27], v2 offset:4096
v_cvt_pk_bf16_f32 v129, v90, v91
v_mfma_f32_16x16x32_bf16 a[44:47], v[52:55], v[108:111], a[44:47]
v_exp_f32 v93, v93
v_mfma_f32_16x16x32_bf16 a[76:79], v[52:55], v[112:115], a[76:79]
buffer_load_dwordx4 v1, s[4:7], s57 offen offset:3072 sc1 lds
v_cvt_pk_bf16_f32 v130, v92, v93
v_mfma_f32_16x16x32_bf16 a[108:111], v[52:55], v[116:119], a[108:111]
ds_read_b128 v[28:31], v2 offset:5120
s_add_u32 s57, s57, 0x4000
v_exp_f32 v94, v94
v_mfma_f32_16x16x32_bf16 a[16:19], v[56:59], v[104:107], a[16:19]
v_exp_f32 v95, v95
v_mfma_f32_16x16x32_bf16 a[48:51], v[56:59], v[108:111], a[48:51]
s_add_u32 m0, s60, 16384
v_cvt_pk_bf16_f32 v131, v94, v95
v_mfma_f32_16x16x32_bf16 a[80:83], v[56:59], v[112:115], a[80:83]
ds_read_b128 v[32:35], v2 offset:6144
buffer_load_dwordx4 v1, s[4:7], s58 offen offset:0 sc1 lds
v_exp_f32 v96, v96
v_mfma_f32_16x16x32_bf16 a[112:115], v[56:59], v[116:119], a[112:115]
v_exp_f32 v97, v97
v_mfma_f32_16x16x32_bf16 a[20:23], v[60:63], v[104:107], a[20:23]
v_exp_f32 v98, v98
v_mfma_f32_16x16x32_bf16 a[52:55], v[60:63], v[108:111], a[52:55]
ds_read_b128 v[36:39], v2 offset:7168
v_cvt_pk_bf16_f32 v132, v96, v97
v_mfma_f32_16x16x32_bf16 a[84:87], v[60:63], v[112:115], a[84:87]
buffer_load_dwordx4 v1, s[4:7], s58 offen offset:1024 sc1 lds
v_exp_f32 v99, v99
v_mfma_f32_16x16x32_bf16 a[116:119], v[60:63], v[116:119], a[116:119]
v_exp_f32 v100, v100
v_mfma_f32_16x16x32_bf16 a[24:27], v[64:67], v[104:107], a[24:27]
v_exp_f32 v101, v101
v_mfma_f32_16x16x32_bf16 a[56:59], v[64:67], v[108:111], a[56:59]
v_cvt_pk_bf16_f32 v133, v98, v99
v_cvt_pk_bf16_f32 v134, v100, v101
v_mfma_f32_16x16x32_bf16 a[88:91], v[64:67], v[112:115], a[88:91]
buffer_load_dwordx4 v1, s[4:7], s58 offen offset:2048 sc1 lds
v_mfma_f32_16x16x32_bf16 a[120:123], v[64:67], v[116:119], a[120:123]
v_exp_f32 v102, v102
v_mfma_f32_16x16x32_bf16 a[28:31], v[68:71], v[104:107], a[28:31]
v_exp_f32 v103, v103
v_mfma_f32_16x16x32_bf16 a[60:63], v[68:71], v[108:111], a[60:63]
v_cvt_pk_bf16_f32 v135, v102, v103
v_mfma_f32_16x16x32_bf16 a[92:95], v[68:71], v[112:115], a[92:95]
buffer_load_dwordx4 v1, s[4:7], s58 offen offset:3072 sc1 lds
v_mfma_f32_16x16x32_bf16 a[124:127], v[68:71], v[116:119], a[124:127]
s_add_u32 s58, s58, 0x4000
v_mfma_f32_16x16x32_bf16 a[128:131], v[136:139], v[104:107], a[128:131]
v_mfma_f32_16x16x32_bf16 a[132:135], v[136:139], v[108:111], a[132:135]
v_mfma_f32_16x16x32_bf16 a[136:139], v[136:139], v[112:115], a[136:139]
v_mfma_f32_16x16x32_bf16 a[140:143], v[136:139], v[116:119], a[140:143]
s_mov_b32 s62, 0x7f000000
s_mov_b32 s63, 0x7f000000
s_mov_b32 s64, 0x7f000000
s_mov_b32 s65, 0x7f000000
s_add_u32 s66, s66, 0x20000
s_lshl_b32 s68, s68, 1
s_lshl_b32 s69, s69, 1
s_or_b32 s69, s69, 1
s_add_u32 s61, s61, 1
s_cmp_lt_u32 s61, 2
s_cbranch_scc1 L_prepK
s_branch L_plain
L_proV:
s_mov_b32 s8, s84
s_and_b32 s9, s85, 0xffff
s_mov_b32 s10, 0x1000000
s_mov_b32 s11, 0x20000
s_mov_b32 s24, s86
s_and_b32 s25, s87, 0xffff
s_mov_b32 s26, 0x10000
s_mov_b32 s27, 0x20000
s_mov_b32 s28, s88
s_and_b32 s29, s89, 0xffff
s_mov_b32 s30, 0x10000
s_mov_b32 s31, 0x20000
s_lshl_b32 s72, s56, 7
s_lshl_b32 s62, s55, 20
s_lshl_b32 s73, s72, 9
s_add_u32 s62, s62, s73
s_add_u32 s63, s62, 8192
s_lshl_b32 s65, s55, 12
s_lshl_b32 s73, s72, 1
s_add_u32 s65, s65, s73
v_lshrrev_b32 v236, 2, v6
v_lshlrev_b32 v236, 5, v236
v_and_b32 v4, 1, v6
v_lshl_add_u32 v236, v4, 4, v236
v_bfe_u32 v4, v6, 1, 1
v_lshl_add_u32 v236, v4, 7, v236
v_lshl_add_u32 v236, v7, 11, v236
s_and_b32 s73, s52, 1
s_lshl_b32 s73, s73, 8
v_add_u32 v236, s73, v236
v_lshlrev_b32 v238, 3, v7
buffer_load_dwordx2 v[172:173], v238, s[24:27], s65 offen
buffer_load_dwordx2 v[174:175], v238, s[24:27], s65 offen offset:32
buffer_load_dwordx2 v[176:177], v238, s[28:31], s65 offen
buffer_load_dwordx2 v[178:179], v238, s[28:31], s65 offen offset:32
buffer_load_dwordx4 v[140:143], v236, s[8:11], s62 offen offset:0 nt
buffer_load_dwordx4 v[144:147], v236, s[8:11], s62 offen offset:512 nt
buffer_load_dwordx4 v[148:151], v236, s[8:11], s62 offen offset:1024 nt
buffer_load_dwordx4 v[152:155], v236, s[8:11], s62 offen offset:1536 nt
buffer_load_dwordx4 v[156:159], v236, s[8:11], s63 offen offset:0 nt
buffer_load_dwordx4 v[160:163], v236, s[8:11], s63 offen offset:512 nt
buffer_load_dwordx4 v[164:167], v236, s[8:11], s63 offen offset:1024 nt
buffer_load_dwordx4 v[168:171], v236, s[8:11], s63 offen offset:1536 nt
v_mov_b32 v239, v1
s_and_b32 s73, s52, 1
s_lshl_b32 s73, s73, 12
s_add_u32 s73, s73, 8192
s_and_b32 s72, s56, 1
s_lshl_b32 s72, s72, 19
s_add_u32 s66, s72, s73
s_lshr_b32 s72, s56, 1
s_lshl_b32 s72, s72, 14
s_add_u32 s66, s66, s72
s_add_u32 s62, s62, 0x4000
s_add_u32 s63, s63, 0x4000
s_add_u32 s65, s65, 64
buffer_load_dwordx2 a[32:33], v238, s[24:27], s65 offen
buffer_load_dwordx2 a[34:35], v238, s[24:27], s65 offen offset:32
buffer_load_dwordx2 a[36:37], v238, s[28:31], s65 offen
buffer_load_dwordx2 a[38:39], v238, s[28:31], s65 offen offset:32
buffer_load_dwordx4 a[0:3], v236, s[8:11], s62 offen offset:0 nt
buffer_load_dwordx4 a[4:7], v236, s[8:11], s62 offen offset:512 nt
buffer_load_dwordx4 a[8:11], v236, s[8:11], s62 offen offset:1024 nt
buffer_load_dwordx4 a[12:15], v236, s[8:11], s62 offen offset:1536 nt
buffer_load_dwordx4 a[16:19], v236, s[8:11], s63 offen offset:0 nt
buffer_load_dwordx4 a[20:23], v236, s[8:11], s63 offen offset:512 nt
buffer_load_dwordx4 a[24:27], v236, s[8:11], s63 offen offset:1024 nt
buffer_load_dwordx4 a[28:31], v236, s[8:11], s63 offen offset:1536 nt
s_add_u32 s62, s62, 0x4000
s_add_u32 s63, s63, 0x4000
s_add_u32 s65, s65, 64
s_waitcnt vmcnt(20)
v_lshlrev_b32 v180, 16, v172
v_and_b32 v181, 0xffff0000, v172
v_lshlrev_b32 v188, 16, v176
v_and_b32 v189, 0xffff0000, v176
v_lshlrev_b32 v182, 16, v173
v_and_b32 v183, 0xffff0000, v173
v_lshlrev_b32 v190, 16, v177
v_and_b32 v191, 0xffff0000, v177
v_lshlrev_b32 v184, 16, v174
v_and_b32 v185, 0xffff0000, v174
v_lshlrev_b32 v192, 16, v178
v_and_b32 v193, 0xffff0000, v178
v_lshlrev_b32 v186, 16, v175
v_and_b32 v187, 0xffff0000, v175
v_lshlrev_b32 v194, 16, v179
v_and_b32 v195, 0xffff0000, v179
v_mul_f32 v188, v188, v180
v_mul_f32 v189, v189, v181
v_mul_f32 v190, v190, v182
v_mul_f32 v191, v191, v183
v_mul_f32 v192, v192, v184
v_mul_f32 v193, v193, v185
v_mul_f32 v194, v194, v186
v_mul_f32 v195, v195, v187
s_waitcnt vmcnt(18)
v_cvt_f32_i32 v140, v140
v_cvt_f32_i32 v141, v141
v_cvt_f32_i32 v142, v142
v_cvt_f32_i32 v143, v143
v_cvt_f32_i32 v144, v144
v_cvt_f32_i32 v145, v145
v_cvt_f32_i32 v146, v146
v_cvt_f32_i32 v147, v147
v_fma_f32 v140, v140, v180, -v188
v_fma_f32 v141, v141, v180, -v188
v_fma_f32 v142, v142, v180, -v188
v_fma_f32 v143, v143, v180, -v188
v_fma_f32 v144, v144, v181, -v189
v_fma_f32 v145, v145, v181, -v189
v_fma_f32 v146, v146, v181, -v189
v_fma_f32 v147, v147, v181, -v189
v_cvt_pk_bf16_f32 v196, v140, v144
v_cvt_pk_bf16_f32 v200, v141, v145
v_cvt_pk_bf16_f32 v204, v142, v146
v_cvt_pk_bf16_f32 v208, v143, v147
s_waitcnt vmcnt(16)
v_cvt_f32_i32 v148, v148
v_cvt_f32_i32 v149, v149
v_cvt_f32_i32 v150, v150
v_cvt_f32_i32 v151, v151
v_cvt_f32_i32 v152, v152
v_cvt_f32_i32 v153, v153
v_cvt_f32_i32 v154, v154
v_cvt_f32_i32 v155, v155
v_fma_f32 v148, v148, v182, -v190
v_fma_f32 v149, v149, v182, -v190
v_fma_f32 v150, v150, v182, -v190
v_fma_f32 v151, v151, v182, -v190
v_fma_f32 v152, v152, v183, -v191
v_fma_f32 v153, v153, v183, -v191
v_fma_f32 v154, v154, v183, -v191
v_fma_f32 v155, v155, v183, -v191
v_cvt_pk_bf16_f32 v197, v148, v152
v_cvt_pk_bf16_f32 v201, v149, v153
v_cvt_pk_bf16_f32 v205, v150, v154
v_cvt_pk_bf16_f32 v209, v151, v155
s_waitcnt vmcnt(14)
v_cvt_f32_i32 v156, v156
v_cvt_f32_i32 v157, v157
v_cvt_f32_i32 v158, v158
v_cvt_f32_i32 v159, v159
v_cvt_f32_i32 v160, v160
v_cvt_f32_i32 v161, v161
v_cvt_f32_i32 v162, v162
v_cvt_f32_i32 v163, v163
v_fma_f32 v156, v156, v184, -v192
v_fma_f32 v157, v157, v184, -v192
v_fma_f32 v158, v158, v184, -v192
v_fma_f32 v159, v159, v184, -v192
v_fma_f32 v160, v160, v185, -v193
v_fma_f32 v161, v161, v185, -v193
v_fma_f32 v162, v162, v185, -v193
v_fma_f32 v163, v163, v185, -v193
v_cvt_pk_bf16_f32 v198, v156, v160
v_cvt_pk_bf16_f32 v202, v157, v161
v_cvt_pk_bf16_f32 v206, v158, v162
v_cvt_pk_bf16_f32 v210, v159, v163
s_waitcnt vmcnt(12)
v_cvt_f32_i32 v164, v164
v_cvt_f32_i32 v165, v165
v_cvt_f32_i32 v166, v166
v_cvt_f32_i32 v167, v167
v_cvt_f32_i32 v168, v168
v_cvt_f32_i32 v169, v169
v_cvt_f32_i32 v170, v170
v_cvt_f32_i32 v171, v171
v_fma_f32 v164, v164, v186, -v194
v_fma_f32 v165, v165, v186, -v194
v_fma_f32 v166, v166, v186, -v194
v_fma_f32 v167, v167, v186, -v194
v_fma_f32 v168, v168, v187, -v195
v_fma_f32 v169, v169, v187, -v195
v_fma_f32 v170, v170, v187, -v195
v_fma_f32 v171, v171, v187, -v195
v_cvt_pk_bf16_f32 v199, v164, v168
v_cvt_pk_bf16_f32 v203, v165, v169
v_cvt_pk_bf16_f32 v207, v166, v170
v_cvt_pk_bf16_f32 v211, v167, v171
buffer_store_dwordx4 v[196:199], v239, s[12:15], s66 offen offset:0 sc1
buffer_store_dwordx4 v[200:203], v239, s[12:15], s66 offen offset:1024 sc1
buffer_store_dwordx4 v[204:207], v239, s[12:15], s66 offen offset:2048 sc1
buffer_store_dwordx4 v[208:211], v239, s[12:15], s66 offen offset:3072 sc1
s_add_u32 s66, s66, 0x20000
s_mov_b32 s48, s90
s_mov_b32 s49, s91
s_mov_b32 s50, s92
s_mov_b32 s51, s93
s_mov_b32 s76, s76
s_and_b32 s77, s77, 0xffff
s_mov_b32 s78, 0x800000
s_mov_b32 s79, 0x20000
s_mov_b32 s80, s48
s_and_b32 s81, s49, 0xffff
s_mov_b32 s82, 0x80000
s_mov_b32 s83, 0x20000
s_mov_b32 s84, s50
s_and_b32 s85, s51, 0xffff
s_mov_b32 s86, 0x80000
s_mov_b32 s87, 0x20000
s_lshl_b32 s46, s56, 15
s_lshl_b32 s47, s52, 13
s_add_u32 s46, s46, s47
s_lshl_b32 s44, s55, 19
s_add_u32 s44, s44, s46
s_add_u32 s45, s44, 4096
s_add_u32 s47, s46, 4096
v_lshrrev_b32 v4, 3, v0
v_lshlrev_b32 v4, 8, v4
v_and_b32 v5, 7, v0
v_lshl_add_u32 v4, v5, 4, v4
buffer_load_dwordx4 v[8:11], v4, s[76:79], s44 offen offset:0 nt
buffer_load_dwordx4 v[12:15], v4, s[76:79], s44 offen offset:128 nt
buffer_load_dwordx4 v[16:19], v4, s[80:83], s46 offen offset:0
buffer_load_dwordx4 v[20:23], v4, s[80:83], s46 offen offset:128
buffer_load_dwordx4 v[24:27], v4, s[84:87], s46 offen offset:0
buffer_load_dwordx4 v[28:31], v4, s[84:87], s46 offen offset:128
buffer_load_dwordx4 v[32:35], v4, s[76:79], s44 offen offset:2048 nt
buffer_load_dwordx4 v[36:39], v4, s[76:79], s44 offen offset:2176 nt
buffer_load_dwordx4 v[40:43], v4, s[80:83], s46 offen offset:2048
buffer_load_dwordx4 v[44:47], v4, s[80:83], s46 offen offset:2176
buffer_load_dwordx4 v[48:51], v4, s[84:87], s46 offen offset:2048
buffer_load_dwordx4 v[52:55], v4, s[84:87], s46 offen offset:2176
buffer_load_dwordx4 v[56:59], v4, s[76:79], s45 offen offset:0 nt
buffer_load_dwordx4 v[60:63], v4, s[76:79], s45 offen offset:128 nt
buffer_load_dwordx4 v[64:67], v4, s[80:83], s47 offen offset:0
buffer_load_dwordx4 v[68:71], v4, s[80:83], s47 offen offset:128
buffer_load_dwordx4 v[72:75], v4, s[84:87], s47 offen offset:0
buffer_load_dwordx4 v[76:79], v4, s[84:87], s47 offen offset:128
buffer_load_dwordx4 v[80:83], v4, s[76:79], s45 offen offset:2048 nt
buffer_load_dwordx4 v[84:87], v4, s[76:79], s45 offen offset:2176 nt
buffer_load_dwordx4 v[88:91], v4, s[80:83], s47 offen offset:2048
buffer_load_dwordx4 v[92:95], v4, s[80:83], s47 offen offset:2176
buffer_load_dwordx4 v[96:99], v4, s[84:87], s47 offen offset:2048
buffer_load_dwordx4 v[100:103], v4, s[84:87], s47 offen offset:2176
v_bfe_u32 v5, v0, 1, 2
v_lshlrev_b32 v5, 10, v5
v_and_b32 v244, 1, v0
v_lshl_add_u32 v5, v244, 9, v5
v_lshrrev_b32 v244, 3, v0
v_lshl_add_u32 v5, v244, 4, v5
s_lshl_b32 s72, s52, 13
s_add_u32 s72, s72, 0x20000
v_add_u32 v5, s72, v5
s_waitcnt vmcnt(36)
v_accvgpr_read_b32 v172, a32
v_accvgpr_read_b32 v173, a33
v_accvgpr_read_b32 v174, a34
v_accvgpr_read_b32 v175, a35
v_accvgpr_read_b32 v176, a36
v_accvgpr_read_b32 v177, a37
v_accvgpr_read_b32 v178, a38
v_accvgpr_read_b32 v179, a39
v_lshlrev_b32 v180, 16, v172
v_and_b32 v181, 0xffff0000, v172
v_lshlrev_b32 v188, 16, v176
v_and_b32 v189, 0xffff0000, v176
v_lshlrev_b32 v182, 16, v173
v_and_b32 v183, 0xffff0000, v173
v_lshlrev_b32 v190, 16, v177
v_and_b32 v191, 0xffff0000, v177
v_lshlrev_b32 v184, 16, v174
v_and_b32 v185, 0xffff0000, v174
v_lshlrev_b32 v192, 16, v178
v_and_b32 v193, 0xffff0000, v178
v_lshlrev_b32 v186, 16, v175
v_and_b32 v187, 0xffff0000, v175
v_lshlrev_b32 v194, 16, v179
v_and_b32 v195, 0xffff0000, v179
v_mul_f32 v188, v188, v180
v_mul_f32 v189, v189, v181
v_mul_f32 v190, v190, v182
v_mul_f32 v191, v191, v183
v_mul_f32 v192, v192, v184
v_mul_f32 v193, v193, v185
v_mul_f32 v194, v194, v186
v_mul_f32 v195, v195, v187
s_waitcnt vmcnt(34)
v_accvgpr_read_b32 v140, a0
v_accvgpr_read_b32 v141, a1
v_accvgpr_read_b32 v142, a2
v_accvgpr_read_b32 v143, a3
v_accvgpr_read_b32 v144, a4
v_accvgpr_read_b32 v145, a5
v_accvgpr_read_b32 v146, a6
v_accvgpr_read_b32 v147, a7
v_cvt_f32_i32 v140, v140
v_cvt_f32_i32 v141, v141
v_cvt_f32_i32 v142, v142
v_cvt_f32_i32 v143, v143
v_cvt_f32_i32 v144, v144
v_cvt_f32_i32 v145, v145
v_cvt_f32_i32 v146, v146
v_cvt_f32_i32 v147, v147
v_fma_f32 v140, v140, v180, -v188
v_fma_f32 v141, v141, v180, -v188
v_fma_f32 v142, v142, v180, -v188
v_fma_f32 v143, v143, v180, -v188
v_fma_f32 v144, v144, v181, -v189
v_fma_f32 v145, v145, v181, -v189
v_fma_f32 v146, v146, v181, -v189
v_fma_f32 v147, v147, v181, -v189
v_cvt_pk_bf16_f32 v196, v140, v144
v_cvt_pk_bf16_f32 v200, v141, v145
v_cvt_pk_bf16_f32 v204, v142, v146
v_cvt_pk_bf16_f32 v208, v143, v147
s_waitcnt vmcnt(32)
v_accvgpr_read_b32 v148, a8
v_accvgpr_read_b32 v149, a9
v_accvgpr_read_b32 v150, a10
v_accvgpr_read_b32 v151, a11
v_accvgpr_read_b32 v152, a12
v_accvgpr_read_b32 v153, a13
v_accvgpr_read_b32 v154, a14
v_accvgpr_read_b32 v155, a15
v_cvt_f32_i32 v148, v148
v_cvt_f32_i32 v149, v149
v_cvt_f32_i32 v150, v150
v_cvt_f32_i32 v151, v151
v_cvt_f32_i32 v152, v152
v_cvt_f32_i32 v153, v153
v_cvt_f32_i32 v154, v154
v_cvt_f32_i32 v155, v155
v_fma_f32 v148, v148, v182, -v190
v_fma_f32 v149, v149, v182, -v190
v_fma_f32 v150, v150, v182, -v190
v_fma_f32 v151, v151, v182, -v190
v_fma_f32 v152, v152, v183, -v191
v_fma_f32 v153, v153, v183, -v191
v_fma_f32 v154, v154, v183, -v191
v_fma_f32 v155, v155, v183, -v191
v_cvt_pk_bf16_f32 v197, v148, v152
v_cvt_pk_bf16_f32 v201, v149, v153
v_cvt_pk_bf16_f32 v205, v150, v154
v_cvt_pk_bf16_f32 v209, v151, v155
s_waitcnt vmcnt(30)
v_accvgpr_read_b32 v156, a16
v_accvgpr_read_b32 v157, a17
v_accvgpr_read_b32 v158, a18
v_accvgpr_read_b32 v159, a19
v_accvgpr_read_b32 v160, a20
v_accvgpr_read_b32 v161, a21
v_accvgpr_read_b32 v162, a22
v_accvgpr_read_b32 v163, a23
v_cvt_f32_i32 v156, v156
v_cvt_f32_i32 v157, v157
v_cvt_f32_i32 v158, v158
v_cvt_f32_i32 v159, v159
v_cvt_f32_i32 v160, v160
v_cvt_f32_i32 v161, v161
v_cvt_f32_i32 v162, v162
v_cvt_f32_i32 v163, v163
v_fma_f32 v156, v156, v184, -v192
v_fma_f32 v157, v157, v184, -v192
v_fma_f32 v158, v158, v184, -v192
v_fma_f32 v159, v159, v184, -v192
v_fma_f32 v160, v160, v185, -v193
v_fma_f32 v161, v161, v185, -v193
v_fma_f32 v162, v162, v185, -v193
v_fma_f32 v163, v163, v185, -v193
v_cvt_pk_bf16_f32 v198, v156, v160
v_cvt_pk_bf16_f32 v202, v157, v161
v_cvt_pk_bf16_f32 v206, v158, v162
v_cvt_pk_bf16_f32 v210, v159, v163
s_waitcnt vmcnt(28)
v_accvgpr_read_b32 v164, a24
v_accvgpr_read_b32 v165, a25
v_accvgpr_read_b32 v166, a26
v_accvgpr_read_b32 v167, a27
v_accvgpr_read_b32 v168, a28
v_accvgpr_read_b32 v169, a29
v_accvgpr_read_b32 v170, a30
v_accvgpr_read_b32 v171, a31
v_cvt_f32_i32 v164, v164
v_cvt_f32_i32 v165, v165
v_cvt_f32_i32 v166, v166
v_cvt_f32_i32 v167, v167
v_cvt_f32_i32 v168, v168
v_cvt_f32_i32 v169, v169
v_cvt_f32_i32 v170, v170
v_cvt_f32_i32 v171, v171
v_fma_f32 v164, v164, v186, -v194
v_fma_f32 v165, v165, v186, -v194
v_fma_f32 v166, v166, v186, -v194
v_fma_f32 v167, v167, v186, -v194
v_fma_f32 v168, v168, v187, -v195
v_fma_f32 v169, v169, v187, -v195
v_fma_f32 v170, v170, v187, -v195
v_fma_f32 v171, v171, v187, -v195
v_cvt_pk_bf16_f32 v199, v164, v168
v_cvt_pk_bf16_f32 v203, v165, v169
v_cvt_pk_bf16_f32 v207, v166, v170
v_cvt_pk_bf16_f32 v211, v167, v171
buffer_store_dwordx4 v[196:199], v239, s[12:15], s66 offen offset:0 sc1
buffer_store_dwordx4 v[200:203], v239, s[12:15], s66 offen offset:1024 sc1
buffer_store_dwordx4 v[204:207], v239, s[12:15], s66 offen offset:2048 sc1
buffer_store_dwordx4 v[208:211], v239, s[12:15], s66 offen offset:3072 sc1
s_add_u32 s66, s66, 0x20000
v_mov_b32 v136, 0x3f803f80
v_mov_b32 v137, 0x3f803f80
v_mov_b32 v138, 0x3f803f80
v_mov_b32 v139, 0x3f803f80
v_accvgpr_write_b32 a0, 0
v_accvgpr_write_b32 a1, 0
v_accvgpr_write_b32 a2, 0
v_accvgpr_write_b32 a3, 0
v_accvgpr_write_b32 a4, 0
v_accvgpr_write_b32 a5, 0
v_accvgpr_write_b32 a6, 0
v_accvgpr_write_b32 a7, 0
v_accvgpr_write_b32 a8, 0
v_accvgpr_write_b32 a9, 0
v_accvgpr_write_b32 a10, 0
v_accvgpr_write_b32 a11, 0
v_accvgpr_write_b32 a12, 0
v_accvgpr_write_b32 a13, 0
v_accvgpr_write_b32 a14, 0
v_accvgpr_write_b32 a15, 0
v_accvgpr_write_b32 a16, 0
v_accvgpr_write_b32 a17, 0
v_accvgpr_write_b32 a18, 0
v_accvgpr_write_b32 a19, 0
v_accvgpr_write_b32 a20, 0
v_accvgpr_write_b32 a21, 0
v_accvgpr_write_b32 a22, 0
v_accvgpr_write_b32 a23, 0
v_accvgpr_write_b32 a24, 0
v_accvgpr_write_b32 a25, 0
v_accvgpr_write_b32 a26, 0
v_accvgpr_write_b32 a27, 0
v_accvgpr_write_b32 a28, 0
v_accvgpr_write_b32 a29, 0
v_accvgpr_write_b32 a30, 0
v_accvgpr_write_b32 a31, 0
v_accvgpr_write_b32 a32, 0
v_accvgpr_write_b32 a33, 0
v_accvgpr_write_b32 a34, 0
v_accvgpr_write_b32 a35, 0
v_accvgpr_write_b32 a36, 0
v_accvgpr_write_b32 a37, 0
v_accvgpr_write_b32 a38, 0
v_accvgpr_write_b32 a39, 0
v_accvgpr_write_b32 a40, 0
v_accvgpr_write_b32 a41, 0
v_accvgpr_write_b32 a42, 0
v_accvgpr_write_b32 a43, 0
v_accvgpr_write_b32 a44, 0
v_accvgpr_write_b32 a45, 0
v_accvgpr_write_b32 a46, 0
v_accvgpr_write_b32 a47, 0
v_accvgpr_write_b32 a48, 0
v_accvgpr_write_b32 a49, 0
v_accvgpr_write_b32 a50, 0
v_accvgpr_write_b32 a51, 0
v_accvgpr_write_b32 a52, 0
v_accvgpr_write_b32 a53, 0
v_accvgpr_write_b32 a54, 0
v_accvgpr_write_b32 a55, 0
v_accvgpr_write_b32 a56, 0
v_accvgpr_write_b32 a57, 0
v_accvgpr_write_b32 a58, 0
v_accvgpr_write_b32 a59, 0
v_accvgpr_write_b32 a60, 0
v_accvgpr_write_b32 a61, 0
v_accvgpr_write_b32 a62, 0
v_accvgpr_write_b32 a63, 0
v_accvgpr_write_b32 a64, 0
v_accvgpr_write_b32 a65, 0
v_accvgpr_write_b32 a66, 0
v_accvgpr_write_b32 a67, 0
v_accvgpr_write_b32 a68, 0
v_accvgpr_write_b32 a69, 0
v_accvgpr_write_b32 a70, 0
v_accvgpr_write_b32 a71, 0
v_accvgpr_write_b32 a72, 0
v_accvgpr_write_b32 a73, 0
v_accvgpr_write_b32 a74, 0
v_accvgpr_write_b32 a75, 0
v_accvgpr_write_b32 a76, 0
v_accvgpr_write_b32 a77, 0
v_accvgpr_write_b32 a78, 0
v_accvgpr_write_b32 a79, 0
v_accvgpr_write_b32 a80, 0
v_accvgpr_write_b32 a81, 0
v_accvgpr_write_b32 a82, 0
v_accvgpr_write_b32 a83, 0
v_accvgpr_write_b32 a84, 0
v_accvgpr_write_b32 a85, 0
v_accvgpr_write_b32 a86, 0
v_accvgpr_write_b32 a87, 0
v_accvgpr_write_b32 a88, 0
v_accvgpr_write_b32 a89, 0
v_accvgpr_write_b32 a90, 0
v_accvgpr_write_b32 a91, 0
v_accvgpr_write_b32 a92, 0
v_accvgpr_write_b32 a93, 0
v_accvgpr_write_b32 a94, 0
v_accvgpr_write_b32 a95, 0
v_accvgpr_write_b32 a96, 0
v_accvgpr_write_b32 a97, 0
v_accvgpr_write_b32 a98, 0
v_accvgpr_write_b32 a99, 0
v_accvgpr_write_b32 a100, 0
v_accvgpr_write_b32 a101, 0
v_accvgpr_write_b32 a102, 0
v_accvgpr_write_b32 a103, 0
v_accvgpr_write_b32 a104, 0
v_accvgpr_write_b32 a105, 0
v_accvgpr_write_b32 a106, 0
v_accvgpr_write_b32 a107, 0
v_accvgpr_write_b32 a108, 0
v_accvgpr_write_b32 a109, 0
v_accvgpr_write_b32 a110, 0
v_accvgpr_write_b32 a111, 0
v_accvgpr_write_b32 a112, 0
v_accvgpr_write_b32 a113, 0
v_accvgpr_write_b32 a114, 0
v_accvgpr_write_b32 a115, 0
v_accvgpr_write_b32 a116, 0
v_accvgpr_write_b32 a117, 0
v_accvgpr_write_b32 a118, 0
v_accvgpr_write_b32 a119, 0
v_accvgpr_write_b32 a120, 0
v_accvgpr_write_b32 a121, 0
v_accvgpr_write_b32 a122, 0
v_accvgpr_write_b32 a123, 0
v_accvgpr_write_b32 a124, 0
v_accvgpr_write_b32 a125, 0
v_accvgpr_write_b32 a126, 0
v_accvgpr_write_b32 a127, 0
v_accvgpr_write_b32 a128, 0
v_accvgpr_write_b32 a129, 0
v_accvgpr_write_b32 a130, 0
v_accvgpr_write_b32 a131, 0
v_accvgpr_write_b32 a132, 0
v_accvgpr_write_b32 a133, 0
v_accvgpr_write_b32 a134, 0
v_accvgpr_write_b32 a135, 0
v_accvgpr_write_b32 a136, 0
v_accvgpr_write_b32 a137, 0
v_accvgpr_write_b32 a138, 0
v_accvgpr_write_b32 a139, 0
v_accvgpr_write_b32 a140, 0
v_accvgpr_write_b32 a141, 0
v_accvgpr_write_b32 a142, 0
v_accvgpr_write_b32 a143, 0
s_waitcnt vmcnt(0) lgkmcnt(0)
s_barrier
v_mov_b32 v244, 3
buffer_store_byte v244, v245, s[32:35], 0 offen sc1
buffer_load_dwordx2 v[172:173], v238, s[24:27], s65 offen
buffer_load_dwordx2 v[174:175], v238, s[24:27], s65 offen offset:32
buffer_load_dwordx2 v[176:177], v238, s[28:31], s65 offen
buffer_load_dwordx2 v[178:179], v238, s[28:31], s65 offen offset:32
buffer_load_dwordx4 v[140:143], v236, s[8:11], s62 offen offset:0 nt
buffer_load_dwordx4 v[144:147], v236, s[8:11], s62 offen offset:512 nt
buffer_load_dwordx4 v[148:151], v236, s[8:11], s62 offen offset:1024 nt
buffer_load_dwordx4 v[152:155], v236, s[8:11], s62 offen offset:1536 nt
buffer_load_dwordx4 v[156:159], v236, s[8:11], s63 offen offset:0 nt
buffer_load_dwordx4 v[160:163], v236, s[8:11], s63 offen offset:512 nt
buffer_load_dwordx4 v[164:167], v236, s[8:11], s63 offen offset:1024 nt
buffer_load_dwordx4 v[168:171], v236, s[8:11], s63 offen offset:1536 nt
s_add_u32 s62, s62, 0x4000
s_add_u32 s63, s63, 0x4000
s_add_u32 s65, s65, 64
s_waitcnt vmcnt(35)
v_lshlrev_b32 v104, 16, v8
v_and_b32 v105, 0xffff0000, v8
v_lshlrev_b32 v108, 16, v12
v_and_b32 v109, 0xffff0000, v12
v_lshlrev_b32 v106, 16, v9
v_and_b32 v107, 0xffff0000, v9
v_lshlrev_b32 v110, 16, v13
v_and_b32 v111, 0xffff0000, v13
v_lshlrev_b32 v112, 16, v16
v_and_b32 v113, 0xffff0000, v16
v_lshlrev_b32 v114, 16, v17
v_and_b32 v115, 0xffff0000, v17
v_lshlrev_b32 v116, 16, v20
v_and_b32 v117, 0xffff0000, v20
v_lshlrev_b32 v118, 16, v21
v_and_b32 v119, 0xffff0000, v21
v_lshlrev_b32 v120, 16, v24
v_and_b32 v121, 0xffff0000, v24
v_lshlrev_b32 v122, 16, v25
v_and_b32 v123, 0xffff0000, v25
v_lshlrev_b32 v124, 16, v28
v_and_b32 v125, 0xffff0000, v28
v_lshlrev_b32 v126, 16, v29
v_and_b32 v127, 0xffff0000, v29
v_mul_f32 v112, v104, v112
v_mul_f32 v116, v108, v116
v_mul_f32 v113, v105, v113
v_mul_f32 v117, v109, v117
v_mul_f32 v114, v106, v114
v_mul_f32 v118, v110, v118
v_mul_f32 v115, v107, v115
v_mul_f32 v119, v111, v119
v_fma_f32 v112, -v108, v120, v112
v_fma_f32 v116, v104, v124, v116
v_fma_f32 v113, -v109, v121, v113
v_fma_f32 v117, v105, v125, v117
v_fma_f32 v114, -v110, v122, v114
v_fma_f32 v118, v106, v126, v118
v_fma_f32 v115, -v111, v123, v115
v_fma_f32 v119, v107, v127, v119
v_mul_f32 v112, 0x3e0293ee, v112
v_mul_f32 v113, 0x3e0293ee, v113
v_mul_f32 v114, 0x3e0293ee, v114
v_mul_f32 v115, 0x3e0293ee, v115
v_mul_f32 v116, 0x3e0293ee, v116
v_mul_f32 v117, 0x3e0293ee, v117
v_mul_f32 v118, 0x3e0293ee, v118
v_mul_f32 v119, 0x3e0293ee, v119
v_cvt_pk_bf16_f32 v128, v112, v113
v_cvt_pk_bf16_f32 v129, v114, v115
v_cvt_pk_bf16_f32 v130, v116, v117
v_cvt_pk_bf16_f32 v131, v118, v119
ds_write_b128 v5, v[128:131] offset:0
v_lshlrev_b32 v104, 16, v10
v_and_b32 v105, 0xffff0000, v10
v_lshlrev_b32 v108, 16, v14
v_and_b32 v109, 0xffff0000, v14
v_lshlrev_b32 v106, 16, v11
v_and_b32 v107, 0xffff0000, v11
v_lshlrev_b32 v110, 16, v15
v_and_b32 v111, 0xffff0000, v15
v_lshlrev_b32 v112, 16, v18
v_and_b32 v113, 0xffff0000, v18
v_lshlrev_b32 v114, 16, v19
v_and_b32 v115, 0xffff0000, v19
v_lshlrev_b32 v116, 16, v22
v_and_b32 v117, 0xffff0000, v22
v_lshlrev_b32 v118, 16, v23
v_and_b32 v119, 0xffff0000, v23
v_lshlrev_b32 v120, 16, v26
v_and_b32 v121, 0xffff0000, v26
v_lshlrev_b32 v122, 16, v27
v_and_b32 v123, 0xffff0000, v27
v_lshlrev_b32 v124, 16, v30
v_and_b32 v125, 0xffff0000, v30
v_lshlrev_b32 v126, 16, v31
v_and_b32 v127, 0xffff0000, v31
v_mul_f32 v112, v104, v112
v_mul_f32 v116, v108, v116
v_mul_f32 v113, v105, v113
v_mul_f32 v117, v109, v117
v_mul_f32 v114, v106, v114
v_mul_f32 v118, v110, v118
v_mul_f32 v115, v107, v115
v_mul_f32 v119, v111, v119
v_fma_f32 v112, -v108, v120, v112
v_fma_f32 v116, v104, v124, v116
v_fma_f32 v113, -v109, v121, v113
v_fma_f32 v117, v105, v125, v117
v_fma_f32 v114, -v110, v122, v114
v_fma_f32 v118, v106, v126, v118
v_fma_f32 v115, -v111, v123, v115
v_fma_f32 v119, v107, v127, v119
v_mul_f32 v112, 0x3e0293ee, v112
v_mul_f32 v113, 0x3e0293ee, v113
v_mul_f32 v114, 0x3e0293ee, v114
v_mul_f32 v115, 0x3e0293ee, v115
v_mul_f32 v116, 0x3e0293ee, v116
v_mul_f32 v117, 0x3e0293ee, v117
v_mul_f32 v118, 0x3e0293ee, v118
v_mul_f32 v119, 0x3e0293ee, v119
v_cvt_pk_bf16_f32 v132, v112, v113
v_cvt_pk_bf16_f32 v133, v114, v115
v_cvt_pk_bf16_f32 v134, v116, v117
v_cvt_pk_bf16_f32 v135, v118, v119
ds_write_b128 v5, v[132:135] offset:256
s_waitcnt vmcnt(29)
v_lshlrev_b32 v104, 16, v32
v_and_b32 v105, 0xffff0000, v32
v_lshlrev_b32 v108, 16, v36
v_and_b32 v109, 0xffff0000, v36
v_lshlrev_b32 v106, 16, v33
v_and_b32 v107, 0xffff0000, v33
v_lshlrev_b32 v110, 16, v37
v_and_b32 v111, 0xffff0000, v37
v_lshlrev_b32 v112, 16, v40
v_and_b32 v113, 0xffff0000, v40
v_lshlrev_b32 v114, 16, v41
v_and_b32 v115, 0xffff0000, v41
v_lshlrev_b32 v116, 16, v44
v_and_b32 v117, 0xffff0000, v44
v_lshlrev_b32 v118, 16, v45
v_and_b32 v119, 0xffff0000, v45
v_lshlrev_b32 v120, 16, v48
v_and_b32 v121, 0xffff0000, v48
v_lshlrev_b32 v122, 16, v49
v_and_b32 v123, 0xffff0000, v49
v_lshlrev_b32 v124, 16, v52
v_and_b32 v125, 0xffff0000, v52
v_lshlrev_b32 v126, 16, v53
v_and_b32 v127, 0xffff0000, v53
v_mul_f32 v112, v104, v112
v_mul_f32 v116, v108, v116
v_mul_f32 v113, v105, v113
v_mul_f32 v117, v109, v117
v_mul_f32 v114, v106, v114
v_mul_f32 v118, v110, v118
v_mul_f32 v115, v107, v115
v_mul_f32 v119, v111, v119
v_fma_f32 v112, -v108, v120, v112
v_fma_f32 v116, v104, v124, v116
v_fma_f32 v113, -v109, v121, v113
v_fma_f32 v117, v105, v125, v117
v_fma_f32 v114, -v110, v122, v114
v_fma_f32 v118, v106, v126, v118
v_fma_f32 v115, -v111, v123, v115
v_fma_f32 v119, v107, v127, v119
v_mul_f32 v112, 0x3e0293ee, v112
v_mul_f32 v113, 0x3e0293ee, v113
v_mul_f32 v114, 0x3e0293ee, v114
v_mul_f32 v115, 0x3e0293ee, v115
v_mul_f32 v116, 0x3e0293ee, v116
v_mul_f32 v117, 0x3e0293ee, v117
v_mul_f32 v118, 0x3e0293ee, v118
v_mul_f32 v119, 0x3e0293ee, v119
v_cvt_pk_bf16_f32 v128, v112, v113
v_cvt_pk_bf16_f32 v129, v114, v115
v_cvt_pk_bf16_f32 v130, v116, v117
v_cvt_pk_bf16_f32 v131, v118, v119
ds_write_b128 v5, v[128:131] offset:128
v_lshlrev_b32 v104, 16, v34
v_and_b32 v105, 0xffff0000, v34
v_lshlrev_b32 v108, 16, v38
v_and_b32 v109, 0xffff0000, v38
v_lshlrev_b32 v106, 16, v35
v_and_b32 v107, 0xffff0000, v35
v_lshlrev_b32 v110, 16, v39
v_and_b32 v111, 0xffff0000, v39
v_lshlrev_b32 v112, 16, v42
v_and_b32 v113, 0xffff0000, v42
v_lshlrev_b32 v114, 16, v43
v_and_b32 v115, 0xffff0000, v43
v_lshlrev_b32 v116, 16, v46
v_and_b32 v117, 0xffff0000, v46
v_lshlrev_b32 v118, 16, v47
v_and_b32 v119, 0xffff0000, v47
v_lshlrev_b32 v120, 16, v50
v_and_b32 v121, 0xffff0000, v50
v_lshlrev_b32 v122, 16, v51
v_and_b32 v123, 0xffff0000, v51
v_lshlrev_b32 v124, 16, v54
v_and_b32 v125, 0xffff0000, v54
v_lshlrev_b32 v126, 16, v55
v_and_b32 v127, 0xffff0000, v55
v_mul_f32 v112, v104, v112
v_mul_f32 v116, v108, v116
v_mul_f32 v113, v105, v113
v_mul_f32 v117, v109, v117
v_mul_f32 v114, v106, v114
v_mul_f32 v118, v110, v118
v_mul_f32 v115, v107, v115
v_mul_f32 v119, v111, v119
v_fma_f32 v112, -v108, v120, v112
v_fma_f32 v116, v104, v124, v116
v_fma_f32 v113, -v109, v121, v113
v_fma_f32 v117, v105, v125, v117
v_fma_f32 v114, -v110, v122, v114
v_fma_f32 v118, v106, v126, v118
v_fma_f32 v115, -v111, v123, v115
v_fma_f32 v119, v107, v127, v119
v_mul_f32 v112, 0x3e0293ee, v112
v_mul_f32 v113, 0x3e0293ee, v113
v_mul_f32 v114, 0x3e0293ee, v114
v_mul_f32 v115, 0x3e0293ee, v115
v_mul_f32 v116, 0x3e0293ee, v116
v_mul_f32 v117, 0x3e0293ee, v117
v_mul_f32 v118, 0x3e0293ee, v118
v_mul_f32 v119, 0x3e0293ee, v119
v_cvt_pk_bf16_f32 v132, v112, v113
v_cvt_pk_bf16_f32 v133, v114, v115
v_cvt_pk_bf16_f32 v134, v116, v117
v_cvt_pk_bf16_f32 v135, v118, v119
ds_write_b128 v5, v[132:135] offset:384
s_waitcnt vmcnt(23)
v_lshlrev_b32 v104, 16, v56
v_and_b32 v105, 0xffff0000, v56
v_lshlrev_b32 v108, 16, v60
v_and_b32 v109, 0xffff0000, v60
v_lshlrev_b32 v106, 16, v57
v_and_b32 v107, 0xffff0000, v57
v_lshlrev_b32 v110, 16, v61
v_and_b32 v111, 0xffff0000, v61
v_lshlrev_b32 v112, 16, v64
v_and_b32 v113, 0xffff0000, v64
v_lshlrev_b32 v114, 16, v65
v_and_b32 v115, 0xffff0000, v65
v_lshlrev_b32 v116, 16, v68
v_and_b32 v117, 0xffff0000, v68
v_lshlrev_b32 v118, 16, v69
v_and_b32 v119, 0xffff0000, v69
v_lshlrev_b32 v120, 16, v72
v_and_b32 v121, 0xffff0000, v72
v_lshlrev_b32 v122, 16, v73
v_and_b32 v123, 0xffff0000, v73
v_lshlrev_b32 v124, 16, v76
v_and_b32 v125, 0xffff0000, v76
v_lshlrev_b32 v126, 16, v77
v_and_b32 v127, 0xffff0000, v77
v_mul_f32 v112, v104, v112
v_mul_f32 v116, v108, v116
v_mul_f32 v113, v105, v113
v_mul_f32 v117, v109, v117
v_mul_f32 v114, v106, v114
v_mul_f32 v118, v110, v118
v_mul_f32 v115, v107, v115
v_mul_f32 v119, v111, v119
v_fma_f32 v112, -v108, v120, v112
v_fma_f32 v116, v104, v124, v116
v_fma_f32 v113, -v109, v121, v113
v_fma_f32 v117, v105, v125, v117
v_fma_f32 v114, -v110, v122, v114
v_fma_f32 v118, v106, v126, v118
v_fma_f32 v115, -v111, v123, v115
v_fma_f32 v119, v107, v127, v119
v_mul_f32 v112, 0x3e0293ee, v112
v_mul_f32 v113, 0x3e0293ee, v113
v_mul_f32 v114, 0x3e0293ee, v114
v_mul_f32 v115, 0x3e0293ee, v115
v_mul_f32 v116, 0x3e0293ee, v116
v_mul_f32 v117, 0x3e0293ee, v117
v_mul_f32 v118, 0x3e0293ee, v118
v_mul_f32 v119, 0x3e0293ee, v119
v_cvt_pk_bf16_f32 v128, v112, v113
v_cvt_pk_bf16_f32 v129, v114, v115
v_cvt_pk_bf16_f32 v130, v116, v117
v_cvt_pk_bf16_f32 v131, v118, v119
ds_write_b128 v5, v[128:131] offset:4096
v_lshlrev_b32 v104, 16, v58
v_and_b32 v105, 0xffff0000, v58
v_lshlrev_b32 v108, 16, v62
v_and_b32 v109, 0xffff0000, v62
v_lshlrev_b32 v106, 16, v59
v_and_b32 v107, 0xffff0000, v59
v_lshlrev_b32 v110, 16, v63
v_and_b32 v111, 0xffff0000, v63
v_lshlrev_b32 v112, 16, v66
v_and_b32 v113, 0xffff0000, v66
v_lshlrev_b32 v114, 16, v67
v_and_b32 v115, 0xffff0000, v67
v_lshlrev_b32 v116, 16, v70
v_and_b32 v117, 0xffff0000, v70
v_lshlrev_b32 v118, 16, v71
v_and_b32 v119, 0xffff0000, v71
v_lshlrev_b32 v120, 16, v74
v_and_b32 v121, 0xffff0000, v74
v_lshlrev_b32 v122, 16, v75
v_and_b32 v123, 0xffff0000, v75
v_lshlrev_b32 v124, 16, v78
v_and_b32 v125, 0xffff0000, v78
v_lshlrev_b32 v126, 16, v79
v_and_b32 v127, 0xffff0000, v79
v_mul_f32 v112, v104, v112
v_mul_f32 v116, v108, v116
v_mul_f32 v113, v105, v113
v_mul_f32 v117, v109, v117
v_mul_f32 v114, v106, v114
v_mul_f32 v118, v110, v118
v_mul_f32 v115, v107, v115
v_mul_f32 v119, v111, v119
v_fma_f32 v112, -v108, v120, v112
v_fma_f32 v116, v104, v124, v116
v_fma_f32 v113, -v109, v121, v113
v_fma_f32 v117, v105, v125, v117
v_fma_f32 v114, -v110, v122, v114
v_fma_f32 v118, v106, v126, v118
v_fma_f32 v115, -v111, v123, v115
v_fma_f32 v119, v107, v127, v119
v_mul_f32 v112, 0x3e0293ee, v112
v_mul_f32 v113, 0x3e0293ee, v113
v_mul_f32 v114, 0x3e0293ee, v114
v_mul_f32 v115, 0x3e0293ee, v115
v_mul_f32 v116, 0x3e0293ee, v116
v_mul_f32 v117, 0x3e0293ee, v117
v_mul_f32 v118, 0x3e0293ee, v118
v_mul_f32 v119, 0x3e0293ee, v119
v_cvt_pk_bf16_f32 v132, v112, v113
v_cvt_pk_bf16_f32 v133, v114, v115
v_cvt_pk_bf16_f32 v134, v116, v117
v_cvt_pk_bf16_f32 v135, v118, v119
ds_write_b128 v5, v[132:135] offset:4352
s_waitcnt vmcnt(17)
v_lshlrev_b32 v104, 16, v80
v_and_b32 v105, 0xffff0000, v80
v_lshlrev_b32 v108, 16, v84
v_and_b32 v109, 0xffff0000, v84
v_lshlrev_b32 v106, 16, v81
v_and_b32 v107, 0xffff0000, v81
v_lshlrev_b32 v110, 16, v85
v_and_b32 v111, 0xffff0000, v85
v_lshlrev_b32 v112, 16, v88
v_and_b32 v113, 0xffff0000, v88
v_lshlrev_b32 v114, 16, v89
v_and_b32 v115, 0xffff0000, v89
v_lshlrev_b32 v116, 16, v92
v_and_b32 v117, 0xffff0000, v92
v_lshlrev_b32 v118, 16, v93
v_and_b32 v119, 0xffff0000, v93
v_lshlrev_b32 v120, 16, v96
v_and_b32 v121, 0xffff0000, v96
v_lshlrev_b32 v122, 16, v97
v_and_b32 v123, 0xffff0000, v97
v_lshlrev_b32 v124, 16, v100
v_and_b32 v125, 0xffff0000, v100
v_lshlrev_b32 v126, 16, v101
v_and_b32 v127, 0xffff0000, v101
v_mul_f32 v112, v104, v112
v_mul_f32 v116, v108, v116
v_mul_f32 v113, v105, v113
v_mul_f32 v117, v109, v117
v_mul_f32 v114, v106, v114
v_mul_f32 v118, v110, v118
v_mul_f32 v115, v107, v115
v_mul_f32 v119, v111, v119
v_fma_f32 v112, -v108, v120, v112
v_fma_f32 v116, v104, v124, v116
v_fma_f32 v113, -v109, v121, v113
v_fma_f32 v117, v105, v125, v117
v_fma_f32 v114, -v110, v122, v114
v_fma_f32 v118, v106, v126, v118
v_fma_f32 v115, -v111, v123, v115
v_fma_f32 v119, v107, v127, v119
v_mul_f32 v112, 0x3e0293ee, v112
v_mul_f32 v113, 0x3e0293ee, v113
v_mul_f32 v114, 0x3e0293ee, v114
v_mul_f32 v115, 0x3e0293ee, v115
v_mul_f32 v116, 0x3e0293ee, v116
v_mul_f32 v117, 0x3e0293ee, v117
v_mul_f32 v118, 0x3e0293ee, v118
v_mul_f32 v119, 0x3e0293ee, v119
v_cvt_pk_bf16_f32 v128, v112, v113
v_cvt_pk_bf16_f32 v129, v114, v115
v_cvt_pk_bf16_f32 v130, v116, v117
v_cvt_pk_bf16_f32 v131, v118, v119
ds_write_b128 v5, v[128:131] offset:4224
v_lshlrev_b32 v104, 16, v82
v_and_b32 v105, 0xffff0000, v82
v_lshlrev_b32 v108, 16, v86
v_and_b32 v109, 0xffff0000, v86
v_lshlrev_b32 v106, 16, v83
v_and_b32 v107, 0xffff0000, v83
v_lshlrev_b32 v110, 16, v87
v_and_b32 v111, 0xffff0000, v87
v_lshlrev_b32 v112, 16, v90
v_and_b32 v113, 0xffff0000, v90
v_lshlrev_b32 v114, 16, v91
v_and_b32 v115, 0xffff0000, v91
v_lshlrev_b32 v116, 16, v94
v_and_b32 v117, 0xffff0000, v94
v_lshlrev_b32 v118, 16, v95
v_and_b32 v119, 0xffff0000, v95
v_lshlrev_b32 v120, 16, v98
v_and_b32 v121, 0xffff0000, v98
v_lshlrev_b32 v122, 16, v99
v_and_b32 v123, 0xffff0000, v99
v_lshlrev_b32 v124, 16, v102
v_and_b32 v125, 0xffff0000, v102
v_lshlrev_b32 v126, 16, v103
v_and_b32 v127, 0xffff0000, v103
v_mul_f32 v112, v104, v112
v_mul_f32 v116, v108, v116
v_mul_f32 v113, v105, v113
v_mul_f32 v117, v109, v117
v_mul_f32 v114, v106, v114
v_mul_f32 v118, v110, v118
v_mul_f32 v115, v107, v115
v_mul_f32 v119, v111, v119
v_fma_f32 v112, -v108, v120, v112
v_fma_f32 v116, v104, v124, v116
v_fma_f32 v113, -v109, v121, v113
v_fma_f32 v117, v105, v125, v117
v_fma_f32 v114, -v110, v122, v114
v_fma_f32 v118, v106, v126, v118
v_fma_f32 v115, -v111, v123, v115
v_fma_f32 v119, v107, v127, v119
v_mul_f32 v112, 0x3e0293ee, v112
v_mul_f32 v113, 0x3e0293ee, v113
v_mul_f32 v114, 0x3e0293ee, v114
v_mul_f32 v115, 0x3e0293ee, v115
v_mul_f32 v116, 0x3e0293ee, v116
v_mul_f32 v117, 0x3e0293ee, v117
v_mul_f32 v118, 0x3e0293ee, v118
v_mul_f32 v119, 0x3e0293ee, v119
v_cvt_pk_bf16_f32 v132, v112, v113
v_cvt_pk_bf16_f32 v133, v114, v115
v_cvt_pk_bf16_f32 v134, v116, v117
v_cvt_pk_bf16_f32 v135, v118, v119
ds_write_b128 v5, v[132:135] offset:4480
s_waitcnt lgkmcnt(0)
s_barrier
s_lshl_b32 s72, s53, 14
s_add_u32 s72, s72, 0x20000
s_lshl_b32 s73, s54, 13
s_add_u32 s44, s72, s73
s_xor_b32 s73, s73, 0x2000
s_add_u32 s45, s72, s73
v_add_u32 v4, s44, v1
v_add_u32 v5, s45, v1
ds_read_b128 a[144:147], v4 offset:0
ds_read_b128 a[148:151], v4 offset:1024
ds_read_b128 a[152:155], v4 offset:2048
ds_read_b128 a[156:159], v4 offset:3072
ds_read_b128 a[160:163], v4 offset:4096
ds_read_b128 a[164:167], v4 offset:5120
ds_read_b128 a[168:171], v4 offset:6144
ds_read_b128 a[172:175], v4 offset:7168
ds_read_b128 a[176:179], v5 offset:0
ds_read_b128 a[180:183], v5 offset:1024
ds_read_b128 a[184:187], v5 offset:2048
ds_read_b128 a[188:191], v5 offset:3072
ds_read_b128 a[192:195], v5 offset:4096
ds_read_b128 a[196:199], v5 offset:5120
ds_read_b128 a[200:203], v5 offset:6144
ds_read_b128 a[204:207], v5 offset:7168
v_mov_b32 v120, 0
v_mov_b32 v121, 0
v_mov_b32 v122, 0
v_mov_b32 v123, 0
v_mov_b32 v124, 0
v_mov_b32 v125, 0
v_mov_b32 v126, 0
v_mov_b32 v127, 0
v_mov_b32 v128, 0
v_mov_b32 v129, 0
v_mov_b32 v130, 0
v_mov_b32 v131, 0
v_mov_b32 v132, 0
v_mov_b32 v133, 0
v_mov_b32 v134, 0
v_mov_b32 v135, 0
s_lshl_b32 s72, s53, 12
v_add_u32 v4, s72, v3
ds_write_b128 v4, v[120:123] offset:24576
ds_write_b128 v4, v[120:123] offset:25600
ds_write_b128 v4, v[120:123] offset:26624
ds_write_b128 v4, v[120:123] offset:27648
s_cmp_eq_u32 s52, 3
s_cselect_b32 s70, s70, 0x7f000000
s_cselect_b32 s68, 0x03030303, 0
s_cbranch_scc0 L_back_pV
s_branch L_spin_pV
L_back_pV:
s_and_b32 s68, s68, 0x02020202
s_barrier
s_mov_b32 m0, s59
s_nop 0
buffer_load_dwordx4 v1, s[4:7], s57 offen offset:0 sc1 lds
buffer_load_dwordx4 v1, s[4:7], s57 offen offset:1024 sc1 lds
buffer_load_dwordx4 v1, s[4:7], s57 offen offset:2048 sc1 lds
buffer_load_dwordx4 v1, s[4:7], s57 offen offset:3072 sc1 lds
s_add_u32 s57, s57, 0x4000
s_add_u32 m0, s59, 8192
s_nop 0
buffer_load_dwordx4 v1, s[4:7], s57 offen offset:0 sc1 lds
buffer_load_dwordx4 v1, s[4:7], s57 offen offset:1024 sc1 lds
buffer_load_dwordx4 v1, s[4:7], s57 offen offset:2048 sc1 lds
buffer_load_dwordx4 v1, s[4:7], s57 offen offset:3072 sc1 lds
s_add_u32 m0, s60, 0
s_nop 0
buffer_load_dwordx4 v1, s[4:7], s58 offen offset:0 sc1 lds
buffer_load_dwordx4 v1, s[4:7], s58 offen offset:1024 sc1 lds
buffer_load_dwordx4 v1, s[4:7], s58 offen offset:2048 sc1 lds
buffer_load_dwordx4 v1, s[4:7], s58 offen offset:3072 sc1 lds
s_add_u32 s58, s58, 0x4000
s_add_u32 s57, s57, 0x4000
s_add_u32 m0, s59, 16384
s_nop 0
buffer_load_dwordx4 v1, s[4:7], s57 offen offset:0 sc1 lds
buffer_load_dwordx4 v1, s[4:7], s57 offen offset:1024 sc1 lds
buffer_load_dwordx4 v1, s[4:7], s57 offen offset:2048 sc1 lds
buffer_load_dwordx4 v1, s[4:7], s57 offen offset:3072 sc1 lds
s_add_u32 m0, s60, 8192
s_nop 0
buffer_load_dwordx4 v1, s[4:7], s58 offen offset:0 sc1 lds
buffer_load_dwordx4 v1, s[4:7], s58 offen offset:1024 sc1 lds
buffer_load_dwordx4 v1, s[4:7], s58 offen offset:2048 sc1 lds
buffer_load_dwordx4 v1, s[4:7], s58 offen offset:3072 sc1 lds
s_add_u32 s58, s58, 0x4000
s_add_u32 s57, s57, 0x4000
s_add_u32 m0, s59, 24576
s_nop 0
buffer_load_dwordx4 v1, s[4:7], s57 offen offset:0 sc1 lds
buffer_load_dwordx4 v1, s[4:7], s57 offen offset:1024 sc1 lds
buffer_load_dwordx4 v1, s[4:7], s57 offen offset:2048 sc1 lds
buffer_load_dwordx4 v1, s[4:7], s57 offen offset:3072 sc1 lds
s_add_u32 m0, s60, 16384
s_nop 0
buffer_load_dwordx4 v1, s[4:7], s58 offen offset:0 sc1 lds
buffer_load_dwordx4 v1, s[4:7], s58 offen offset:1024 sc1 lds
buffer_load_dwordx4 v1, s[4:7], s58 offen offset:2048 sc1 lds
buffer_load_dwordx4 v1, s[4:7], s58 offen offset:3072 sc1 lds
s_add_u32 s58, s58, 0x4000
s_add_u32 s57, s57, 0x4000
s_waitcnt vmcnt(24) lgkmcnt(0)
s_barrier
ds_read_b128 v[8:11], v2 offset:0
ds_read_b128 v[12:15], v2 offset:1024
ds_read_b128 v[16:19], v2 offset:2048
ds_read_b128 v[20:23], v2 offset:3072
ds_read_b128 v[24:27], v2 offset:4096
ds_read_b128 v[28:31], v2 offset:5120
ds_read_b128 v[32:35], v2 offset:6144
ds_read_b128 v[36:39], v2 offset:7168
s_mov_b32 s61, 0
s_mov_b32 s69, 3
s_mov_b32 s71, 0
.p2align 6
L_prepV:
s_waitcnt lgkmcnt(0)
v_mfma_f32_16x16x32_bf16 v[72:75], v[8:11], a[144:147], 0
ds_read_b128 v[40:43], v3 offset:24576
s_waitcnt vmcnt(36)
v_mfma_f32_16x16x32_bf16 v[72:75], v[12:15], a[148:151], v[72:75]
v_lshlrev_b32 v180, 16, v172
v_and_b32 v181, 0xffff0000, v172
v_mfma_f32_16x16x32_bf16 v[72:75], v[16:19], a[152:155], v[72:75]
v_lshlrev_b32 v188, 16, v176
v_and_b32 v189, 0xffff0000, v176
v_mfma_f32_16x16x32_bf16 v[72:75], v[20:23], a[156:159], v[72:75]
ds_read_b128 v[44:47], v3 offset:25600
v_lshlrev_b32 v182, 16, v173
v_mfma_f32_16x16x32_bf16 v[76:79], v[24:27], a[144:147], 0
v_and_b32 v183, 0xffff0000, v173
v_lshlrev_b32 v190, 16, v177
v_mfma_f32_16x16x32_bf16 v[76:79], v[28:31], a[148:151], v[76:79]
v_and_b32 v191, 0xffff0000, v177
v_lshlrev_b32 v184, 16, v174
v_mfma_f32_16x16x32_bf16 v[76:79], v[32:35], a[152:155], v[76:79]
ds_read_b128 v[48:51], v3 offset:26624
v_and_b32 v185, 0xffff0000, v174
v_mfma_f32_16x16x32_bf16 v[76:79], v[36:39], a[156:159], v[76:79]
v_lshlrev_b32 v192, 16, v178
v_and_b32 v193, 0xffff0000, v178
v_mfma_f32_16x16x32_bf16 v[80:83], v[8:11], a[160:163], 0
v_lshlrev_b32 v186, 16, v175
v_and_b32 v187, 0xffff0000, v175
v_mfma_f32_16x16x32_bf16 v[80:83], v[12:15], a[164:167], v[80:83]
ds_read_b128 v[52:55], v3 offset:27648
v_lshlrev_b32 v194, 16, v179
v_mfma_f32_16x16x32_bf16 v[80:83], v[16:19], a[168:171], v[80:83]
v_exp_f32 v72, v72
v_mfma_f32_16x16x32_bf16 v[80:83], v[20:23], a[172:175], v[80:83]
v_exp_f32 v73, v73
v_mfma_f32_16x16x32_bf16 v[84:87], v[24:27], a[160:163], 0
ds_read_b128 v[56:59], v3 offset:28672
v_cvt_pk_bf16_f32 v104, v72, v73
v_mfma_f32_16x16x32_bf16 v[84:87], v[28:31], a[164:167], v[84:87]
v_exp_f32 v74, v74
v_mfma_f32_16x16x32_bf16 v[84:87], v[32:35], a[168:171], v[84:87]
v_exp_f32 v75, v75
v_mfma_f32_16x16x32_bf16 v[84:87], v[36:39], a[172:175], v[84:87]
ds_read_b128 v[60:63], v3 offset:29696
v_cvt_pk_bf16_f32 v105, v74, v75
v_mfma_f32_16x16x32_bf16 v[88:91], v[8:11], a[176:179], 0
v_exp_f32 v76, v76
v_mfma_f32_16x16x32_bf16 v[88:91], v[12:15], a[180:183], v[88:91]
v_exp_f32 v77, v77
v_mfma_f32_16x16x32_bf16 v[88:91], v[16:19], a[184:187], v[88:91]
ds_read_b128 v[64:67], v3 offset:30720
v_cvt_pk_bf16_f32 v106, v76, v77
v_mfma_f32_16x16x32_bf16 v[88:91], v[20:23], a[188:191], v[88:91]
v_exp_f32 v78, v78
v_mfma_f32_16x16x32_bf16 v[92:95], v[24:27], a[176:179], 0
v_exp_f32 v79, v79
v_mfma_f32_16x16x32_bf16 v[92:95], v[28:31], a[180:183], v[92:95]
ds_read_b128 v[68:71], v3 offset:31744
v_cvt_pk_bf16_f32 v107, v78, v79
v_mfma_f32_16x16x32_bf16 v[92:95], v[32:35], a[184:187], v[92:95]
v_exp_f32 v80, v80
v_mfma_f32_16x16x32_bf16 v[92:95], v[36:39], a[188:191], v[92:95]
v_exp_f32 v81, v81
v_mfma_f32_16x16x32_bf16 v[96:99], v[8:11], a[192:195], 0
v_exp_f32 v82, v82
v_mfma_f32_16x16x32_bf16 v[96:99], v[12:15], a[196:199], v[96:99]
v_exp_f32 v83, v83
v_mfma_f32_16x16x32_bf16 v[96:99], v[16:19], a[200:203], v[96:99]
v_cvt_pk_bf16_f32 v108, v80, v81
v_cvt_pk_bf16_f32 v109, v82, v83
v_mfma_f32_16x16x32_bf16 v[96:99], v[20:23], a[204:207], v[96:99]
v_exp_f32 v84, v84
v_mfma_f32_16x16x32_bf16 v[100:103], v[24:27], a[192:195], 0
v_exp_f32 v85, v85
v_mfma_f32_16x16x32_bf16 v[100:103], v[28:31], a[196:199], v[100:103]
v_exp_f32 v86, v86
v_mfma_f32_16x16x32_bf16 v[100:103], v[32:35], a[200:203], v[100:103]
v_exp_f32 v87, v87
v_mfma_f32_16x16x32_bf16 v[100:103], v[36:39], a[204:207], v[100:103]
v_cvt_pk_bf16_f32 v110, v84, v85
v_cvt_pk_bf16_f32 v111, v86, v87
s_waitcnt vmcnt(16) lgkmcnt(0)
s_barrier
v_mfma_f32_16x16x32_bf16 a[0:3], v[40:43], v[120:123], a[0:3]
ds_read_b128 v[8:11], v2 offset:8192
v_and_b32 v195, 0xffff0000, v179
v_mfma_f32_16x16x32_bf16 a[32:35], v[40:43], v[124:127], a[32:35]
s_add_u32 m0, s59, 0
v_mul_f32 v188, v188, v180
v_mfma_f32_16x16x32_bf16 a[64:67], v[40:43], v[128:131], a[64:67]
buffer_load_dwordx4 v1, s[4:7], s57 offen offset:0 sc1 lds
v_mul_f32 v189, v189, v181
v_mfma_f32_16x16x32_bf16 a[96:99], v[40:43], v[132:135], a[96:99]
ds_read_b128 v[12:15], v2 offset:9216
v_mul_f32 v190, v190, v182
v_mfma_f32_16x16x32_bf16 a[4:7], v[44:47], v[120:123], a[4:7]
v_mov_b32 v244, s69
v_mul_f32 v191, v191, v183
v_mfma_f32_16x16x32_bf16 a[36:39], v[44:47], v[124:127], a[36:39]
buffer_store_byte v244, v245, s[32:35], 0 offen sc1
v_mul_f32 v192, v192, v184
v_mfma_f32_16x16x32_bf16 a[68:71], v[44:47], v[128:131], a[68:71]
ds_read_b128 v[16:19], v2 offset:10240
buffer_load_dwordx4 v1, s[4:7], s57 offen offset:1024 sc1 lds
v_exp_f32 v88, v88
v_mfma_f32_16x16x32_bf16 a[100:103], v[44:47], v[132:135], a[100:103]
v_exp_f32 v89, v89
v_mfma_f32_16x16x32_bf16 a[8:11], v[48:51], v[120:123], a[8:11]
v_exp_f32 v90, v90
v_mfma_f32_16x16x32_bf16 a[40:43], v[48:51], v[124:127], a[40:43]
ds_read_b128 v[20:23], v2 offset:11264
v_cvt_pk_bf16_f32 v112, v88, v89
v_mfma_f32_16x16x32_bf16 a[72:75], v[48:51], v[128:131], a[72:75]
buffer_load_dwordx4 v1, s[4:7], s57 offen offset:2048 sc1 lds
v_mul_f32 v193, v193, v185
v_exp_f32 v91, v91
v_mfma_f32_16x16x32_bf16 a[104:107], v[48:51], v[132:135], a[104:107]
v_exp_f32 v92, v92
v_mfma_f32_16x16x32_bf16 a[12:15], v[52:55], v[120:123], a[12:15]
ds_read_b128 v[24:27], v2 offset:12288
v_cvt_pk_bf16_f32 v113, v90, v91
v_mfma_f32_16x16x32_bf16 a[44:47], v[52:55], v[124:127], a[44:47]
v_exp_f32 v93, v93
v_mfma_f32_16x16x32_bf16 a[76:79], v[52:55], v[128:131], a[76:79]
buffer_load_dwordx4 v1, s[4:7], s57 offen offset:3072 sc1 lds
v_cvt_pk_bf16_f32 v114, v92, v93
v_mfma_f32_16x16x32_bf16 a[108:111], v[52:55], v[132:135], a[108:111]
ds_read_b128 v[28:31], v2 offset:13312
s_add_u32 s57, s57, 0x4000
v_exp_f32 v94, v94
v_mfma_f32_16x16x32_bf16 a[16:19], v[56:59], v[120:123], a[16:19]
v_exp_f32 v95, v95
v_mfma_f32_16x16x32_bf16 a[48:51], v[56:59], v[124:127], a[48:51]
s_add_u32 m0, s60, 24576
v_cvt_pk_bf16_f32 v115, v94, v95
v_mfma_f32_16x16x32_bf16 a[80:83], v[56:59], v[128:131], a[80:83]
ds_read_b128 v[32:35], v2 offset:14336
buffer_load_dwordx4 v1, s[4:7], s58 offen offset:0 sc1 lds
v_exp_f32 v96, v96
v_mfma_f32_16x16x32_bf16 a[112:115], v[56:59], v[132:135], a[112:115]
v_exp_f32 v97, v97
v_mfma_f32_16x16x32_bf16 a[20:23], v[60:63], v[120:123], a[20:23]
v_exp_f32 v98, v98
v_mfma_f32_16x16x32_bf16 a[52:55], v[60:63], v[124:127], a[52:55]
ds_read_b128 v[36:39], v2 offset:15360
v_cvt_pk_bf16_f32 v116, v96, v97
v_mfma_f32_16x16x32_bf16 a[84:87], v[60:63], v[128:131], a[84:87]
buffer_load_dwordx4 v1, s[4:7], s58 offen offset:1024 sc1 lds
v_mul_f32 v194, v194, v186
v_exp_f32 v99, v99
v_mfma_f32_16x16x32_bf16 a[116:119], v[60:63], v[132:135], a[116:119]
v_exp_f32 v100, v100
v_mfma_f32_16x16x32_bf16 a[24:27], v[64:67], v[120:123], a[24:27]
v_exp_f32 v101, v101
v_mfma_f32_16x16x32_bf16 a[56:59], v[64:67], v[124:127], a[56:59]
v_cvt_pk_bf16_f32 v117, v98, v99
v_cvt_pk_bf16_f32 v118, v100, v101
v_mfma_f32_16x16x32_bf16 a[88:91], v[64:67], v[128:131], a[88:91]
buffer_load_dwordx4 v1, s[4:7], s58 offen offset:2048 sc1 lds
v_mul_f32 v195, v195, v187
v_mfma_f32_16x16x32_bf16 a[120:123], v[64:67], v[132:135], a[120:123]
v_exp_f32 v102, v102
v_mfma_f32_16x16x32_bf16 a[28:31], v[68:71], v[120:123], a[28:31]
v_exp_f32 v103, v103
v_mfma_f32_16x16x32_bf16 a[60:63], v[68:71], v[124:127], a[60:63]
v_cvt_pk_bf16_f32 v119, v102, v103
s_waitcnt vmcnt(42)
v_mfma_f32_16x16x32_bf16 a[92:95], v[68:71], v[128:131], a[92:95]
buffer_load_dwordx4 v1, s[4:7], s58 offen offset:3072 sc1 lds
v_cvt_f32_i32 v140, v140
v_mfma_f32_16x16x32_bf16 a[124:127], v[68:71], v[132:135], a[124:127]
s_add_u32 s58, s58, 0x4000
v_mfma_f32_16x16x32_bf16 a[128:131], v[136:139], v[120:123], a[128:131]
v_mfma_f32_16x16x32_bf16 a[132:135], v[136:139], v[124:127], a[132:135]
v_mfma_f32_16x16x32_bf16 a[136:139], v[136:139], v[128:131], a[136:139]
v_mfma_f32_16x16x32_bf16 a[140:143], v[136:139], v[132:135], a[140:143]
s_waitcnt lgkmcnt(0)
v_mfma_f32_16x16x32_bf16 v[72:75], v[8:11], a[144:147], 0
ds_read_b128 v[40:43], v3 offset:0
v_cvt_f32_i32 v141, v141
v_mfma_f32_16x16x32_bf16 v[72:75], v[12:15], a[148:151], v[72:75]
buffer_load_dwordx2 v[172:173], v238, s[24:27], s65 offen
v_cvt_f32_i32 v142, v142
v_mfma_f32_16x16x32_bf16 v[72:75], v[16:19], a[152:155], v[72:75]
v_cvt_f32_i32 v143, v143
v_cvt_f32_i32 v144, v144
v_mfma_f32_16x16x32_bf16 v[72:75], v[20:23], a[156:159], v[72:75]
ds_read_b128 v[44:47], v3 offset:1024
v_cvt_f32_i32 v145, v145
v_mfma_f32_16x16x32_bf16 v[76:79], v[24:27], a[144:147], 0
v_cvt_f32_i32 v146, v146
v_cvt_f32_i32 v147, v147
v_mfma_f32_16x16x32_bf16 v[76:79], v[28:31], a[148:151], v[76:79]
v_fma_f32 v140, v140, v180, -v188
v_fma_f32 v141, v141, v180, -v188
v_mfma_f32_16x16x32_bf16 v[76:79], v[32:35], a[152:155], v[76:79]
ds_read_b128 v[48:51], v3 offset:2048
v_fma_f32 v142, v142, v180, -v188
v_mfma_f32_16x16x32_bf16 v[76:79], v[36:39], a[156:159], v[76:79]
buffer_load_dwordx2 v[174:175], v238, s[24:27], s65 offen offset:32
v_fma_f32 v143, v143, v180, -v188
v_mfma_f32_16x16x32_bf16 v[80:83], v[8:11], a[160:163], 0
v_fma_f32 v144, v144, v181, -v189
v_fma_f32 v145, v145, v181, -v189
v_mfma_f32_16x16x32_bf16 v[80:83], v[12:15], a[164:167], v[80:83]
ds_read_b128 v[52:55], v3 offset:3072
v_fma_f32 v146, v146, v181, -v189
v_mfma_f32_16x16x32_bf16 v[80:83], v[16:19], a[168:171], v[80:83]
v_exp_f32 v72, v72
v_mfma_f32_16x16x32_bf16 v[80:83], v[20:23], a[172:175], v[80:83]
v_exp_f32 v73, v73
v_mfma_f32_16x16x32_bf16 v[84:87], v[24:27], a[160:163], 0
ds_read_b128 v[56:59], v3 offset:4096
v_cvt_pk_bf16_f32 v120, v72, v73
v_mfma_f32_16x16x32_bf16 v[84:87], v[28:31], a[164:167], v[84:87]
buffer_load_dwordx2 v[176:177], v238, s[28:31], s65 offen
v_fma_f32 v147, v147, v181, -v189
v_mfma_f32_16x16x32_bf16 v[84:87], v[32:35], a[168:171], v[84:87]
v_exp_f32 v74, v74
v_mfma_f32_16x16x32_bf16 v[84:87], v[36:39], a[172:175], v[84:87]
ds_read_b128 v[60:63], v3 offset:5120
v_cvt_pk_bf16_f32 v196, v140, v144
v_mfma_f32_16x16x32_bf16 v[88:91], v[8:11], a[176:179], 0
v_exp_f32 v75, v75
v_mfma_f32_16x16x32_bf16 v[88:91], v[12:15], a[180:183], v[88:91]
v_exp_f32 v76, v76
v_mfma_f32_16x16x32_bf16 v[88:91], v[16:19], a[184:187], v[88:91]
ds_read_b128 v[64:67], v3 offset:6144
v_cvt_pk_bf16_f32 v121, v74, v75
v_mfma_f32_16x16x32_bf16 v[88:91], v[20:23], a[188:191], v[88:91]
buffer_load_dwordx2 v[178:179], v238, s[28:31], s65 offen offset:32
v_cvt_pk_bf16_f32 v200, v141, v145
v_mfma_f32_16x16x32_bf16 v[92:95], v[24:27], a[176:179], 0
v_exp_f32 v77, v77
v_mfma_f32_16x16x32_bf16 v[92:95], v[28:31], a[180:183], v[92:95]
ds_read_b128 v[68:71], v3 offset:7168
v_cvt_pk_bf16_f32 v122, v76, v77
v_mfma_f32_16x16x32_bf16 v[92:95], v[32:35], a[184:187], v[92:95]
v_exp_f32 v78, v78
v_mfma_f32_16x16x32_bf16 v[92:95], v[36:39], a[188:191], v[92:95]
v_exp_f32 v79, v79
v_mfma_f32_16x16x32_bf16 v[96:99], v[8:11], a[192:195], 0
v_exp_f32 v80, v80
v_mfma_f32_16x16x32_bf16 v[96:99], v[12:15], a[196:199], v[96:99]
v_exp_f32 v81, v81
v_mfma_f32_16x16x32_bf16 v[96:99], v[16:19], a[200:203], v[96:99]
v_cvt_pk_bf16_f32 v123, v78, v79
v_cvt_pk_bf16_f32 v124, v80, v81
v_mfma_f32_16x16x32_bf16 v[96:99], v[20:23], a[204:207], v[96:99]
v_exp_f32 v82, v82
v_mfma_f32_16x16x32_bf16 v[100:103], v[24:27], a[192:195], 0
v_exp_f32 v83, v83
v_mfma_f32_16x16x32_bf16 v[100:103], v[28:31], a[196:199], v[100:103]
v_exp_f32 v84, v84
v_mfma_f32_16x16x32_bf16 v[100:103], v[32:35], a[200:203], v[100:103]
v_exp_f32 v85, v85
v_mfma_f32_16x16x32_bf16 v[100:103], v[36:39], a[204:207], v[100:103]
v_cvt_pk_bf16_f32 v125, v82, v83
v_cvt_pk_bf16_f32 v126, v84, v85
s_waitcnt vmcnt(21) lgkmcnt(0)
s_barrier
v_mfma_f32_16x16x32_bf16 a[0:3], v[40:43], v[104:107], a[0:3]
ds_read_b128 v[8:11], v2 offset:16384
v_cvt_pk_bf16_f32 v204, v142, v146
v_mfma_f32_16x16x32_bf16 a[32:35], v[40:43], v[108:111], a[32:35]
s_add_u32 m0, s59, 8192
v_cvt_pk_bf16_f32 v208, v143, v147
v_mfma_f32_16x16x32_bf16 a[64:67], v[40:43], v[112:115], a[64:67]
buffer_load_dwordx4 v1, s[4:7], s57 offen offset:0 sc1 lds
s_waitcnt vmcnt(46)
v_mfma_f32_16x16x32_bf16 a[96:99], v[40:43], v[116:119], a[96:99]
ds_read_b128 v[12:15], v2 offset:17408
v_cvt_f32_i32 v148, v148
v_exp_f32 v86, v86
v_mfma_f32_16x16x32_bf16 a[4:7], v[44:47], v[104:107], a[4:7]
v_exp_f32 v87, v87
v_mfma_f32_16x16x32_bf16 a[36:39], v[44:47], v[108:111], a[36:39]
v_exp_f32 v88, v88
v_mfma_f32_16x16x32_bf16 a[68:71], v[44:47], v[112:115], a[68:71]
ds_read_b128 v[16:19], v2 offset:18432
buffer_load_dwordx4 v1, s[4:7], s57 offen offset:1024 sc1 lds
v_mfma_f32_16x16x32_bf16 a[100:103], v[44:47], v[116:119], a[100:103]
v_exp_f32 v89, v89
v_mfma_f32_16x16x32_bf16 a[8:11], v[48:51], v[104:107], a[8:11]
v_cvt_pk_bf16_f32 v127, v86, v87
v_cvt_pk_bf16_f32 v128, v88, v89
v_mfma_f32_16x16x32_bf16 a[40:43], v[48:51], v[108:111], a[40:43]
ds_read_b128 v[20:23], v2 offset:19456
v_cvt_f32_i32 v149, v149
v_exp_f32 v90, v90
v_mfma_f32_16x16x32_bf16 a[72:75], v[48:51], v[112:115], a[72:75]
buffer_load_dwordx4 v1, s[4:7], s57 offen offset:2048 sc1 lds
v_cvt_f32_i32 v150, v150
v_exp_f32 v91, v91
v_mfma_f32_16x16x32_bf16 a[104:107], v[48:51], v[116:119], a[104:107]
v_exp_f32 v92, v92
v_mfma_f32_16x16x32_bf16 a[12:15], v[52:55], v[104:107], a[12:15]
ds_read_b128 v[24:27], v2 offset:20480
v_cvt_pk_bf16_f32 v129, v90, v91
v_mfma_f32_16x16x32_bf16 a[44:47], v[52:55], v[108:111], a[44:47]
v_exp_f32 v93, v93
v_mfma_f32_16x16x32_bf16 a[76:79], v[52:55], v[112:115], a[76:79]
buffer_load_dwordx4 v1, s[4:7], s57 offen offset:3072 sc1 lds
v_cvt_pk_bf16_f32 v130, v92, v93
v_mfma_f32_16x16x32_bf16 a[108:111], v[52:55], v[116:119], a[108:111]
ds_read_b128 v[28:31], v2 offset:21504
s_add_u32 s57, s57, 0x4000
v_exp_f32 v94, v94
v_mfma_f32_16x16x32_bf16 a[16:19], v[56:59], v[104:107], a[16:19]
v_exp_f32 v95, v95
v_mfma_f32_16x16x32_bf16 a[48:51], v[56:59], v[108:111], a[48:51]
s_add_u32 m0, s60, 0
v_cvt_pk_bf16_f32 v131, v94, v95
v_mfma_f32_16x16x32_bf16 a[80:83], v[56:59], v[112:115], a[80:83]
ds_read_b128 v[32:35], v2 offset:22528
buffer_load_dwordx4 v1, s[4:7], s58 offen offset:0 sc1 lds
v_exp_f32 v96, v96
v_mfma_f32_16x16x32_bf16 a[112:115], v[56:59], v[116:119], a[112:115]
v_exp_f32 v97, v97
v_mfma_f32_16x16x32_bf16 a[20:23], v[60:63], v[104:107], a[20:23]
v_exp_f32 v98, v98
v_mfma_f32_16x16x32_bf16 a[52:55], v[60:63], v[108:111], a[52:55]
ds_read_b128 v[36:39], v2 offset:23552
v_cvt_pk_bf16_f32 v132, v96, v97
v_cvt_f32_i32 v151, v151
v_mfma_f32_16x16x32_bf16 a[84:87], v[60:63], v[112:115], a[84:87]
buffer_load_dwordx4 v1, s[4:7], s58 offen offset:1024 sc1 lds
v_cvt_f32_i32 v152, v152
v_exp_f32 v99, v99
v_mfma_f32_16x16x32_bf16 a[116:119], v[60:63], v[116:119], a[116:119]
v_exp_f32 v100, v100
v_mfma_f32_16x16x32_bf16 a[24:27], v[64:67], v[104:107], a[24:27]
v_exp_f32 v101, v101
v_mfma_f32_16x16x32_bf16 a[56:59], v[64:67], v[108:111], a[56:59]
v_cvt_pk_bf16_f32 v133, v98, v99
v_cvt_pk_bf16_f32 v134, v100, v101
v_mfma_f32_16x16x32_bf16 a[88:91], v[64:67], v[112:115], a[88:91]
buffer_load_dwordx4 v1, s[4:7], s58 offen offset:2048 sc1 lds
v_cvt_f32_i32 v153, v153
v_mfma_f32_16x16x32_bf16 a[120:123], v[64:67], v[116:119], a[120:123]
v_exp_f32 v102, v102
v_mfma_f32_16x16x32_bf16 a[28:31], v[68:71], v[104:107], a[28:31]
v_exp_f32 v103, v103
v_cvt_f32_i32 v154, v154
v_mfma_f32_16x16x32_bf16 a[60:63], v[68:71], v[108:111], a[60:63]
v_cvt_pk_bf16_f32 v135, v102, v103
v_cvt_f32_i32 v155, v155
v_mfma_f32_16x16x32_bf16 a[92:95], v[68:71], v[112:115], a[92:95]
buffer_load_dwordx4 v1, s[4:7], s58 offen offset:3072 sc1 lds
v_fma_f32 v148, v148, v182, -v190
v_mfma_f32_16x16x32_bf16 a[124:127], v[68:71], v[116:119], a[124:127]
s_add_u32 s58, s58, 0x4000
v_mfma_f32_16x16x32_bf16 a[128:131], v[136:139], v[104:107], a[128:131]
v_mfma_f32_16x16x32_bf16 a[132:135], v[136:139], v[108:111], a[132:135]
v_mfma_f32_16x16x32_bf16 a[136:139], v[136:139], v[112:115], a[136:139]
v_mfma_f32_16x16x32_bf16 a[140:143], v[136:139], v[116:119], a[140:143]
s_waitcnt lgkmcnt(0)
v_mfma_f32_16x16x32_bf16 v[72:75], v[8:11], a[144:147], 0
ds_read_b128 v[40:43], v3 offset:8192
v_fma_f32 v149, v149, v182, -v190
v_mfma_f32_16x16x32_bf16 v[72:75], v[12:15], a[148:151], v[72:75]
buffer_load_dwordx4 v[140:143], v236, s[8:11], s62 offen offset:0 nt
v_fma_f32 v150, v150, v182, -v190
v_mfma_f32_16x16x32_bf16 v[72:75], v[16:19], a[152:155], v[72:75]
v_fma_f32 v151, v151, v182, -v190
v_fma_f32 v152, v152, v183, -v191
v_mfma_f32_16x16x32_bf16 v[72:75], v[20:23], a[156:159], v[72:75]
ds_read_b128 v[44:47], v3 offset:9216
v_fma_f32 v153, v153, v183, -v191
v_mfma_f32_16x16x32_bf16 v[76:79], v[24:27], a[144:147], 0
v_fma_f32 v154, v154, v183, -v191
v_fma_f32 v155, v155, v183, -v191
v_mfma_f32_16x16x32_bf16 v[76:79], v[28:31], a[148:151], v[76:79]
v_cvt_pk_bf16_f32 v197, v148, v152
v_cvt_pk_bf16_f32 v201, v149, v153
v_mfma_f32_16x16x32_bf16 v[76:79], v[32:35], a[152:155], v[76:79]
ds_read_b128 v[48:51], v3 offset:10240
v_cvt_pk_bf16_f32 v205, v150, v154
v_mfma_f32_16x16x32_bf16 v[76:79], v[36:39], a[156:159], v[76:79]
buffer_load_dwordx4 v[144:147], v236, s[8:11], s62 offen offset:512 nt
v_cvt_pk_bf16_f32 v209, v151, v155
v_mfma_f32_16x16x32_bf16 v[80:83], v[8:11], a[160:163], 0
s_waitcnt vmcnt(49)
v_cvt_f32_i32 v156, v156
v_mfma_f32_16x16x32_bf16 v[80:83], v[12:15], a[164:167], v[80:83]
ds_read_b128 v[52:55], v3 offset:11264
v_cvt_f32_i32 v157, v157
v_mfma_f32_16x16x32_bf16 v[80:83], v[16:19], a[168:171], v[80:83]
v_exp_f32 v72, v72
v_mfma_f32_16x16x32_bf16 v[80:83], v[20:23], a[172:175], v[80:83]
v_exp_f32 v73, v73
v_mfma_f32_16x16x32_bf16 v[84:87], v[24:27], a[160:163], 0
ds_read_b128 v[56:59], v3 offset:12288
v_cvt_pk_bf16_f32 v104, v72, v73
v_mfma_f32_16x16x32_bf16 v[84:87], v[28:31], a[164:167], v[84:87]
v_exp_f32 v74, v74
v_mfma_f32_16x16x32_bf16 v[84:87], v[32:35], a[168:171], v[84:87]
v_exp_f32 v75, v75
v_mfma_f32_16x16x32_bf16 v[84:87], v[36:39], a[172:175], v[84:87]
ds_read_b128 v[60:63], v3 offset:13312
v_cvt_pk_bf16_f32 v105, v74, v75
v_mfma_f32_16x16x32_bf16 v[88:91], v[8:11], a[176:179], 0
v_exp_f32 v76, v76
v_mfma_f32_16x16x32_bf16 v[88:91], v[12:15], a[180:183], v[88:91]
v_exp_f32 v77, v77
v_mfma_f32_16x16x32_bf16 v[88:91], v[16:19], a[184:187], v[88:91]
ds_read_b128 v[64:67], v3 offset:14336
v_cvt_pk_bf16_f32 v106, v76, v77
v_mfma_f32_16x16x32_bf16 v[88:91], v[20:23], a[188:191], v[88:91]
v_exp_f32 v78, v78
v_mfma_f32_16x16x32_bf16 v[92:95], v[24:27], a[176:179], 0
v_exp_f32 v79, v79
v_mfma_f32_16x16x32_bf16 v[92:95], v[28:31], a[180:183], v[92:95]
ds_read_b128 v[68:71], v3 offset:15360
v_cvt_pk_bf16_f32 v107, v78, v79
v_mfma_f32_16x16x32_bf16 v[92:95], v[32:35], a[184:187], v[92:95]
v_exp_f32 v80, v80
v_mfma_f32_16x16x32_bf16 v[92:95], v[36:39], a[188:191], v[92:95]
v_exp_f32 v81, v81
v_mfma_f32_16x16x32_bf16 v[96:99], v[8:11], a[192:195], 0
v_exp_f32 v82, v82
v_mfma_f32_16x16x32_bf16 v[96:99], v[12:15], a[196:199], v[96:99]
v_exp_f32 v83, v83
v_mfma_f32_16x16x32_bf16 v[96:99], v[16:19], a[200:203], v[96:99]
v_cvt_pk_bf16_f32 v108, v80, v81
v_cvt_pk_bf16_f32 v109, v82, v83
v_mfma_f32_16x16x32_bf16 v[96:99], v[20:23], a[204:207], v[96:99]
v_exp_f32 v84, v84
v_mfma_f32_16x16x32_bf16 v[100:103], v[24:27], a[192:195], 0
v_exp_f32 v85, v85
v_mfma_f32_16x16x32_bf16 v[100:103], v[28:31], a[196:199], v[100:103]
v_exp_f32 v86, v86
v_mfma_f32_16x16x32_bf16 v[100:103], v[32:35], a[200:203], v[100:103]
v_exp_f32 v87, v87
v_mfma_f32_16x16x32_bf16 v[100:103], v[36:39], a[204:207], v[100:103]
v_cvt_pk_bf16_f32 v110, v84, v85
v_cvt_pk_bf16_f32 v111, v86, v87
s_waitcnt vmcnt(23) lgkmcnt(0)
s_barrier
v_mfma_f32_16x16x32_bf16 a[0:3], v[40:43], v[120:123], a[0:3]
ds_read_b128 v[8:11], v2 offset:24576
v_cvt_f32_i32 v158, v158
v_mfma_f32_16x16x32_bf16 a[32:35], v[40:43], v[124:127], a[32:35]
s_add_u32 m0, s59, 16384
v_cvt_f32_i32 v159, v159
v_mfma_f32_16x16x32_bf16 a[64:67], v[40:43], v[128:131], a[64:67]
buffer_load_dwordx4 v1, s[4:7], s57 offen offset:0 sc1 lds
v_cvt_f32_i32 v160, v160
v_mfma_f32_16x16x32_bf16 a[96:99], v[40:43], v[132:135], a[96:99]
ds_read_b128 v[12:15], v2 offset:25600
v_cvt_f32_i32 v161, v161
v_mfma_f32_16x16x32_bf16 a[4:7], v[44:47], v[120:123], a[4:7]
v_exp_f32 v88, v88
v_mfma_f32_16x16x32_bf16 a[36:39], v[44:47], v[124:127], a[36:39]
v_exp_f32 v89, v89
v_mfma_f32_16x16x32_bf16 a[68:71], v[44:47], v[128:131], a[68:71]
ds_read_b128 v[16:19], v2 offset:26624
buffer_load_dwordx4 v1, s[4:7], s57 offen offset:1024 sc1 lds
v_mfma_f32_16x16x32_bf16 a[100:103], v[44:47], v[132:135], a[100:103]
v_exp_f32 v90, v90
v_mfma_f32_16x16x32_bf16 a[8:11], v[48:51], v[120:123], a[8:11]
v_exp_f32 v91, v91
v_mfma_f32_16x16x32_bf16 a[40:43], v[48:51], v[124:127], a[40:43]
ds_read_b128 v[20:23], v2 offset:27648
v_cvt_pk_bf16_f32 v112, v88, v89
v_mfma_f32_16x16x32_bf16 a[72:75], v[48:51], v[128:131], a[72:75]
buffer_load_dwordx4 v1, s[4:7], s57 offen offset:2048 sc1 lds
v_cvt_pk_bf16_f32 v113, v90, v91
v_cvt_f32_i32 v162, v162
v_mfma_f32_16x16x32_bf16 a[104:107], v[48:51], v[132:135], a[104:107]
v_exp_f32 v92, v92
v_mfma_f32_16x16x32_bf16 a[12:15], v[52:55], v[120:123], a[12:15]
ds_read_b128 v[24:27], v2 offset:28672
v_cvt_f32_i32 v163, v163
v_mfma_f32_16x16x32_bf16 a[44:47], v[52:55], v[124:127], a[44:47]
v_exp_f32 v93, v93
v_mfma_f32_16x16x32_bf16 a[76:79], v[52:55], v[128:131], a[76:79]
buffer_load_dwordx4 v1, s[4:7], s57 offen offset:3072 sc1 lds
v_cvt_pk_bf16_f32 v114, v92, v93
v_fma_f32 v156, v156, v184, -v192
v_mfma_f32_16x16x32_bf16 a[108:111], v[52:55], v[132:135], a[108:111]
ds_read_b128 v[28:31], v2 offset:29696
s_add_u32 s57, s57, 0x4000
v_exp_f32 v94, v94
v_mfma_f32_16x16x32_bf16 a[16:19], v[56:59], v[120:123], a[16:19]
v_exp_f32 v95, v95
v_mfma_f32_16x16x32_bf16 a[48:51], v[56:59], v[124:127], a[48:51]
s_add_u32 m0, s60, 8192
v_cvt_pk_bf16_f32 v115, v94, v95
v_fma_f32 v157, v157, v184, -v192
v_mfma_f32_16x16x32_bf16 a[80:83], v[56:59], v[128:131], a[80:83]
ds_read_b128 v[32:35], v2 offset:30720
buffer_load_dwordx4 v1, s[4:7], s58 offen offset:0 sc1 lds
v_exp_f32 v96, v96
v_mfma_f32_16x16x32_bf16 a[112:115], v[56:59], v[132:135], a[112:115]
v_exp_f32 v97, v97
v_fma_f32 v158, v158, v184, -v192
v_mfma_f32_16x16x32_bf16 a[20:23], v[60:63], v[120:123], a[20:23]
v_exp_f32 v98, v98
v_mfma_f32_16x16x32_bf16 a[52:55], v[60:63], v[124:127], a[52:55]
ds_read_b128 v[36:39], v2 offset:31744
v_cvt_pk_bf16_f32 v116, v96, v97
v_fma_f32 v159, v159, v184, -v192
v_mfma_f32_16x16x32_bf16 a[84:87], v[60:63], v[128:131], a[84:87]
buffer_load_dwordx4 v1, s[4:7], s58 offen offset:1024 sc1 lds
v_fma_f32 v160, v160, v185, -v193
v_exp_f32 v99, v99
v_mfma_f32_16x16x32_bf16 a[116:119], v[60:63], v[132:135], a[116:119]
v_exp_f32 v100, v100
v_mfma_f32_16x16x32_bf16 a[24:27], v[64:67], v[120:123], a[24:27]
v_exp_f32 v101, v101
v_mfma_f32_16x16x32_bf16 a[56:59], v[64:67], v[124:127], a[56:59]
v_cvt_pk_bf16_f32 v117, v98, v99
v_cvt_pk_bf16_f32 v118, v100, v101
v_mfma_f32_16x16x32_bf16 a[88:91], v[64:67], v[128:131], a[88:91]
buffer_load_dwordx4 v1, s[4:7], s58 offen offset:2048 sc1 lds
v_fma_f32 v161, v161, v185, -v193
v_mfma_f32_16x16x32_bf16 a[120:123], v[64:67], v[132:135], a[120:123]
v_exp_f32 v102, v102
v_mfma_f32_16x16x32_bf16 a[28:31], v[68:71], v[120:123], a[28:31]
v_exp_f32 v103, v103
v_fma_f32 v162, v162, v185, -v193
v_mfma_f32_16x16x32_bf16 a[60:63], v[68:71], v[124:127], a[60:63]
v_cvt_pk_bf16_f32 v119, v102, v103
v_fma_f32 v163, v163, v185, -v193
v_mfma_f32_16x16x32_bf16 a[92:95], v[68:71], v[128:131], a[92:95]
buffer_load_dwordx4 v1, s[4:7], s58 offen offset:3072 sc1 lds
v_cvt_pk_bf16_f32 v198, v156, v160
v_mfma_f32_16x16x32_bf16 a[124:127], v[68:71], v[132:135], a[124:127]
s_add_u32 s58, s58, 0x4000
v_mfma_f32_16x16x32_bf16 a[128:131], v[136:139], v[120:123], a[128:131]
v_mfma_f32_16x16x32_bf16 a[132:135], v[136:139], v[124:127], a[132:135]
v_mfma_f32_16x16x32_bf16 a[136:139], v[136:139], v[128:131], a[136:139]
v_mfma_f32_16x16x32_bf16 a[140:143], v[136:139], v[132:135], a[140:143]
s_waitcnt lgkmcnt(0)
v_mfma_f32_16x16x32_bf16 v[72:75], v[8:11], a[144:147], 0
ds_read_b128 v[40:43], v3 offset:16384
v_cvt_pk_bf16_f32 v202, v157, v161
v_mfma_f32_16x16x32_bf16 v[72:75], v[12:15], a[148:151], v[72:75]
buffer_load_dwordx4 v[148:151], v236, s[8:11], s62 offen offset:1024 nt
v_cvt_pk_bf16_f32 v206, v158, v162
v_mfma_f32_16x16x32_bf16 v[72:75], v[16:19], a[152:155], v[72:75]
v_cvt_pk_bf16_f32 v210, v159, v163
s_waitcnt vmcnt(56)
v_mfma_f32_16x16x32_bf16 v[72:75], v[20:23], a[156:159], v[72:75]
ds_read_b128 v[44:47], v3 offset:17408
v_cvt_f32_i32 v164, v164
v_mfma_f32_16x16x32_bf16 v[76:79], v[24:27], a[144:147], 0
v_cvt_f32_i32 v165, v165
v_cvt_f32_i32 v166, v166
v_mfma_f32_16x16x32_bf16 v[76:79], v[28:31], a[148:151], v[76:79]
buffer_load_dwordx4 v[240:243], off, s[32:35], s70 sc1
v_cvt_f32_i32 v167, v167
v_mfma_f32_16x16x32_bf16 v[76:79], v[32:35], a[152:155], v[76:79]
ds_read_b128 v[48:51], v3 offset:18432
v_cvt_f32_i32 v168, v168
v_mfma_f32_16x16x32_bf16 v[76:79], v[36:39], a[156:159], v[76:79]
buffer_load_dwordx4 v[152:155], v236, s[8:11], s62 offen offset:1536 nt
v_cvt_f32_i32 v169, v169
v_mfma_f32_16x16x32_bf16 v[80:83], v[8:11], a[160:163], 0
v_cvt_f32_i32 v170, v170
v_cvt_f32_i32 v171, v171
v_mfma_f32_16x16x32_bf16 v[80:83], v[12:15], a[164:167], v[80:83]
ds_read_b128 v[52:55], v3 offset:19456
v_fma_f32 v164, v164, v186, -v194
v_mfma_f32_16x16x32_bf16 v[80:83], v[16:19], a[168:171], v[80:83]
v_exp_f32 v72, v72
v_mfma_f32_16x16x32_bf16 v[80:83], v[20:23], a[172:175], v[80:83]
v_exp_f32 v73, v73
v_mfma_f32_16x16x32_bf16 v[84:87], v[24:27], a[160:163], 0
ds_read_b128 v[56:59], v3 offset:20480
v_cvt_pk_bf16_f32 v120, v72, v73
v_mfma_f32_16x16x32_bf16 v[84:87], v[28:31], a[164:167], v[84:87]
v_exp_f32 v74, v74
v_mfma_f32_16x16x32_bf16 v[84:87], v[32:35], a[168:171], v[84:87]
v_exp_f32 v75, v75
v_mfma_f32_16x16x32_bf16 v[84:87], v[36:39], a[172:175], v[84:87]
ds_read_b128 v[60:63], v3 offset:21504
v_cvt_pk_bf16_f32 v121, v74, v75
v_mfma_f32_16x16x32_bf16 v[88:91], v[8:11], a[176:179], 0
v_exp_f32 v76, v76
v_mfma_f32_16x16x32_bf16 v[88:91], v[12:15], a[180:183], v[88:91]
v_exp_f32 v77, v77
v_mfma_f32_16x16x32_bf16 v[88:91], v[16:19], a[184:187], v[88:91]
ds_read_b128 v[64:67], v3 offset:22528
v_cvt_pk_bf16_f32 v122, v76, v77
v_mfma_f32_16x16x32_bf16 v[88:91], v[20:23], a[188:191], v[88:91]
v_exp_f32 v78, v78
v_mfma_f32_16x16x32_bf16 v[92:95], v[24:27], a[176:179], 0
v_exp_f32 v79, v79
v_mfma_f32_16x16x32_bf16 v[92:95], v[28:31], a[180:183], v[92:95]
ds_read_b128 v[68:71], v3 offset:23552
v_cvt_pk_bf16_f32 v123, v78, v79
v_mfma_f32_16x16x32_bf16 v[92:95], v[32:35], a[184:187], v[92:95]
v_exp_f32 v80, v80
v_mfma_f32_16x16x32_bf16 v[92:95], v[36:39], a[188:191], v[92:95]
v_exp_f32 v81, v81
v_mfma_f32_16x16x32_bf16 v[96:99], v[8:11], a[192:195], 0
v_exp_f32 v82, v82
v_mfma_f32_16x16x32_bf16 v[96:99], v[12:15], a[196:199], v[96:99]
v_exp_f32 v83, v83
v_mfma_f32_16x16x32_bf16 v[96:99], v[16:19], a[200:203], v[96:99]
v_cvt_pk_bf16_f32 v124, v80, v81
v_cvt_pk_bf16_f32 v125, v82, v83
v_mfma_f32_16x16x32_bf16 v[96:99], v[20:23], a[204:207], v[96:99]
v_exp_f32 v84, v84
v_mfma_f32_16x16x32_bf16 v[100:103], v[24:27], a[192:195], 0
v_exp_f32 v85, v85
v_mfma_f32_16x16x32_bf16 v[100:103], v[28:31], a[196:199], v[100:103]
v_exp_f32 v86, v86
v_mfma_f32_16x16x32_bf16 v[100:103], v[32:35], a[200:203], v[100:103]
v_exp_f32 v87, v87
v_mfma_f32_16x16x32_bf16 v[100:103], v[36:39], a[204:207], v[100:103]
v_cvt_pk_bf16_f32 v126, v84, v85
v_cvt_pk_bf16_f32 v127, v86, v87
s_waitcnt vmcnt(25) lgkmcnt(0)
s_barrier
v_mfma_f32_16x16x32_bf16 a[0:3], v[40:43], v[104:107], a[0:3]
ds_read_b128 v[8:11], v2 offset:0
v_fma_f32 v165, v165, v186, -v194
v_mfma_f32_16x16x32_bf16 a[32:35], v[40:43], v[108:111], a[32:35]
s_add_u32 m0, s59, 24576
v_fma_f32 v166, v166, v186, -v194
v_mfma_f32_16x16x32_bf16 a[64:67], v[40:43], v[112:115], a[64:67]
buffer_load_dwordx4 v1, s[4:7], s57 offen offset:0 sc1 lds
v_fma_f32 v167, v167, v186, -v194
v_mfma_f32_16x16x32_bf16 a[96:99], v[40:43], v[116:119], a[96:99]
ds_read_b128 v[12:15], v2 offset:1024
v_fma_f32 v168, v168, v187, -v195
v_mfma_f32_16x16x32_bf16 a[4:7], v[44:47], v[104:107], a[4:7]
v_exp_f32 v88, v88
v_mfma_f32_16x16x32_bf16 a[36:39], v[44:47], v[108:111], a[36:39]
v_exp_f32 v89, v89
v_mfma_f32_16x16x32_bf16 a[68:71], v[44:47], v[112:115], a[68:71]
ds_read_b128 v[16:19], v2 offset:2048
buffer_load_dwordx4 v1, s[4:7], s57 offen offset:1024 sc1 lds
v_mfma_f32_16x16x32_bf16 a[100:103], v[44:47], v[116:119], a[100:103]
v_exp_f32 v90, v90
v_mfma_f32_16x16x32_bf16 a[8:11], v[48:51], v[104:107], a[8:11]
v_exp_f32 v91, v91
v_mfma_f32_16x16x32_bf16 a[40:43], v[48:51], v[108:111], a[40:43]
ds_read_b128 v[20:23], v2 offset:3072
v_cvt_pk_bf16_f32 v128, v88, v89
v_mfma_f32_16x16x32_bf16 a[72:75], v[48:51], v[112:115], a[72:75]
buffer_load_dwordx4 v1, s[4:7], s57 offen offset:2048 sc1 lds
v_cvt_pk_bf16_f32 v129, v90, v91
v_mfma_f32_16x16x32_bf16 a[104:107], v[48:51], v[116:119], a[104:107]
v_exp_f32 v92, v92
v_mfma_f32_16x16x32_bf16 a[12:15], v[52:55], v[104:107], a[12:15]
ds_read_b128 v[24:27], v2 offset:4096
v_fma_f32 v169, v169, v187, -v195
v_mfma_f32_16x16x32_bf16 a[44:47], v[52:55], v[108:111], a[44:47]
v_exp_f32 v93, v93
v_mfma_f32_16x16x32_bf16 a[76:79], v[52:55], v[112:115], a[76:79]
buffer_load_dwordx4 v1, s[4:7], s57 offen offset:3072 sc1 lds
v_cvt_pk_bf16_f32 v130, v92, v93
v_mfma_f32_16x16x32_bf16 a[108:111], v[52:55], v[116:119], a[108:111]
ds_read_b128 v[28:31], v2 offset:5120
s_add_u32 s57, s57, 0x4000
v_exp_f32 v94, v94
v_mfma_f32_16x16x32_bf16 a[16:19], v[56:59], v[104:107], a[16:19]
v_exp_f32 v95, v95
v_mfma_f32_16x16x32_bf16 a[48:51], v[56:59], v[108:111], a[48:51]
s_add_u32 m0, s60, 16384
v_cvt_pk_bf16_f32 v131, v94, v95
v_mfma_f32_16x16x32_bf16 a[80:83], v[56:59], v[112:115], a[80:83]
ds_read_b128 v[32:35], v2 offset:6144
buffer_load_dwordx4 v1, s[4:7], s58 offen offset:0 sc1 lds
v_exp_f32 v96, v96
v_mfma_f32_16x16x32_bf16 a[112:115], v[56:59], v[116:119], a[112:115]
v_exp_f32 v97, v97
v_fma_f32 v170, v170, v187, -v195
v_mfma_f32_16x16x32_bf16 a[20:23], v[60:63], v[104:107], a[20:23]
v_exp_f32 v98, v98
v_mfma_f32_16x16x32_bf16 a[52:55], v[60:63], v[108:111], a[52:55]
ds_read_b128 v[36:39], v2 offset:7168
v_cvt_pk_bf16_f32 v132, v96, v97
v_fma_f32 v171, v171, v187, -v195
v_mfma_f32_16x16x32_bf16 a[84:87], v[60:63], v[112:115], a[84:87]
buffer_load_dwordx4 v1, s[4:7], s58 offen offset:1024 sc1 lds
v_cvt_pk_bf16_f32 v199, v164, v168
v_exp_f32 v99, v99
v_mfma_f32_16x16x32_bf16 a[116:119], v[60:63], v[116:119], a[116:119]
v_exp_f32 v100, v100
v_mfma_f32_16x16x32_bf16 a[24:27], v[64:67], v[104:107], a[24:27]
v_exp_f32 v101, v101
v_mfma_f32_16x16x32_bf16 a[56:59], v[64:67], v[108:111], a[56:59]
v_cvt_pk_bf16_f32 v133, v98, v99
v_cvt_pk_bf16_f32 v134, v100, v101
v_mfma_f32_16x16x32_bf16 a[88:91], v[64:67], v[112:115], a[88:91]
buffer_load_dwordx4 v1, s[4:7], s58 offen offset:2048 sc1 lds
v_cvt_pk_bf16_f32 v203, v165, v169
v_mfma_f32_16x16x32_bf16 a[120:123], v[64:67], v[116:119], a[120:123]
v_exp_f32 v102, v102
v_mfma_f32_16x16x32_bf16 a[28:31], v[68:71], v[104:107], a[28:31]
v_exp_f32 v103, v103
v_mfma_f32_16x16x32_bf16 a[60:63], v[68:71], v[108:111], a[60:63]
v_cvt_pk_bf16_f32 v135, v102, v103
v_cvt_pk_bf16_f32 v207, v166, v170
v_mfma_f32_16x16x32_bf16 a[92:95], v[68:71], v[112:115], a[92:95]
buffer_load_dwordx4 v1, s[4:7], s58 offen offset:3072 sc1 lds
v_cvt_pk_bf16_f32 v211, v167, v171
v_mfma_f32_16x16x32_bf16 a[124:127], v[68:71], v[116:119], a[124:127]
s_add_u32 s58, s58, 0x4000
v_mfma_f32_16x16x32_bf16 a[128:131], v[136:139], v[104:107], a[128:131]
v_mfma_f32_16x16x32_bf16 a[132:135], v[136:139], v[108:111], a[132:135]
v_mfma_f32_16x16x32_bf16 a[136:139], v[136:139], v[112:115], a[136:139]
v_mfma_f32_16x16x32_bf16 a[140:143], v[136:139], v[116:119], a[140:143]
s_waitcnt lgkmcnt(0)
v_mfma_f32_16x16x32_bf16 v[72:75], v[8:11], a[144:147], 0
ds_read_b128 v[40:43], v3 offset:24576
v_mfma_f32_16x16x32_bf16 v[72:75], v[12:15], a[148:151], v[72:75]
buffer_store_dwordx4 v[196:199], v239, s[12:15], s66 offen offset:0 sc1
v_mfma_f32_16x16x32_bf16 v[72:75], v[16:19], a[152:155], v[72:75]
v_mfma_f32_16x16x32_bf16 v[72:75], v[20:23], a[156:159], v[72:75]
ds_read_b128 v[44:47], v3 offset:25600
v_mfma_f32_16x16x32_bf16 v[76:79], v[24:27], a[144:147], 0
v_mfma_f32_16x16x32_bf16 v[76:79], v[28:31], a[148:151], v[76:79]
v_mfma_f32_16x16x32_bf16 v[76:79], v[32:35], a[152:155], v[76:79]
ds_read_b128 v[48:51], v3 offset:26624
v_mfma_f32_16x16x32_bf16 v[76:79], v[36:39], a[156:159], v[76:79]
buffer_store_dwordx4 v[200:203], v239, s[12:15], s66 offen offset:1024 sc1
v_mfma_f32_16x16x32_bf16 v[80:83], v[8:11], a[160:163], 0
v_mfma_f32_16x16x32_bf16 v[80:83], v[12:15], a[164:167], v[80:83]
ds_read_b128 v[52:55], v3 offset:27648
v_mfma_f32_16x16x32_bf16 v[80:83], v[16:19], a[168:171], v[80:83]
v_mfma_f32_16x16x32_bf16 v[80:83], v[20:23], a[172:175], v[80:83]
v_mfma_f32_16x16x32_bf16 v[84:87], v[24:27], a[160:163], 0
ds_read_b128 v[56:59], v3 offset:28672
v_mfma_f32_16x16x32_bf16 v[84:87], v[28:31], a[164:167], v[84:87]
buffer_store_dwordx4 v[204:207], v239, s[12:15], s66 offen offset:2048 sc1
v_mfma_f32_16x16x32_bf16 v[84:87], v[32:35], a[168:171], v[84:87]
v_exp_f32 v72, v72
v_mfma_f32_16x16x32_bf16 v[84:87], v[36:39], a[172:175], v[84:87]
ds_read_b128 v[60:63], v3 offset:29696
v_exp_f32 v73, v73
v_mfma_f32_16x16x32_bf16 v[88:91], v[8:11], a[176:179], 0
v_exp_f32 v74, v74
v_mfma_f32_16x16x32_bf16 v[88:91], v[12:15], a[180:183], v[88:91]
v_exp_f32 v75, v75
v_mfma_f32_16x16x32_bf16 v[88:91], v[16:19], a[184:187], v[88:91]
ds_read_b128 v[64:67], v3 offset:30720
v_cvt_pk_bf16_f32 v104, v72, v73
v_mfma_f32_16x16x32_bf16 v[88:91], v[20:23], a[188:191], v[88:91]
buffer_store_dwordx4 v[208:211], v239, s[12:15], s66 offen offset:3072 sc1
v_cvt_pk_bf16_f32 v105, v74, v75
v_mfma_f32_16x16x32_bf16 v[92:95], v[24:27], a[176:179], 0
v_exp_f32 v76, v76
v_mfma_f32_16x16x32_bf16 v[92:95], v[28:31], a[180:183], v[92:95]
ds_read_b128 v[68:71], v3 offset:31744
v_exp_f32 v77, v77
v_mfma_f32_16x16x32_bf16 v[92:95], v[32:35], a[184:187], v[92:95]
v_exp_f32 v78, v78
v_mfma_f32_16x16x32_bf16 v[92:95], v[36:39], a[188:191], v[92:95]
s_waitcnt vmcnt(13)
v_and_b32 v240, v240, v241
v_mfma_f32_16x16x32_bf16 v[96:99], v[8:11], a[192:195], 0
v_and_b32 v242, v242, v243
v_cvt_pk_bf16_f32 v106, v76, v77
v_exp_f32 v79, v79
v_mfma_f32_16x16x32_bf16 v[96:99], v[12:15], a[196:199], v[96:99]
v_and_b32 v240, v240, v242
v_cvt_pk_bf16_f32 v107, v78, v79
v_mfma_f32_16x16x32_bf16 v[96:99], v[16:19], a[200:203], v[96:99]
v_exp_f32 v80, v80
v_mfma_f32_16x16x32_bf16 v[96:99], v[20:23], a[204:207], v[96:99]
v_readfirstlane_b32 s72, v240
v_exp_f32 v81, v81
v_mfma_f32_16x16x32_bf16 v[100:103], v[24:27], a[192:195], 0
s_and_b32 s72, s72, s68
v_cvt_pk_bf16_f32 v108, v80, v81
v_mfma_f32_16x16x32_bf16 v[100:103], v[28:31], a[196:199], v[100:103]
s_cmp_eq_u32 s72, s68
s_cbranch_scc0 L_spin_V4
L_back_V4:
v_exp_f32 v82, v82
v_mfma_f32_16x16x32_bf16 v[100:103], v[32:35], a[200:203], v[100:103]
v_exp_f32 v83, v83
v_mfma_f32_16x16x32_bf16 v[100:103], v[36:39], a[204:207], v[100:103]
v_exp_f32 v84, v84
s_waitcnt vmcnt(25) lgkmcnt(0)
s_barrier
v_mfma_f32_16x16x32_bf16 a[0:3], v[40:43], v[120:123], a[0:3]
ds_read_b128 v[8:11], v2 offset:8192
v_cvt_pk_bf16_f32 v109, v82, v83
v_mfma_f32_16x16x32_bf16 a[32:35], v[40:43], v[124:127], a[32:35]
s_add_u32 m0, s59, 0
v_exp_f32 v85, v85
v_mfma_f32_16x16x32_bf16 a[64:67], v[40:43], v[128:131], a[64:67]
buffer_load_dwordx4 v1, s[4:7], s57 offen offset:0 sc1 lds
v_cvt_pk_bf16_f32 v110, v84, v85
v_mfma_f32_16x16x32_bf16 a[96:99], v[40:43], v[132:135], a[96:99]
ds_read_b128 v[12:15], v2 offset:9216
v_exp_f32 v86, v86
v_mfma_f32_16x16x32_bf16 a[4:7], v[44:47], v[120:123], a[4:7]
v_exp_f32 v87, v87
v_mfma_f32_16x16x32_bf16 a[36:39], v[44:47], v[124:127], a[36:39]
v_exp_f32 v88, v88
v_mfma_f32_16x16x32_bf16 a[68:71], v[44:47], v[128:131], a[68:71]
ds_read_b128 v[16:19], v2 offset:10240
buffer_load_dwordx4 v1, s[4:7], s57 offen offset:1024 sc1 lds
v_mfma_f32_16x16x32_bf16 a[100:103], v[44:47], v[132:135], a[100:103]
v_exp_f32 v89, v89
v_mfma_f32_16x16x32_bf16 a[8:11], v[48:51], v[120:123], a[8:11]
v_cvt_pk_bf16_f32 v111, v86, v87
v_cvt_pk_bf16_f32 v112, v88, v89
v_mfma_f32_16x16x32_bf16 a[40:43], v[48:51], v[124:127], a[40:43]
ds_read_b128 v[20:23], v2 offset:11264
v_exp_f32 v90, v90
v_mfma_f32_16x16x32_bf16 a[72:75], v[48:51], v[128:131], a[72:75]
buffer_load_dwordx4 v1, s[4:7], s57 offen offset:2048 sc1 lds
v_exp_f32 v91, v91
v_mfma_f32_16x16x32_bf16 a[104:107], v[48:51], v[132:135], a[104:107]
v_exp_f32 v92, v92
v_mfma_f32_16x16x32_bf16 a[12:15], v[52:55], v[120:123], a[12:15]
ds_read_b128 v[24:27], v2 offset:12288
v_cvt_pk_bf16_f32 v113, v90, v91
v_mfma_f32_16x16x32_bf16 a[44:47], v[52:55], v[124:127], a[44:47]
v_exp_f32 v93, v93
v_mfma_f32_16x16x32_bf16 a[76:79], v[52:55], v[128:131], a[76:79]
buffer_load_dwordx4 v1, s[4:7], s57 offen offset:3072 sc1 lds
v_cvt_pk_bf16_f32 v114, v92, v93
v_mfma_f32_16x16x32_bf16 a[108:111], v[52:55], v[132:135], a[108:111]
ds_read_b128 v[28:31], v2 offset:13312
s_add_u32 s57, s57, 0x4000
v_exp_f32 v94, v94
v_mfma_f32_16x16x32_bf16 a[16:19], v[56:59], v[120:123], a[16:19]
v_exp_f32 v95, v95
v_mfma_f32_16x16x32_bf16 a[48:51], v[56:59], v[124:127], a[48:51]
s_add_u32 m0, s60, 24576
v_cvt_pk_bf16_f32 v115, v94, v95
v_mfma_f32_16x16x32_bf16 a[80:83], v[56:59], v[128:131], a[80:83]
ds_read_b128 v[32:35], v2 offset:14336
buffer_load_dwordx4 v1, s[4:7], s58 offen offset:0 sc1 lds
v_exp_f32 v96, v96
v_mfma_f32_16x16x32_bf16 a[112:115], v[56:59], v[132:135], a[112:115]
v_exp_f32 v97, v97
v_mfma_f32_16x16x32_bf16 a[20:23], v[60:63], v[120:123], a[20:23]
v_exp_f32 v98, v98
v_mfma_f32_16x16x32_bf16 a[52:55], v[60:63], v[124:127], a[52:55]
ds_read_b128 v[36:39], v2 offset:15360
v_cvt_pk_bf16_f32 v116, v96, v97
v_mfma_f32_16x16x32_bf16 a[84:87], v[60:63], v[128:131], a[84:87]
buffer_load_dwordx4 v1, s[4:7], s58 offen offset:1024 sc1 lds
v_exp_f32 v99, v99
v_mfma_f32_16x16x32_bf16 a[116:119], v[60:63], v[132:135], a[116:119]
v_exp_f32 v100, v100
v_mfma_f32_16x16x32_bf16 a[24:27], v[64:67], v[120:123], a[24:27]
v_exp_f32 v101, v101
v_mfma_f32_16x16x32_bf16 a[56:59], v[64:67], v[124:127], a[56:59]
v_cvt_pk_bf16_f32 v117, v98, v99
v_cvt_pk_bf16_f32 v118, v100, v101
v_mfma_f32_16x16x32_bf16 a[88:91], v[64:67], v[128:131], a[88:91]
buffer_load_dwordx4 v1, s[4:7], s58 offen offset:2048 sc1 lds
v_mfma_f32_16x16x32_bf16 a[120:123], v[64:67], v[132:135], a[120:123]
v_exp_f32 v102, v102
v_mfma_f32_16x16x32_bf16 a[28:31], v[68:71], v[120:123], a[28:31]
v_exp_f32 v103, v103
v_mfma_f32_16x16x32_bf16 a[60:63], v[68:71], v[124:127], a[60:63]
v_cvt_pk_bf16_f32 v119, v102, v103
v_mfma_f32_16x16x32_bf16 a[92:95], v[68:71], v[128:131], a[92:95]
buffer_load_dwordx4 v1, s[4:7], s58 offen offset:3072 sc1 lds
v_mfma_f32_16x16x32_bf16 a[124:127], v[68:71], v[132:135], a[124:127]
s_add_u32 s58, s58, 0x4000
v_mfma_f32_16x16x32_bf16 a[128:131], v[136:139], v[120:123], a[128:131]
v_mfma_f32_16x16x32_bf16 a[132:135], v[136:139], v[124:127], a[132:135]
v_mfma_f32_16x16x32_bf16 a[136:139], v[136:139], v[128:131], a[136:139]
v_mfma_f32_16x16x32_bf16 a[140:143], v[136:139], v[132:135], a[140:143]
s_waitcnt lgkmcnt(0)
v_mfma_f32_16x16x32_bf16 v[72:75], v[8:11], a[144:147], 0
ds_read_b128 v[40:43], v3 offset:0
v_mfma_f32_16x16x32_bf16 v[72:75], v[12:15], a[148:151], v[72:75]
buffer_load_dwordx4 v[156:159], v236, s[8:11], s63 offen offset:0 nt
v_mfma_f32_16x16x32_bf16 v[72:75], v[16:19], a[152:155], v[72:75]
v_mfma_f32_16x16x32_bf16 v[72:75], v[20:23], a[156:159], v[72:75]
ds_read_b128 v[44:47], v3 offset:1024
v_mfma_f32_16x16x32_bf16 v[76:79], v[24:27], a[144:147], 0
v_mfma_f32_16x16x32_bf16 v[76:79], v[28:31], a[148:151], v[76:79]
v_mfma_f32_16x16x32_bf16 v[76:79], v[32:35], a[152:155], v[76:79]
ds_read_b128 v[48:51], v3 offset:2048
v_mfma_f32_16x16x32_bf16 v[76:79], v[36:39], a[156:159], v[76:79]
buffer_load_dwordx4 v[160:163], v236, s[8:11], s63 offen offset:512 nt
v_mfma_f32_16x16x32_bf16 v[80:83], v[8:11], a[160:163], 0
v_mfma_f32_16x16x32_bf16 v[80:83], v[12:15], a[164:167], v[80:83]
ds_read_b128 v[52:55], v3 offset:3072
v_mfma_f32_16x16x32_bf16 v[80:83], v[16:19], a[168:171], v[80:83]
v_mfma_f32_16x16x32_bf16 v[80:83], v[20:23], a[172:175], v[80:83]
v_mfma_f32_16x16x32_bf16 v[84:87], v[24:27], a[160:163], 0
ds_read_b128 v[56:59], v3 offset:4096
v_mfma_f32_16x16x32_bf16 v[84:87], v[28:31], a[164:167], v[84:87]
buffer_load_dwordx4 v[164:167], v236, s[8:11], s63 offen offset:1024 nt
v_mfma_f32_16x16x32_bf16 v[84:87], v[32:35], a[168:171], v[84:87]
v_exp_f32 v72, v72
v_mfma_f32_16x16x32_bf16 v[84:87], v[36:39], a[172:175], v[84:87]
ds_read_b128 v[60:63], v3 offset:5120
v_exp_f32 v73, v73
v_mfma_f32_16x16x32_bf16 v[88:91], v[8:11], a[176:179], 0
v_exp_f32 v74, v74
v_mfma_f32_16x16x32_bf16 v[88:91], v[12:15], a[180:183], v[88:91]
v_exp_f32 v75, v75
v_mfma_f32_16x16x32_bf16 v[88:91], v[16:19], a[184:187], v[88:91]
ds_read_b128 v[64:67], v3 offset:6144
v_cvt_pk_bf16_f32 v120, v72, v73
v_mfma_f32_16x16x32_bf16 v[88:91], v[20:23], a[188:191], v[88:91]
buffer_load_dwordx4 v[168:171], v236, s[8:11], s63 offen offset:1536 nt
v_cvt_pk_bf16_f32 v121, v74, v75
v_mfma_f32_16x16x32_bf16 v[92:95], v[24:27], a[176:179], 0
v_exp_f32 v76, v76
v_mfma_f32_16x16x32_bf16 v[92:95], v[28:31], a[180:183], v[92:95]
ds_read_b128 v[68:71], v3 offset:7168
v_exp_f32 v77, v77
v_mfma_f32_16x16x32_bf16 v[92:95], v[32:35], a[184:187], v[92:95]
v_exp_f32 v78, v78
v_mfma_f32_16x16x32_bf16 v[92:95], v[36:39], a[188:191], v[92:95]
v_exp_f32 v79, v79
v_mfma_f32_16x16x32_bf16 v[96:99], v[8:11], a[192:195], 0
v_cvt_pk_bf16_f32 v122, v76, v77
v_cvt_pk_bf16_f32 v123, v78, v79
v_mfma_f32_16x16x32_bf16 v[96:99], v[12:15], a[196:199], v[96:99]
v_exp_f32 v80, v80
v_mfma_f32_16x16x32_bf16 v[96:99], v[16:19], a[200:203], v[96:99]
v_exp_f32 v81, v81
v_mfma_f32_16x16x32_bf16 v[96:99], v[20:23], a[204:207], v[96:99]
v_exp_f32 v82, v82
v_mfma_f32_16x16x32_bf16 v[100:103], v[24:27], a[192:195], 0
v_exp_f32 v83, v83
v_mfma_f32_16x16x32_bf16 v[100:103], v[28:31], a[196:199], v[100:103]
v_cvt_pk_bf16_f32 v124, v80, v81
v_cvt_pk_bf16_f32 v125, v82, v83
v_mfma_f32_16x16x32_bf16 v[100:103], v[32:35], a[200:203], v[100:103]
v_exp_f32 v84, v84
v_mfma_f32_16x16x32_bf16 v[100:103], v[36:39], a[204:207], v[100:103]
v_exp_f32 v85, v85
s_waitcnt vmcnt(27) lgkmcnt(0)
s_barrier
v_mfma_f32_16x16x32_bf16 a[0:3], v[40:43], v[104:107], a[0:3]
ds_read_b128 v[8:11], v2 offset:16384
v_cvt_pk_bf16_f32 v126, v84, v85
v_mfma_f32_16x16x32_bf16 a[32:35], v[40:43], v[108:111], a[32:35]
s_add_u32 m0, s59, 8192
v_mfma_f32_16x16x32_bf16 a[64:67], v[40:43], v[112:115], a[64:67]
buffer_load_dwordx4 v1, s[4:7], s57 offen offset:0 sc1 lds
v_mfma_f32_16x16x32_bf16 a[96:99], v[40:43], v[116:119], a[96:99]
ds_read_b128 v[12:15], v2 offset:17408
v_exp_f32 v86, v86
v_mfma_f32_16x16x32_bf16 a[4:7], v[44:47], v[104:107], a[4:7]
v_exp_f32 v87, v87
v_mfma_f32_16x16x32_bf16 a[36:39], v[44:47], v[108:111], a[36:39]
v_exp_f32 v88, v88
v_mfma_f32_16x16x32_bf16 a[68:71], v[44:47], v[112:115], a[68:71]
ds_read_b128 v[16:19], v2 offset:18432
buffer_load_dwordx4 v1, s[4:7], s57 offen offset:1024 sc1 lds
v_mfma_f32_16x16x32_bf16 a[100:103], v[44:47], v[116:119], a[100:103]
v_exp_f32 v89, v89
v_mfma_f32_16x16x32_bf16 a[8:11], v[48:51], v[104:107], a[8:11]
v_cvt_pk_bf16_f32 v127, v86, v87
v_cvt_pk_bf16_f32 v128, v88, v89
v_mfma_f32_16x16x32_bf16 a[40:43], v[48:51], v[108:111], a[40:43]
ds_read_b128 v[20:23], v2 offset:19456
v_exp_f32 v90, v90
v_mfma_f32_16x16x32_bf16 a[72:75], v[48:51], v[112:115], a[72:75]
buffer_load_dwordx4 v1, s[4:7], s57 offen offset:2048 sc1 lds
v_exp_f32 v91, v91
v_mfma_f32_16x16x32_bf16 a[104:107], v[48:51], v[116:119], a[104:107]
v_exp_f32 v92, v92
v_mfma_f32_16x16x32_bf16 a[12:15], v[52:55], v[104:107], a[12:15]
ds_read_b128 v[24:27], v2 offset:20480
v_cvt_pk_bf16_f32 v129, v90, v91
v_mfma_f32_16x16x32_bf16 a[44:47], v[52:55], v[108:111], a[44:47]
v_exp_f32 v93, v93
v_mfma_f32_16x16x32_bf16 a[76:79], v[52:55], v[112:115], a[76:79]
buffer_load_dwordx4 v1, s[4:7], s57 offen offset:3072 sc1 lds
v_cvt_pk_bf16_f32 v130, v92, v93
v_mfma_f32_16x16x32_bf16 a[108:111], v[52:55], v[116:119], a[108:111]
ds_read_b128 v[28:31], v2 offset:21504
s_add_u32 s57, s57, 0x4000
v_exp_f32 v94, v94
v_mfma_f32_16x16x32_bf16 a[16:19], v[56:59], v[104:107], a[16:19]
v_exp_f32 v95, v95
v_mfma_f32_16x16x32_bf16 a[48:51], v[56:59], v[108:111], a[48:51]
s_add_u32 m0, s60, 0
v_cvt_pk_bf16_f32 v131, v94, v95
v_mfma_f32_16x16x32_bf16 a[80:83], v[56:59], v[112:115], a[80:83]
ds_read_b128 v[32:35], v2 offset:22528
buffer_load_dwordx4 v1, s[4:7], s58 offen offset:0 sc1 lds
v_exp_f32 v96, v96
v_mfma_f32_16x16x32_bf16 a[112:115], v[56:59], v[116:119], a[112:115]
v_exp_f32 v97, v97
v_mfma_f32_16x16x32_bf16 a[20:23], v[60:63], v[104:107], a[20:23]
v_exp_f32 v98, v98
v_mfma_f32_16x16x32_bf16 a[52:55], v[60:63], v[108:111], a[52:55]
ds_read_b128 v[36:39], v2 offset:23552
v_cvt_pk_bf16_f32 v132, v96, v97
v_mfma_f32_16x16x32_bf16 a[84:87], v[60:63], v[112:115], a[84:87]
buffer_load_dwordx4 v1, s[4:7], s58 offen offset:1024 sc1 lds
v_exp_f32 v99, v99
v_mfma_f32_16x16x32_bf16 a[116:119], v[60:63], v[116:119], a[116:119]
v_exp_f32 v100, v100
v_mfma_f32_16x16x32_bf16 a[24:27], v[64:67], v[104:107], a[24:27]
v_exp_f32 v101, v101
v_mfma_f32_16x16x32_bf16 a[56:59], v[64:67], v[108:111], a[56:59]
v_cvt_pk_bf16_f32 v133, v98, v99
v_cvt_pk_bf16_f32 v134, v100, v101
v_mfma_f32_16x16x32_bf16 a[88:91], v[64:67], v[112:115], a[88:91]
buffer_load_dwordx4 v1, s[4:7], s58 offen offset:2048 sc1 lds
v_mfma_f32_16x16x32_bf16 a[120:123], v[64:67], v[116:119], a[120:123]
v_exp_f32 v102, v102
v_mfma_f32_16x16x32_bf16 a[28:31], v[68:71], v[104:107], a[28:31]
v_exp_f32 v103, v103
v_mfma_f32_16x16x32_bf16 a[60:63], v[68:71], v[108:111], a[60:63]
v_cvt_pk_bf16_f32 v135, v102, v103
v_mfma_f32_16x16x32_bf16 a[92:95], v[68:71], v[112:115], a[92:95]
buffer_load_dwordx4 v1, s[4:7], s58 offen offset:3072 sc1 lds
v_mfma_f32_16x16x32_bf16 a[124:127], v[68:71], v[116:119], a[124:127]
s_add_u32 s58, s58, 0x4000
v_mfma_f32_16x16x32_bf16 a[128:131], v[136:139], v[104:107], a[128:131]
v_mfma_f32_16x16x32_bf16 a[132:135], v[136:139], v[108:111], a[132:135]
v_mfma_f32_16x16x32_bf16 a[136:139], v[136:139], v[112:115], a[136:139]
v_mfma_f32_16x16x32_bf16 a[140:143], v[136:139], v[116:119], a[140:143]
s_waitcnt lgkmcnt(0)
v_mfma_f32_16x16x32_bf16 v[72:75], v[8:11], a[144:147], 0
ds_read_b128 v[40:43], v3 offset:8192
v_mfma_f32_16x16x32_bf16 v[72:75], v[12:15], a[148:151], v[72:75]
v_mfma_f32_16x16x32_bf16 v[72:75], v[16:19], a[152:155], v[72:75]
v_mfma_f32_16x16x32_bf16 v[72:75], v[20:23], a[156:159], v[72:75]
ds_read_b128 v[44:47], v3 offset:9216
v_mfma_f32_16x16x32_bf16 v[76:79], v[24:27], a[144:147], 0
v_mfma_f32_16x16x32_bf16 v[76:79], v[28:31], a[148:151], v[76:79]
v_mfma_f32_16x16x32_bf16 v[76:79], v[32:35], a[152:155], v[76:79]
ds_read_b128 v[48:51], v3 offset:10240
v_mfma_f32_16x16x32_bf16 v[76:79], v[36:39], a[156:159], v[76:79]
v_mfma_f32_16x16x32_bf16 v[80:83], v[8:11], a[160:163], 0
v_mfma_f32_16x16x32_bf16 v[80:83], v[12:15], a[164:167], v[80:83]
ds_read_b128 v[52:55], v3 offset:11264
v_mfma_f32_16x16x32_bf16 v[80:83], v[16:19], a[168:171], v[80:83]
v_mfma_f32_16x16x32_bf16 v[80:83], v[20:23], a[172:175], v[80:83]
v_mfma_f32_16x16x32_bf16 v[84:87], v[24:27], a[160:163], 0
ds_read_b128 v[56:59], v3 offset:12288
v_mfma_f32_16x16x32_bf16 v[84:87], v[28:31], a[164:167], v[84:87]
v_mfma_f32_16x16x32_bf16 v[84:87], v[32:35], a[168:171], v[84:87]
v_exp_f32 v72, v72
v_mfma_f32_16x16x32_bf16 v[84:87], v[36:39], a[172:175], v[84:87]
ds_read_b128 v[60:63], v3 offset:13312
v_exp_f32 v73, v73
v_mfma_f32_16x16x32_bf16 v[88:91], v[8:11], a[176:179], 0
v_exp_f32 v74, v74
v_mfma_f32_16x16x32_bf16 v[88:91], v[12:15], a[180:183], v[88:91]
v_exp_f32 v75, v75
v_mfma_f32_16x16x32_bf16 v[88:91], v[16:19], a[184:187], v[88:91]
ds_read_b128 v[64:67], v3 offset:14336
v_cvt_pk_bf16_f32 v104, v72, v73
v_mfma_f32_16x16x32_bf16 v[88:91], v[20:23], a[188:191], v[88:91]
v_exp_f32 v76, v76
v_mfma_f32_16x16x32_bf16 v[92:95], v[24:27], a[176:179], 0
v_exp_f32 v77, v77
v_mfma_f32_16x16x32_bf16 v[92:95], v[28:31], a[180:183], v[92:95]
ds_read_b128 v[68:71], v3 offset:15360
v_cvt_pk_bf16_f32 v105, v74, v75
v_mfma_f32_16x16x32_bf16 v[92:95], v[32:35], a[184:187], v[92:95]
v_exp_f32 v78, v78
v_mfma_f32_16x16x32_bf16 v[92:95], v[36:39], a[188:191], v[92:95]
v_exp_f32 v79, v79
v_mfma_f32_16x16x32_bf16 v[96:99], v[8:11], a[192:195], 0
v_cvt_pk_bf16_f32 v106, v76, v77
v_cvt_pk_bf16_f32 v107, v78, v79
v_mfma_f32_16x16x32_bf16 v[96:99], v[12:15], a[196:199], v[96:99]
v_exp_f32 v80, v80
v_mfma_f32_16x16x32_bf16 v[96:99], v[16:19], a[200:203], v[96:99]
v_exp_f32 v81, v81
v_mfma_f32_16x16x32_bf16 v[96:99], v[20:23], a[204:207], v[96:99]
v_exp_f32 v82, v82
v_mfma_f32_16x16x32_bf16 v[100:103], v[24:27], a[192:195], 0
v_exp_f32 v83, v83
v_mfma_f32_16x16x32_bf16 v[100:103], v[28:31], a[196:199], v[100:103]
v_cvt_pk_bf16_f32 v108, v80, v81
v_cvt_pk_bf16_f32 v109, v82, v83
v_mfma_f32_16x16x32_bf16 v[100:103], v[32:35], a[200:203], v[100:103]
v_exp_f32 v84, v84
v_mfma_f32_16x16x32_bf16 v[100:103], v[36:39], a[204:207], v[100:103]
v_exp_f32 v85, v85
s_waitcnt vmcnt(24) lgkmcnt(0)
s_barrier
v_mfma_f32_16x16x32_bf16 a[0:3], v[40:43], v[120:123], a[0:3]
ds_read_b128 v[8:11], v2 offset:24576
v_cvt_pk_bf16_f32 v110, v84, v85
v_mfma_f32_16x16x32_bf16 a[32:35], v[40:43], v[124:127], a[32:35]
s_add_u32 m0, s59, 16384
v_mfma_f32_16x16x32_bf16 a[64:67], v[40:43], v[128:131], a[64:67]
buffer_load_dwordx4 v1, s[4:7], s57 offen offset:0 sc1 lds
v_mfma_f32_16x16x32_bf16 a[96:99], v[40:43], v[132:135], a[96:99]
ds_read_b128 v[12:15], v2 offset:25600
v_exp_f32 v86, v86
v_mfma_f32_16x16x32_bf16 a[4:7], v[44:47], v[120:123], a[4:7]
v_exp_f32 v87, v87
v_mfma_f32_16x16x32_bf16 a[36:39], v[44:47], v[124:127], a[36:39]
v_exp_f32 v88, v88
v_mfma_f32_16x16x32_bf16 a[68:71], v[44:47], v[128:131], a[68:71]
ds_read_b128 v[16:19], v2 offset:26624
buffer_load_dwordx4 v1, s[4:7], s57 offen offset:1024 sc1 lds
v_mfma_f32_16x16x32_bf16 a[100:103], v[44:47], v[132:135], a[100:103]
v_exp_f32 v89, v89
v_mfma_f32_16x16x32_bf16 a[8:11], v[48:51], v[120:123], a[8:11]
v_cvt_pk_bf16_f32 v111, v86, v87
v_cvt_pk_bf16_f32 v112, v88, v89
v_mfma_f32_16x16x32_bf16 a[40:43], v[48:51], v[124:127], a[40:43]
ds_read_b128 v[20:23], v2 offset:27648
v_exp_f32 v90, v90
v_mfma_f32_16x16x32_bf16 a[72:75], v[48:51], v[128:131], a[72:75]
buffer_load_dwordx4 v1, s[4:7], s57 offen offset:2048 sc1 lds
v_exp_f32 v91, v91
v_mfma_f32_16x16x32_bf16 a[104:107], v[48:51], v[132:135], a[104:107]
v_exp_f32 v92, v92
v_mfma_f32_16x16x32_bf16 a[12:15], v[52:55], v[120:123], a[12:15]
ds_read_b128 v[24:27], v2 offset:28672
v_cvt_pk_bf16_f32 v113, v90, v91
v_mfma_f32_16x16x32_bf16 a[44:47], v[52:55], v[124:127], a[44:47]
v_exp_f32 v93, v93
v_mfma_f32_16x16x32_bf16 a[76:79], v[52:55], v[128:131], a[76:79]
buffer_load_dwordx4 v1, s[4:7], s57 offen offset:3072 sc1 lds
v_cvt_pk_bf16_f32 v114, v92, v93
v_mfma_f32_16x16x32_bf16 a[108:111], v[52:55], v[132:135], a[108:111]
ds_read_b128 v[28:31], v2 offset:29696
s_add_u32 s57, s57, 0x4000
v_exp_f32 v94, v94
v_mfma_f32_16x16x32_bf16 a[16:19], v[56:59], v[120:123], a[16:19]
v_exp_f32 v95, v95
v_mfma_f32_16x16x32_bf16 a[48:51], v[56:59], v[124:127], a[48:51]
s_add_u32 m0, s60, 8192
v_cvt_pk_bf16_f32 v115, v94, v95
v_mfma_f32_16x16x32_bf16 a[80:83], v[56:59], v[128:131], a[80:83]
ds_read_b128 v[32:35], v2 offset:30720
buffer_load_dwordx4 v1, s[4:7], s58 offen offset:0 sc1 lds
v_exp_f32 v96, v96
v_mfma_f32_16x16x32_bf16 a[112:115], v[56:59], v[132:135], a[112:115]
v_exp_f32 v97, v97
v_mfma_f32_16x16x32_bf16 a[20:23], v[60:63], v[120:123], a[20:23]
v_exp_f32 v98, v98
v_mfma_f32_16x16x32_bf16 a[52:55], v[60:63], v[124:127], a[52:55]
ds_read_b128 v[36:39], v2 offset:31744
v_cvt_pk_bf16_f32 v116, v96, v97
v_mfma_f32_16x16x32_bf16 a[84:87], v[60:63], v[128:131], a[84:87]
buffer_load_dwordx4 v1, s[4:7], s58 offen offset:1024 sc1 lds
v_exp_f32 v99, v99
v_mfma_f32_16x16x32_bf16 a[116:119], v[60:63], v[132:135], a[116:119]
v_exp_f32 v100, v100
v_mfma_f32_16x16x32_bf16 a[24:27], v[64:67], v[120:123], a[24:27]
v_exp_f32 v101, v101
v_mfma_f32_16x16x32_bf16 a[56:59], v[64:67], v[124:127], a[56:59]
v_cvt_pk_bf16_f32 v117, v98, v99
v_cvt_pk_bf16_f32 v118, v100, v101
v_mfma_f32_16x16x32_bf16 a[88:91], v[64:67], v[128:131], a[88:91]
buffer_load_dwordx4 v1, s[4:7], s58 offen offset:2048 sc1 lds
v_mfma_f32_16x16x32_bf16 a[120:123], v[64:67], v[132:135], a[120:123]
v_exp_f32 v102, v102
v_mfma_f32_16x16x32_bf16 a[28:31], v[68:71], v[120:123], a[28:31]
v_exp_f32 v103, v103
v_mfma_f32_16x16x32_bf16 a[60:63], v[68:71], v[124:127], a[60:63]
v_cvt_pk_bf16_f32 v119, v102, v103
v_mfma_f32_16x16x32_bf16 a[92:95], v[68:71], v[128:131], a[92:95]
buffer_load_dwordx4 v1, s[4:7], s58 offen offset:3072 sc1 lds
v_mfma_f32_16x16x32_bf16 a[124:127], v[68:71], v[132:135], a[124:127]
s_add_u32 s58, s58, 0x4000
v_mfma_f32_16x16x32_bf16 a[128:131], v[136:139], v[120:123], a[128:131]
v_mfma_f32_16x16x32_bf16 a[132:135], v[136:139], v[124:127], a[132:135]
v_mfma_f32_16x16x32_bf16 a[136:139], v[136:139], v[128:131], a[136:139]
v_mfma_f32_16x16x32_bf16 a[140:143], v[136:139], v[132:135], a[140:143]
s_waitcnt lgkmcnt(0)
v_mfma_f32_16x16x32_bf16 v[72:75], v[8:11], a[144:147], 0
ds_read_b128 v[40:43], v3 offset:16384
v_mfma_f32_16x16x32_bf16 v[72:75], v[12:15], a[148:151], v[72:75]
v_mfma_f32_16x16x32_bf16 v[72:75], v[16:19], a[152:155], v[72:75]
v_mfma_f32_16x16x32_bf16 v[72:75], v[20:23], a[156:159], v[72:75]
ds_read_b128 v[44:47], v3 offset:17408
v_mfma_f32_16x16x32_bf16 v[76:79], v[24:27], a[144:147], 0
v_mfma_f32_16x16x32_bf16 v[76:79], v[28:31], a[148:151], v[76:79]
v_mfma_f32_16x16x32_bf16 v[76:79], v[32:35], a[152:155], v[76:79]
ds_read_b128 v[48:51], v3 offset:18432
v_mfma_f32_16x16x32_bf16 v[76:79], v[36:39], a[156:159], v[76:79]
v_mfma_f32_16x16x32_bf16 v[80:83], v[8:11], a[160:163], 0
v_mfma_f32_16x16x32_bf16 v[80:83], v[12:15], a[164:167], v[80:83]
ds_read_b128 v[52:55], v3 offset:19456
v_mfma_f32_16x16x32_bf16 v[80:83], v[16:19], a[168:171], v[80:83]
v_mfma_f32_16x16x32_bf16 v[80:83], v[20:23], a[172:175], v[80:83]
v_mfma_f32_16x16x32_bf16 v[84:87], v[24:27], a[160:163], 0
ds_read_b128 v[56:59], v3 offset:20480
v_mfma_f32_16x16x32_bf16 v[84:87], v[28:31], a[164:167], v[84:87]
v_mfma_f32_16x16x32_bf16 v[84:87], v[32:35], a[168:171], v[84:87]
v_exp_f32 v72, v72
v_mfma_f32_16x16x32_bf16 v[84:87], v[36:39], a[172:175], v[84:87]
ds_read_b128 v[60:63], v3 offset:21504
v_exp_f32 v73, v73
v_mfma_f32_16x16x32_bf16 v[88:91], v[8:11], a[176:179], 0
v_exp_f32 v74, v74
v_mfma_f32_16x16x32_bf16 v[88:91], v[12:15], a[180:183], v[88:91]
v_exp_f32 v75, v75
v_mfma_f32_16x16x32_bf16 v[88:91], v[16:19], a[184:187], v[88:91]
ds_read_b128 v[64:67], v3 offset:22528
v_cvt_pk_bf16_f32 v120, v72, v73
v_mfma_f32_16x16x32_bf16 v[88:91], v[20:23], a[188:191], v[88:91]
v_exp_f32 v76, v76
v_mfma_f32_16x16x32_bf16 v[92:95], v[24:27], a[176:179], 0
v_exp_f32 v77, v77
v_mfma_f32_16x16x32_bf16 v[92:95], v[28:31], a[180:183], v[92:95]
ds_read_b128 v[68:71], v3 offset:23552
v_cvt_pk_bf16_f32 v121, v74, v75
v_mfma_f32_16x16x32_bf16 v[92:95], v[32:35], a[184:187], v[92:95]
v_exp_f32 v78, v78
v_mfma_f32_16x16x32_bf16 v[92:95], v[36:39], a[188:191], v[92:95]
v_exp_f32 v79, v79
v_mfma_f32_16x16x32_bf16 v[96:99], v[8:11], a[192:195], 0
v_cvt_pk_bf16_f32 v122, v76, v77
v_cvt_pk_bf16_f32 v123, v78, v79
v_mfma_f32_16x16x32_bf16 v[96:99], v[12:15], a[196:199], v[96:99]
v_exp_f32 v80, v80
v_mfma_f32_16x16x32_bf16 v[96:99], v[16:19], a[200:203], v[96:99]
v_exp_f32 v81, v81
v_mfma_f32_16x16x32_bf16 v[96:99], v[20:23], a[204:207], v[96:99]
v_exp_f32 v82, v82
v_mfma_f32_16x16x32_bf16 v[100:103], v[24:27], a[192:195], 0
v_exp_f32 v83, v83
v_mfma_f32_16x16x32_bf16 v[100:103], v[28:31], a[196:199], v[100:103]
v_cvt_pk_bf16_f32 v124, v80, v81
v_cvt_pk_bf16_f32 v125, v82, v83
v_mfma_f32_16x16x32_bf16 v[100:103], v[32:35], a[200:203], v[100:103]
v_exp_f32 v84, v84
v_mfma_f32_16x16x32_bf16 v[100:103], v[36:39], a[204:207], v[100:103]
v_exp_f32 v85, v85
s_waitcnt vmcnt(20) lgkmcnt(0)
s_barrier
v_mfma_f32_16x16x32_bf16 a[0:3], v[40:43], v[104:107], a[0:3]
ds_read_b128 v[8:11], v2 offset:0
v_cvt_pk_bf16_f32 v126, v84, v85
v_mfma_f32_16x16x32_bf16 a[32:35], v[40:43], v[108:111], a[32:35]
s_add_u32 m0, s59, 24576
v_mfma_f32_16x16x32_bf16 a[64:67], v[40:43], v[112:115], a[64:67]
buffer_load_dwordx4 v1, s[4:7], s57 offen offset:0 sc1 lds
v_mfma_f32_16x16x32_bf16 a[96:99], v[40:43], v[116:119], a[96:99]
ds_read_b128 v[12:15], v2 offset:1024
v_exp_f32 v86, v86
v_mfma_f32_16x16x32_bf16 a[4:7], v[44:47], v[104:107], a[4:7]
v_exp_f32 v87, v87
v_mfma_f32_16x16x32_bf16 a[36:39], v[44:47], v[108:111], a[36:39]
v_exp_f32 v88, v88
v_mfma_f32_16x16x32_bf16 a[68:71], v[44:47], v[112:115], a[68:71]
ds_read_b128 v[16:19], v2 offset:2048
buffer_load_dwordx4 v1, s[4:7], s57 offen offset:1024 sc1 lds
v_mfma_f32_16x16x32_bf16 a[100:103], v[44:47], v[116:119], a[100:103]
v_exp_f32 v89, v89
v_mfma_f32_16x16x32_bf16 a[8:11], v[48:51], v[104:107], a[8:11]
v_cvt_pk_bf16_f32 v127, v86, v87
v_cvt_pk_bf16_f32 v128, v88, v89
v_mfma_f32_16x16x32_bf16 a[40:43], v[48:51], v[108:111], a[40:43]
ds_read_b128 v[20:23], v2 offset:3072
v_exp_f32 v90, v90
v_mfma_f32_16x16x32_bf16 a[72:75], v[48:51], v[112:115], a[72:75]
buffer_load_dwordx4 v1, s[4:7], s57 offen offset:2048 sc1 lds
v_exp_f32 v91, v91
v_mfma_f32_16x16x32_bf16 a[104:107], v[48:51], v[116:119], a[104:107]
v_exp_f32 v92, v92
v_mfma_f32_16x16x32_bf16 a[12:15], v[52:55], v[104:107], a[12:15]
ds_read_b128 v[24:27], v2 offset:4096
v_cvt_pk_bf16_f32 v129, v90, v91
v_mfma_f32_16x16x32_bf16 a[44:47], v[52:55], v[108:111], a[44:47]
v_exp_f32 v93, v93
v_mfma_f32_16x16x32_bf16 a[76:79], v[52:55], v[112:115], a[76:79]
buffer_load_dwordx4 v1, s[4:7], s57 offen offset:3072 sc1 lds
v_cvt_pk_bf16_f32 v130, v92, v93
v_mfma_f32_16x16x32_bf16 a[108:111], v[52:55], v[116:119], a[108:111]
ds_read_b128 v[28:31], v2 offset:5120
s_add_u32 s57, s57, 0x4000
v_exp_f32 v94, v94
v_mfma_f32_16x16x32_bf16 a[16:19], v[56:59], v[104:107], a[16:19]
v_exp_f32 v95, v95
v_mfma_f32_16x16x32_bf16 a[48:51], v[56:59], v[108:111], a[48:51]
s_add_u32 m0, s60, 16384
v_cvt_pk_bf16_f32 v131, v94, v95
v_mfma_f32_16x16x32_bf16 a[80:83], v[56:59], v[112:115], a[80:83]
ds_read_b128 v[32:35], v2 offset:6144
buffer_load_dwordx4 v1, s[4:7], s58 offen offset:0 sc1 lds
v_exp_f32 v96, v96
v_mfma_f32_16x16x32_bf16 a[112:115], v[56:59], v[116:119], a[112:115]
v_exp_f32 v97, v97
v_mfma_f32_16x16x32_bf16 a[20:23], v[60:63], v[104:107], a[20:23]
v_exp_f32 v98, v98
v_mfma_f32_16x16x32_bf16 a[52:55], v[60:63], v[108:111], a[52:55]
ds_read_b128 v[36:39], v2 offset:7168
v_cvt_pk_bf16_f32 v132, v96, v97
v_mfma_f32_16x16x32_bf16 a[84:87], v[60:63], v[112:115], a[84:87]
buffer_load_dwordx4 v1, s[4:7], s58 offen offset:1024 sc1 lds
v_exp_f32 v99, v99
v_mfma_f32_16x16x32_bf16 a[116:119], v[60:63], v[116:119], a[116:119]
v_exp_f32 v100, v100
v_mfma_f32_16x16x32_bf16 a[24:27], v[64:67], v[104:107], a[24:27]
v_exp_f32 v101, v101
v_mfma_f32_16x16x32_bf16 a[56:59], v[64:67], v[108:111], a[56:59]
v_cvt_pk_bf16_f32 v133, v98, v99
v_cvt_pk_bf16_f32 v134, v100, v101
v_mfma_f32_16x16x32_bf16 a[88:91], v[64:67], v[112:115], a[88:91]
buffer_load_dwordx4 v1, s[4:7], s58 offen offset:2048 sc1 lds
v_mfma_f32_16x16x32_bf16 a[120:123], v[64:67], v[116:119], a[120:123]
v_exp_f32 v102, v102
v_mfma_f32_16x16x32_bf16 a[28:31], v[68:71], v[104:107], a[28:31]
v_exp_f32 v103, v103
v_mfma_f32_16x16x32_bf16 a[60:63], v[68:71], v[108:111], a[60:63]
v_cvt_pk_bf16_f32 v135, v102, v103
v_mfma_f32_16x16x32_bf16 a[92:95], v[68:71], v[112:115], a[92:95]
buffer_load_dwordx4 v1, s[4:7], s58 offen offset:3072 sc1 lds
v_mfma_f32_16x16x32_bf16 a[124:127], v[68:71], v[116:119], a[124:127]
s_add_u32 s58, s58, 0x4000
v_mfma_f32_16x16x32_bf16 a[128:131], v[136:139], v[104:107], a[128:131]
v_mfma_f32_16x16x32_bf16 a[132:135], v[136:139], v[108:111], a[132:135]
v_mfma_f32_16x16x32_bf16 a[136:139], v[136:139], v[112:115], a[136:139]
v_mfma_f32_16x16x32_bf16 a[140:143], v[136:139], v[116:119], a[140:143]
s_mov_b32 s62, 0x7f000000
s_mov_b32 s63, 0x7f000000
s_mov_b32 s64, 0x7f000000
s_mov_b32 s65, 0x7f000000
s_add_u32 s66, s66, 0x20000
s_lshl_b32 s68, s68, 1
s_lshl_b32 s69, s69, 1
s_or_b32 s69, s69, 1
s_add_u32 s61, s61, 1
s_cmp_lt_u32 s61, 2
s_cbranch_scc1 L_prepV
.p2align 6
L_plain:
s_waitcnt lgkmcnt(0)
v_mfma_f32_16x16x32_bf16 v[72:75], v[8:11], a[144:147], 0
ds_read_b128 v[40:43], v3 offset:24576
v_mfma_f32_16x16x32_bf16 v[72:75], v[12:15], a[148:151], v[72:75]
v_mfma_f32_16x16x32_bf16 v[72:75], v[16:19], a[152:155], v[72:75]
v_mfma_f32_16x16x32_bf16 v[72:75], v[20:23], a[156:159], v[72:75]
ds_read_b128 v[44:47], v3 offset:25600
v_mfma_f32_16x16x32_bf16 v[76:79], v[24:27], a[144:147], 0
v_mfma_f32_16x16x32_bf16 v[76:79], v[28:31], a[148:151], v[76:79]
v_mfma_f32_16x16x32_bf16 v[76:79], v[32:35], a[152:155], v[76:79]
ds_read_b128 v[48:51], v3 offset:26624
v_mfma_f32_16x16x32_bf16 v[76:79], v[36:39], a[156:159], v[76:79]
v_mfma_f32_16x16x32_bf16 v[80:83], v[8:11], a[160:163], 0
v_mfma_f32_16x16x32_bf16 v[80:83], v[12:15], a[164:167], v[80:83]
ds_read_b128 v[52:55], v3 offset:27648
v_mfma_f32_16x16x32_bf16 v[80:83], v[16:19], a[168:171], v[80:83]
v_mfma_f32_16x16x32_bf16 v[80:83], v[20:23], a[172:175], v[80:83]
v_mfma_f32_16x16x32_bf16 v[84:87], v[24:27], a[160:163], 0
ds_read_b128 v[56:59], v3 offset:28672
v_mfma_f32_16x16x32_bf16 v[84:87], v[28:31], a[164:167], v[84:87]
v_mfma_f32_16x16x32_bf16 v[84:87], v[32:35], a[168:171], v[84:87]
v_exp_f32 v72, v72
v_mfma_f32_16x16x32_bf16 v[84:87], v[36:39], a[172:175], v[84:87]
ds_read_b128 v[60:63], v3 offset:29696
v_exp_f32 v73, v73
v_mfma_f32_16x16x32_bf16 v[88:91], v[8:11], a[176:179], 0
v_exp_f32 v74, v74
v_mfma_f32_16x16x32_bf16 v[88:91], v[12:15], a[180:183], v[88:91]
v_exp_f32 v75, v75
v_mfma_f32_16x16x32_bf16 v[88:91], v[16:19], a[184:187], v[88:91]
ds_read_b128 v[64:67], v3 offset:30720
v_cvt_pk_bf16_f32 v104, v72, v73
v_mfma_f32_16x16x32_bf16 v[88:91], v[20:23], a[188:191], v[88:91]
v_exp_f32 v76, v76
v_mfma_f32_16x16x32_bf16 v[92:95], v[24:27], a[176:179], 0
v_exp_f32 v77, v77
v_mfma_f32_16x16x32_bf16 v[92:95], v[28:31], a[180:183], v[92:95]
ds_read_b128 v[68:71], v3 offset:31744
v_cvt_pk_bf16_f32 v105, v74, v75
v_mfma_f32_16x16x32_bf16 v[92:95], v[32:35], a[184:187], v[92:95]
v_exp_f32 v78, v78
v_mfma_f32_16x16x32_bf16 v[92:95], v[36:39], a[188:191], v[92:95]
v_exp_f32 v79, v79
v_mfma_f32_16x16x32_bf16 v[96:99], v[8:11], a[192:195], 0
v_cvt_pk_bf16_f32 v106, v76, v77
v_cvt_pk_bf16_f32 v107, v78, v79
v_mfma_f32_16x16x32_bf16 v[96:99], v[12:15], a[196:199], v[96:99]
v_exp_f32 v80, v80
v_mfma_f32_16x16x32_bf16 v[96:99], v[16:19], a[200:203], v[96:99]
v_exp_f32 v81, v81
v_mfma_f32_16x16x32_bf16 v[96:99], v[20:23], a[204:207], v[96:99]
v_exp_f32 v82, v82
v_mfma_f32_16x16x32_bf16 v[100:103], v[24:27], a[192:195], 0
v_exp_f32 v83, v83
v_mfma_f32_16x16x32_bf16 v[100:103], v[28:31], a[196:199], v[100:103]
v_cvt_pk_bf16_f32 v108, v80, v81
v_cvt_pk_bf16_f32 v109, v82, v83
v_mfma_f32_16x16x32_bf16 v[100:103], v[32:35], a[200:203], v[100:103]
v_exp_f32 v84, v84
v_mfma_f32_16x16x32_bf16 v[100:103], v[36:39], a[204:207], v[100:103]
v_exp_f32 v85, v85
s_waitcnt vmcnt(16) lgkmcnt(0)
s_barrier
v_mfma_f32_16x16x32_bf16 a[0:3], v[40:43], v[120:123], a[0:3]
ds_read_b128 v[8:11], v2 offset:8192
v_cvt_pk_bf16_f32 v110, v84, v85
v_mfma_f32_16x16x32_bf16 a[32:35], v[40:43], v[124:127], a[32:35]
s_add_u32 m0, s59, 0
v_mfma_f32_16x16x32_bf16 a[64:67], v[40:43], v[128:131], a[64:67]
buffer_load_dwordx4 v1, s[4:7], s57 offen offset:0 sc1 lds
v_mfma_f32_16x16x32_bf16 a[96:99], v[40:43], v[132:135], a[96:99]
ds_read_b128 v[12:15], v2 offset:9216
v_exp_f32 v86, v86
v_mfma_f32_16x16x32_bf16 a[4:7], v[44:47], v[120:123], a[4:7]
v_mov_b32 v244, s69
v_exp_f32 v87, v87
v_mfma_f32_16x16x32_bf16 a[36:39], v[44:47], v[124:127], a[36:39]
buffer_store_byte v244, v245, s[32:35], 0 offen sc1
v_cvt_pk_bf16_f32 v111, v86, v87
v_mfma_f32_16x16x32_bf16 a[68:71], v[44:47], v[128:131], a[68:71]
ds_read_b128 v[16:19], v2 offset:10240
buffer_load_dwordx4 v1, s[4:7], s57 offen offset:1024 sc1 lds
v_exp_f32 v88, v88
v_mfma_f32_16x16x32_bf16 a[100:103], v[44:47], v[132:135], a[100:103]
v_exp_f32 v89, v89
v_mfma_f32_16x16x32_bf16 a[8:11], v[48:51], v[120:123], a[8:11]
v_exp_f32 v90, v90
v_mfma_f32_16x16x32_bf16 a[40:43], v[48:51], v[124:127], a[40:43]
ds_read_b128 v[20:23], v2 offset:11264
v_cvt_pk_bf16_f32 v112, v88, v89
v_mfma_f32_16x16x32_bf16 a[72:75], v[48:51], v[128:131], a[72:75]
buffer_load_dwordx4 v1, s[4:7], s57 offen offset:2048 sc1 lds
v_exp_f32 v91, v91
v_mfma_f32_16x16x32_bf16 a[104:107], v[48:51], v[132:135], a[104:107]
v_exp_f32 v92, v92
v_mfma_f32_16x16x32_bf16 a[12:15], v[52:55], v[120:123], a[12:15]
ds_read_b128 v[24:27], v2 offset:12288
v_cvt_pk_bf16_f32 v113, v90, v91
v_mfma_f32_16x16x32_bf16 a[44:47], v[52:55], v[124:127], a[44:47]
v_exp_f32 v93, v93
v_mfma_f32_16x16x32_bf16 a[76:79], v[52:55], v[128:131], a[76:79]
buffer_load_dwordx4 v1, s[4:7], s57 offen offset:3072 sc1 lds
v_cvt_pk_bf16_f32 v114, v92, v93
v_mfma_f32_16x16x32_bf16 a[108:111], v[52:55], v[132:135], a[108:111]
ds_read_b128 v[28:31], v2 offset:13312
s_add_u32 s57, s57, 0x4000
v_exp_f32 v94, v94
v_mfma_f32_16x16x32_bf16 a[16:19], v[56:59], v[120:123], a[16:19]
v_exp_f32 v95, v95
v_mfma_f32_16x16x32_bf16 a[48:51], v[56:59], v[124:127], a[48:51]
s_add_u32 m0, s60, 24576
v_cvt_pk_bf16_f32 v115, v94, v95
v_mfma_f32_16x16x32_bf16 a[80:83], v[56:59], v[128:131], a[80:83]
ds_read_b128 v[32:35], v2 offset:14336
buffer_load_dwordx4 v1, s[4:7], s58 offen offset:0 sc1 lds
v_exp_f32 v96, v96
v_mfma_f32_16x16x32_bf16 a[112:115], v[56:59], v[132:135], a[112:115]
v_exp_f32 v97, v97
v_mfma_f32_16x16x32_bf16 a[20:23], v[60:63], v[120:123], a[20:23]
v_exp_f32 v98, v98
v_mfma_f32_16x16x32_bf16 a[52:55], v[60:63], v[124:127], a[52:55]
ds_read_b128 v[36:39], v2 offset:15360
v_cvt_pk_bf16_f32 v116, v96, v97
v_mfma_f32_16x16x32_bf16 a[84:87], v[60:63], v[128:131], a[84:87]
buffer_load_dwordx4 v1, s[4:7], s58 offen offset:1024 sc1 lds
v_exp_f32 v99, v99
v_mfma_f32_16x16x32_bf16 a[116:119], v[60:63], v[132:135], a[116:119]
v_exp_f32 v100, v100
v_mfma_f32_16x16x32_bf16 a[24:27], v[64:67], v[120:123], a[24:27]
v_exp_f32 v101, v101
v_mfma_f32_16x16x32_bf16 a[56:59], v[64:67], v[124:127], a[56:59]
v_cvt_pk_bf16_f32 v117, v98, v99
v_cvt_pk_bf16_f32 v118, v100, v101
v_mfma_f32_16x16x32_bf16 a[88:91], v[64:67], v[128:131], a[88:91]
buffer_load_dwordx4 v1, s[4:7], s58 offen offset:2048 sc1 lds
v_mfma_f32_16x16x32_bf16 a[120:123], v[64:67], v[132:135], a[120:123]
v_exp_f32 v102, v102
v_mfma_f32_16x16x32_bf16 a[28:31], v[68:71], v[120:123], a[28:31]
v_exp_f32 v103, v103
v_mfma_f32_16x16x32_bf16 a[60:63], v[68:71], v[124:127], a[60:63]
v_cvt_pk_bf16_f32 v119, v102, v103
v_mfma_f32_16x16x32_bf16 a[92:95], v[68:71], v[128:131], a[92:95]
buffer_load_dwordx4 v1, s[4:7], s58 offen offset:3072 sc1 lds
v_mfma_f32_16x16x32_bf16 a[124:127], v[68:71], v[132:135], a[124:127]
s_add_u32 s58, s58, 0x4000
v_mfma_f32_16x16x32_bf16 a[128:131], v[136:139], v[120:123], a[128:131]
v_mfma_f32_16x16x32_bf16 a[132:135], v[136:139], v[124:127], a[132:135]
v_mfma_f32_16x16x32_bf16 a[136:139], v[136:139], v[128:131], a[136:139]
v_mfma_f32_16x16x32_bf16 a[140:143], v[136:139], v[132:135], a[140:143]
s_waitcnt lgkmcnt(0)
v_mfma_f32_16x16x32_bf16 v[72:75], v[8:11], a[144:147], 0
ds_read_b128 v[40:43], v3 offset:0
v_mfma_f32_16x16x32_bf16 v[72:75], v[12:15], a[148:151], v[72:75]
v_mfma_f32_16x16x32_bf16 v[72:75], v[16:19], a[152:155], v[72:75]
v_mfma_f32_16x16x32_bf16 v[72:75], v[20:23], a[156:159], v[72:75]
ds_read_b128 v[44:47], v3 offset:1024
v_mfma_f32_16x16x32_bf16 v[76:79], v[24:27], a[144:147], 0
v_mfma_f32_16x16x32_bf16 v[76:79], v[28:31], a[148:151], v[76:79]
v_mfma_f32_16x16x32_bf16 v[76:79], v[32:35], a[152:155], v[76:79]
ds_read_b128 v[48:51], v3 offset:2048
v_mfma_f32_16x16x32_bf16 v[76:79], v[36:39], a[156:159], v[76:79]
v_mfma_f32_16x16x32_bf16 v[80:83], v[8:11], a[160:163], 0
v_mfma_f32_16x16x32_bf16 v[80:83], v[12:15], a[164:167], v[80:83]
ds_read_b128 v[52:55], v3 offset:3072
v_mfma_f32_16x16x32_bf16 v[80:83], v[16:19], a[168:171], v[80:83]
v_mfma_f32_16x16x32_bf16 v[80:83], v[20:23], a[172:175], v[80:83]
v_mfma_f32_16x16x32_bf16 v[84:87], v[24:27], a[160:163], 0
ds_read_b128 v[56:59], v3 offset:4096
v_mfma_f32_16x16x32_bf16 v[84:87], v[28:31], a[164:167], v[84:87]
v_mfma_f32_16x16x32_bf16 v[84:87], v[32:35], a[168:171], v[84:87]
v_exp_f32 v72, v72
v_mfma_f32_16x16x32_bf16 v[84:87], v[36:39], a[172:175], v[84:87]
ds_read_b128 v[60:63], v3 offset:5120
v_exp_f32 v73, v73
v_mfma_f32_16x16x32_bf16 v[88:91], v[8:11], a[176:179], 0
v_exp_f32 v74, v74
v_mfma_f32_16x16x32_bf16 v[88:91], v[12:15], a[180:183], v[88:91]
v_exp_f32 v75, v75
v_mfma_f32_16x16x32_bf16 v[88:91], v[16:19], a[184:187], v[88:91]
ds_read_b128 v[64:67], v3 offset:6144
v_cvt_pk_bf16_f32 v120, v72, v73
v_mfma_f32_16x16x32_bf16 v[88:91], v[20:23], a[188:191], v[88:91]
v_exp_f32 v76, v76
v_mfma_f32_16x16x32_bf16 v[92:95], v[24:27], a[176:179], 0
v_exp_f32 v77, v77
v_mfma_f32_16x16x32_bf16 v[92:95], v[28:31], a[180:183], v[92:95]
ds_read_b128 v[68:71], v3 offset:7168
v_cvt_pk_bf16_f32 v121, v74, v75
v_mfma_f32_16x16x32_bf16 v[92:95], v[32:35], a[184:187], v[92:95]
v_exp_f32 v78, v78
v_mfma_f32_16x16x32_bf16 v[92:95], v[36:39], a[188:191], v[92:95]
v_exp_f32 v79, v79
v_mfma_f32_16x16x32_bf16 v[96:99], v[8:11], a[192:195], 0
v_cvt_pk_bf16_f32 v122, v76, v77
v_cvt_pk_bf16_f32 v123, v78, v79
v_mfma_f32_16x16x32_bf16 v[96:99], v[12:15], a[196:199], v[96:99]
v_exp_f32 v80, v80
v_mfma_f32_16x16x32_bf16 v[96:99], v[16:19], a[200:203], v[96:99]
v_exp_f32 v81, v81
v_mfma_f32_16x16x32_bf16 v[96:99], v[20:23], a[204:207], v[96:99]
v_exp_f32 v82, v82
v_mfma_f32_16x16x32_bf16 v[100:103], v[24:27], a[192:195], 0
v_exp_f32 v83, v83
v_mfma_f32_16x16x32_bf16 v[100:103], v[28:31], a[196:199], v[100:103]
v_cvt_pk_bf16_f32 v124, v80, v81
v_cvt_pk_bf16_f32 v125, v82, v83
v_mfma_f32_16x16x32_bf16 v[100:103], v[32:35], a[200:203], v[100:103]
v_exp_f32 v84, v84
v_mfma_f32_16x16x32_bf16 v[100:103], v[36:39], a[204:207], v[100:103]
v_exp_f32 v85, v85
s_waitcnt vmcnt(17) lgkmcnt(0)
s_barrier
v_mfma_f32_16x16x32_bf16 a[0:3], v[40:43], v[104:107], a[0:3]
ds_read_b128 v[8:11], v2 offset:16384
v_cvt_pk_bf16_f32 v126, v84, v85
v_mfma_f32_16x16x32_bf16 a[32:35], v[40:43], v[108:111], a[32:35]
s_add_u32 m0, s59, 8192
v_mfma_f32_16x16x32_bf16 a[64:67], v[40:43], v[112:115], a[64:67]
buffer_load_dwordx4 v1, s[4:7], s57 offen offset:0 sc1 lds
v_mfma_f32_16x16x32_bf16 a[96:99], v[40:43], v[116:119], a[96:99]
ds_read_b128 v[12:15], v2 offset:17408
v_exp_f32 v86, v86
v_mfma_f32_16x16x32_bf16 a[4:7], v[44:47], v[104:107], a[4:7]
v_exp_f32 v87, v87
v_mfma_f32_16x16x32_bf16 a[36:39], v[44:47], v[108:111], a[36:39]
v_exp_f32 v88, v88
v_mfma_f32_16x16x32_bf16 a[68:71], v[44:47], v[112:115], a[68:71]
ds_read_b128 v[16:19], v2 offset:18432
buffer_load_dwordx4 v1, s[4:7], s57 offen offset:1024 sc1 lds
v_mfma_f32_16x16x32_bf16 a[100:103], v[44:47], v[116:119], a[100:103]
v_exp_f32 v89, v89
v_mfma_f32_16x16x32_bf16 a[8:11], v[48:51], v[104:107], a[8:11]
v_cvt_pk_bf16_f32 v127, v86, v87
v_cvt_pk_bf16_f32 v128, v88, v89
v_mfma_f32_16x16x32_bf16 a[40:43], v[48:51], v[108:111], a[40:43]
ds_read_b128 v[20:23], v2 offset:19456
v_exp_f32 v90, v90
v_mfma_f32_16x16x32_bf16 a[72:75], v[48:51], v[112:115], a[72:75]
buffer_load_dwordx4 v1, s[4:7], s57 offen offset:2048 sc1 lds
v_exp_f32 v91, v91
v_mfma_f32_16x16x32_bf16 a[104:107], v[48:51], v[116:119], a[104:107]
v_exp_f32 v92, v92
v_mfma_f32_16x16x32_bf16 a[12:15], v[52:55], v[104:107], a[12:15]
ds_read_b128 v[24:27], v2 offset:20480
v_cvt_pk_bf16_f32 v129, v90, v91
v_mfma_f32_16x16x32_bf16 a[44:47], v[52:55], v[108:111], a[44:47]
v_exp_f32 v93, v93
v_mfma_f32_16x16x32_bf16 a[76:79], v[52:55], v[112:115], a[76:79]
buffer_load_dwordx4 v1, s[4:7], s57 offen offset:3072 sc1 lds
v_cvt_pk_bf16_f32 v130, v92, v93
v_mfma_f32_16x16x32_bf16 a[108:111], v[52:55], v[116:119], a[108:111]
ds_read_b128 v[28:31], v2 offset:21504
s_add_u32 s57, s57, 0x4000
v_exp_f32 v94, v94
v_mfma_f32_16x16x32_bf16 a[16:19], v[56:59], v[104:107], a[16:19]
v_exp_f32 v95, v95
v_mfma_f32_16x16x32_bf16 a[48:51], v[56:59], v[108:111], a[48:51]
s_add_u32 m0, s60, 0
v_cvt_pk_bf16_f32 v131, v94, v95
v_mfma_f32_16x16x32_bf16 a[80:83], v[56:59], v[112:115], a[80:83]
ds_read_b128 v[32:35], v2 offset:22528
buffer_load_dwordx4 v1, s[4:7], s58 offen offset:0 sc1 lds
v_exp_f32 v96, v96
v_mfma_f32_16x16x32_bf16 a[112:115], v[56:59], v[116:119], a[112:115]
v_exp_f32 v97, v97
v_mfma_f32_16x16x32_bf16 a[20:23], v[60:63], v[104:107], a[20:23]
v_exp_f32 v98, v98
v_mfma_f32_16x16x32_bf16 a[52:55], v[60:63], v[108:111], a[52:55]
ds_read_b128 v[36:39], v2 offset:23552
v_cvt_pk_bf16_f32 v132, v96, v97
v_mfma_f32_16x16x32_bf16 a[84:87], v[60:63], v[112:115], a[84:87]
buffer_load_dwordx4 v1, s[4:7], s58 offen offset:1024 sc1 lds
v_exp_f32 v99, v99
v_mfma_f32_16x16x32_bf16 a[116:119], v[60:63], v[116:119], a[116:119]
v_exp_f32 v100, v100
v_mfma_f32_16x16x32_bf16 a[24:27], v[64:67], v[104:107], a[24:27]
v_exp_f32 v101, v101
v_mfma_f32_16x16x32_bf16 a[56:59], v[64:67], v[108:111], a[56:59]
v_cvt_pk_bf16_f32 v133, v98, v99
v_cvt_pk_bf16_f32 v134, v100, v101
v_mfma_f32_16x16x32_bf16 a[88:91], v[64:67], v[112:115], a[88:91]
buffer_load_dwordx4 v1, s[4:7], s58 offen offset:2048 sc1 lds
v_mfma_f32_16x16x32_bf16 a[120:123], v[64:67], v[116:119], a[120:123]
v_exp_f32 v102, v102
v_mfma_f32_16x16x32_bf16 a[28:31], v[68:71], v[104:107], a[28:31]
v_exp_f32 v103, v103
v_mfma_f32_16x16x32_bf16 a[60:63], v[68:71], v[108:111], a[60:63]
v_cvt_pk_bf16_f32 v135, v102, v103
v_mfma_f32_16x16x32_bf16 a[92:95], v[68:71], v[112:115], a[92:95]
buffer_load_dwordx4 v1, s[4:7], s58 offen offset:3072 sc1 lds
v_mfma_f32_16x16x32_bf16 a[124:127], v[68:71], v[116:119], a[124:127]
s_add_u32 s58, s58, 0x4000
v_mfma_f32_16x16x32_bf16 a[128:131], v[136:139], v[104:107], a[128:131]
v_mfma_f32_16x16x32_bf16 a[132:135], v[136:139], v[108:111], a[132:135]
v_mfma_f32_16x16x32_bf16 a[136:139], v[136:139], v[112:115], a[136:139]
v_mfma_f32_16x16x32_bf16 a[140:143], v[136:139], v[116:119], a[140:143]
s_waitcnt lgkmcnt(0)
v_mfma_f32_16x16x32_bf16 v[72:75], v[8:11], a[144:147], 0
ds_read_b128 v[40:43], v3 offset:8192
v_mfma_f32_16x16x32_bf16 v[72:75], v[12:15], a[148:151], v[72:75]
v_mfma_f32_16x16x32_bf16 v[72:75], v[16:19], a[152:155], v[72:75]
v_mfma_f32_16x16x32_bf16 v[72:75], v[20:23], a[156:159], v[72:75]
ds_read_b128 v[44:47], v3 offset:9216
v_mfma_f32_16x16x32_bf16 v[76:79], v[24:27], a[144:147], 0
v_mfma_f32_16x16x32_bf16 v[76:79], v[28:31], a[148:151], v[76:79]
v_mfma_f32_16x16x32_bf16 v[76:79], v[32:35], a[152:155], v[76:79]
ds_read_b128 v[48:51], v3 offset:10240
v_mfma_f32_16x16x32_bf16 v[76:79], v[36:39], a[156:159], v[76:79]
v_mfma_f32_16x16x32_bf16 v[80:83], v[8:11], a[160:163], 0
v_mfma_f32_16x16x32_bf16 v[80:83], v[12:15], a[164:167], v[80:83]
ds_read_b128 v[52:55], v3 offset:11264
v_mfma_f32_16x16x32_bf16 v[80:83], v[16:19], a[168:171], v[80:83]
v_mfma_f32_16x16x32_bf16 v[80:83], v[20:23], a[172:175], v[80:83]
v_mfma_f32_16x16x32_bf16 v[84:87], v[24:27], a[160:163], 0
ds_read_b128 v[56:59], v3 offset:12288
v_mfma_f32_16x16x32_bf16 v[84:87], v[28:31], a[164:167], v[84:87]
v_mfma_f32_16x16x32_bf16 v[84:87], v[32:35], a[168:171], v[84:87]
v_exp_f32 v72, v72
v_mfma_f32_16x16x32_bf16 v[84:87], v[36:39], a[172:175], v[84:87]
ds_read_b128 v[60:63], v3 offset:13312
v_exp_f32 v73, v73
v_mfma_f32_16x16x32_bf16 v[88:91], v[8:11], a[176:179], 0
v_exp_f32 v74, v74
v_mfma_f32_16x16x32_bf16 v[88:91], v[12:15], a[180:183], v[88:91]
v_exp_f32 v75, v75
v_mfma_f32_16x16x32_bf16 v[88:91], v[16:19], a[184:187], v[88:91]
ds_read_b128 v[64:67], v3 offset:14336
v_cvt_pk_bf16_f32 v104, v72, v73
v_mfma_f32_16x16x32_bf16 v[88:91], v[20:23], a[188:191], v[88:91]
v_exp_f32 v76, v76
v_mfma_f32_16x16x32_bf16 v[92:95], v[24:27], a[176:179], 0
v_exp_f32 v77, v77
v_mfma_f32_16x16x32_bf16 v[92:95], v[28:31], a[180:183], v[92:95]
ds_read_b128 v[68:71], v3 offset:15360
v_cvt_pk_bf16_f32 v105, v74, v75
v_mfma_f32_16x16x32_bf16 v[92:95], v[32:35], a[184:187], v[92:95]
v_exp_f32 v78, v78
v_mfma_f32_16x16x32_bf16 v[92:95], v[36:39], a[188:191], v[92:95]
v_exp_f32 v79, v79
v_mfma_f32_16x16x32_bf16 v[96:99], v[8:11], a[192:195], 0
v_cvt_pk_bf16_f32 v106, v76, v77
v_cvt_pk_bf16_f32 v107, v78, v79
v_mfma_f32_16x16x32_bf16 v[96:99], v[12:15], a[196:199], v[96:99]
v_exp_f32 v80, v80
v_mfma_f32_16x16x32_bf16 v[96:99], v[16:19], a[200:203], v[96:99]
v_exp_f32 v81, v81
v_mfma_f32_16x16x32_bf16 v[96:99], v[20:23], a[204:207], v[96:99]
v_exp_f32 v82, v82
v_mfma_f32_16x16x32_bf16 v[100:103], v[24:27], a[192:195], 0
v_exp_f32 v83, v83
v_mfma_f32_16x16x32_bf16 v[100:103], v[28:31], a[196:199], v[100:103]
v_cvt_pk_bf16_f32 v108, v80, v81
v_cvt_pk_bf16_f32 v109, v82, v83
v_mfma_f32_16x16x32_bf16 v[100:103], v[32:35], a[200:203], v[100:103]
v_exp_f32 v84, v84
v_mfma_f32_16x16x32_bf16 v[100:103], v[36:39], a[204:207], v[100:103]
v_exp_f32 v85, v85
s_waitcnt vmcnt(17) lgkmcnt(0)
s_barrier
v_mfma_f32_16x16x32_bf16 a[0:3], v[40:43], v[120:123], a[0:3]
ds_read_b128 v[8:11], v2 offset:24576
v_cvt_pk_bf16_f32 v110, v84, v85
v_mfma_f32_16x16x32_bf16 a[32:35], v[40:43], v[124:127], a[32:35]
s_add_u32 m0, s59, 16384
v_mfma_f32_16x16x32_bf16 a[64:67], v[40:43], v[128:131], a[64:67]
buffer_load_dwordx4 v1, s[4:7], s57 offen offset:0 sc1 lds
v_mfma_f32_16x16x32_bf16 a[96:99], v[40:43], v[132:135], a[96:99]
ds_read_b128 v[12:15], v2 offset:25600
v_exp_f32 v86, v86
v_mfma_f32_16x16x32_bf16 a[4:7], v[44:47], v[120:123], a[4:7]
v_exp_f32 v87, v87
v_mfma_f32_16x16x32_bf16 a[36:39], v[44:47], v[124:127], a[36:39]
v_exp_f32 v88, v88
v_mfma_f32_16x16x32_bf16 a[68:71], v[44:47], v[128:131], a[68:71]
ds_read_b128 v[16:19], v2 offset:26624
buffer_load_dwordx4 v1, s[4:7], s57 offen offset:1024 sc1 lds
v_mfma_f32_16x16x32_bf16 a[100:103], v[44:47], v[132:135], a[100:103]
v_exp_f32 v89, v89
v_mfma_f32_16x16x32_bf16 a[8:11], v[48:51], v[120:123], a[8:11]
v_cvt_pk_bf16_f32 v111, v86, v87
v_cvt_pk_bf16_f32 v112, v88, v89
v_mfma_f32_16x16x32_bf16 a[40:43], v[48:51], v[124:127], a[40:43]
ds_read_b128 v[20:23], v2 offset:27648
v_exp_f32 v90, v90
v_mfma_f32_16x16x32_bf16 a[72:75], v[48:51], v[128:131], a[72:75]
buffer_load_dwordx4 v1, s[4:7], s57 offen offset:2048 sc1 lds
v_exp_f32 v91, v91
v_mfma_f32_16x16x32_bf16 a[104:107], v[48:51], v[132:135], a[104:107]
v_exp_f32 v92, v92
v_mfma_f32_16x16x32_bf16 a[12:15], v[52:55], v[120:123], a[12:15]
ds_read_b128 v[24:27], v2 offset:28672
v_cvt_pk_bf16_f32 v113, v90, v91
v_mfma_f32_16x16x32_bf16 a[44:47], v[52:55], v[124:127], a[44:47]
v_exp_f32 v93, v93
v_mfma_f32_16x16x32_bf16 a[76:79], v[52:55], v[128:131], a[76:79]
buffer_load_dwordx4 v1, s[4:7], s57 offen offset:3072 sc1 lds
v_cvt_pk_bf16_f32 v114, v92, v93
v_mfma_f32_16x16x32_bf16 a[108:111], v[52:55], v[132:135], a[108:111]
ds_read_b128 v[28:31], v2 offset:29696
s_add_u32 s57, s57, 0x4000
v_exp_f32 v94, v94
v_mfma_f32_16x16x32_bf16 a[16:19], v[56:59], v[120:123], a[16:19]
v_exp_f32 v95, v95
v_mfma_f32_16x16x32_bf16 a[48:51], v[56:59], v[124:127], a[48:51]
s_add_u32 m0, s60, 8192
v_cvt_pk_bf16_f32 v115, v94, v95
v_mfma_f32_16x16x32_bf16 a[80:83], v[56:59], v[128:131], a[80:83]
ds_read_b128 v[32:35], v2 offset:30720
buffer_load_dwordx4 v1, s[4:7], s58 offen offset:0 sc1 lds
v_exp_f32 v96, v96
v_mfma_f32_16x16x32_bf16 a[112:115], v[56:59], v[132:135], a[112:115]
v_exp_f32 v97, v97
v_mfma_f32_16x16x32_bf16 a[20:23], v[60:63], v[120:123], a[20:23]
v_exp_f32 v98, v98
v_mfma_f32_16x16x32_bf16 a[52:55], v[60:63], v[124:127], a[52:55]
ds_read_b128 v[36:39], v2 offset:31744
v_cvt_pk_bf16_f32 v116, v96, v97
v_mfma_f32_16x16x32_bf16 a[84:87], v[60:63], v[128:131], a[84:87]
buffer_load_dwordx4 v1, s[4:7], s58 offen offset:1024 sc1 lds
v_exp_f32 v99, v99
v_mfma_f32_16x16x32_bf16 a[116:119], v[60:63], v[132:135], a[116:119]
v_exp_f32 v100, v100
v_mfma_f32_16x16x32_bf16 a[24:27], v[64:67], v[120:123], a[24:27]
v_exp_f32 v101, v101
v_mfma_f32_16x16x32_bf16 a[56:59], v[64:67], v[124:127], a[56:59]
v_cvt_pk_bf16_f32 v117, v98, v99
v_cvt_pk_bf16_f32 v118, v100, v101
v_mfma_f32_16x16x32_bf16 a[88:91], v[64:67], v[128:131], a[88:91]
buffer_load_dwordx4 v1, s[4:7], s58 offen offset:2048 sc1 lds
v_mfma_f32_16x16x32_bf16 a[120:123], v[64:67], v[132:135], a[120:123]
v_exp_f32 v102, v102
v_mfma_f32_16x16x32_bf16 a[28:31], v[68:71], v[120:123], a[28:31]
v_exp_f32 v103, v103
v_mfma_f32_16x16x32_bf16 a[60:63], v[68:71], v[124:127], a[60:63]
v_cvt_pk_bf16_f32 v119, v102, v103
v_mfma_f32_16x16x32_bf16 a[92:95], v[68:71], v[128:131], a[92:95]
buffer_load_dwordx4 v1, s[4:7], s58 offen offset:3072 sc1 lds
v_mfma_f32_16x16x32_bf16 a[124:127], v[68:71], v[132:135], a[124:127]
s_add_u32 s58, s58, 0x4000
v_mfma_f32_16x16x32_bf16 a[128:131], v[136:139], v[120:123], a[128:131]
v_mfma_f32_16x16x32_bf16 a[132:135], v[136:139], v[124:127], a[132:135]
v_mfma_f32_16x16x32_bf16 a[136:139], v[136:139], v[128:131], a[136:139]
v_mfma_f32_16x16x32_bf16 a[140:143], v[136:139], v[132:135], a[140:143]
s_waitcnt lgkmcnt(0)
v_mfma_f32_16x16x32_bf16 v[72:75], v[8:11], a[144:147], 0
ds_read_b128 v[40:43], v3 offset:16384
v_mfma_f32_16x16x32_bf16 v[72:75], v[12:15], a[148:151], v[72:75]
v_mfma_f32_16x16x32_bf16 v[72:75], v[16:19], a[152:155], v[72:75]
v_mfma_f32_16x16x32_bf16 v[72:75], v[20:23], a[156:159], v[72:75]
ds_read_b128 v[44:47], v3 offset:17408
v_mfma_f32_16x16x32_bf16 v[76:79], v[24:27], a[144:147], 0
v_mfma_f32_16x16x32_bf16 v[76:79], v[28:31], a[148:151], v[76:79]
buffer_load_dwordx4 v[240:243], off, s[32:35], s70 sc1
v_mfma_f32_16x16x32_bf16 v[76:79], v[32:35], a[152:155], v[76:79]
ds_read_b128 v[48:51], v3 offset:18432
v_mfma_f32_16x16x32_bf16 v[76:79], v[36:39], a[156:159], v[76:79]
v_mfma_f32_16x16x32_bf16 v[80:83], v[8:11], a[160:163], 0
v_mfma_f32_16x16x32_bf16 v[80:83], v[12:15], a[164:167], v[80:83]
ds_read_b128 v[52:55], v3 offset:19456
v_mfma_f32_16x16x32_bf16 v[80:83], v[16:19], a[168:171], v[80:83]
v_mfma_f32_16x16x32_bf16 v[80:83], v[20:23], a[172:175], v[80:83]
v_mfma_f32_16x16x32_bf16 v[84:87], v[24:27], a[160:163], 0
ds_read_b128 v[56:59], v3 offset:20480
v_mfma_f32_16x16x32_bf16 v[84:87], v[28:31], a[164:167], v[84:87]
v_mfma_f32_16x16x32_bf16 v[84:87], v[32:35], a[168:171], v[84:87]
v_exp_f32 v72, v72
v_mfma_f32_16x16x32_bf16 v[84:87], v[36:39], a[172:175], v[84:87]
ds_read_b128 v[60:63], v3 offset:21504
v_exp_f32 v73, v73
v_mfma_f32_16x16x32_bf16 v[88:91], v[8:11], a[176:179], 0
v_exp_f32 v74, v74
v_mfma_f32_16x16x32_bf16 v[88:91], v[12:15], a[180:183], v[88:91]
v_exp_f32 v75, v75
v_mfma_f32_16x16x32_bf16 v[88:91], v[16:19], a[184:187], v[88:91]
ds_read_b128 v[64:67], v3 offset:22528
v_cvt_pk_bf16_f32 v120, v72, v73
v_mfma_f32_16x16x32_bf16 v[88:91], v[20:23], a[188:191], v[88:91]
v_exp_f32 v76, v76
v_mfma_f32_16x16x32_bf16 v[92:95], v[24:27], a[176:179], 0
v_exp_f32 v77, v77
v_mfma_f32_16x16x32_bf16 v[92:95], v[28:31], a[180:183], v[92:95]
ds_read_b128 v[68:71], v3 offset:23552
v_cvt_pk_bf16_f32 v121, v74, v75
v_mfma_f32_16x16x32_bf16 v[92:95], v[32:35], a[184:187], v[92:95]
v_exp_f32 v78, v78
v_mfma_f32_16x16x32_bf16 v[92:95], v[36:39], a[188:191], v[92:95]
v_exp_f32 v79, v79
v_mfma_f32_16x16x32_bf16 v[96:99], v[8:11], a[192:195], 0
v_cvt_pk_bf16_f32 v122, v76, v77
v_cvt_pk_bf16_f32 v123, v78, v79
v_mfma_f32_16x16x32_bf16 v[96:99], v[12:15], a[196:199], v[96:99]
v_exp_f32 v80, v80
v_mfma_f32_16x16x32_bf16 v[96:99], v[16:19], a[200:203], v[96:99]
v_exp_f32 v81, v81
v_mfma_f32_16x16x32_bf16 v[96:99], v[20:23], a[204:207], v[96:99]
v_exp_f32 v82, v82
v_mfma_f32_16x16x32_bf16 v[100:103], v[24:27], a[192:195], 0
v_exp_f32 v83, v83
v_mfma_f32_16x16x32_bf16 v[100:103], v[28:31], a[196:199], v[100:103]
v_cvt_pk_bf16_f32 v124, v80, v81
v_cvt_pk_bf16_f32 v125, v82, v83
v_mfma_f32_16x16x32_bf16 v[100:103], v[32:35], a[200:203], v[100:103]
v_exp_f32 v84, v84
v_mfma_f32_16x16x32_bf16 v[100:103], v[36:39], a[204:207], v[100:103]
v_exp_f32 v85, v85
s_waitcnt vmcnt(17) lgkmcnt(0)
s_barrier
v_mfma_f32_16x16x32_bf16 a[0:3], v[40:43], v[104:107], a[0:3]
ds_read_b128 v[8:11], v2 offset:0
v_cvt_pk_bf16_f32 v126, v84, v85
v_mfma_f32_16x16x32_bf16 a[32:35], v[40:43], v[108:111], a[32:35]
s_add_u32 m0, s59, 24576
v_mfma_f32_16x16x32_bf16 a[64:67], v[40:43], v[112:115], a[64:67]
buffer_load_dwordx4 v1, s[4:7], s57 offen offset:0 sc1 lds
v_mfma_f32_16x16x32_bf16 a[96:99], v[40:43], v[116:119], a[96:99]
ds_read_b128 v[12:15], v2 offset:1024
v_exp_f32 v86, v86
v_mfma_f32_16x16x32_bf16 a[4:7], v[44:47], v[104:107], a[4:7]
v_exp_f32 v87, v87
v_mfma_f32_16x16x32_bf16 a[36:39], v[44:47], v[108:111], a[36:39]
v_exp_f32 v88, v88
v_mfma_f32_16x16x32_bf16 a[68:71], v[44:47], v[112:115], a[68:71]
ds_read_b128 v[16:19], v2 offset:2048
buffer_load_dwordx4 v1, s[4:7], s57 offen offset:1024 sc1 lds
v_mfma_f32_16x16x32_bf16 a[100:103], v[44:47], v[116:119], a[100:103]
v_exp_f32 v89, v89
v_mfma_f32_16x16x32_bf16 a[8:11], v[48:51], v[104:107], a[8:11]
v_cvt_pk_bf16_f32 v127, v86, v87
v_cvt_pk_bf16_f32 v128, v88, v89
v_mfma_f32_16x16x32_bf16 a[40:43], v[48:51], v[108:111], a[40:43]
ds_read_b128 v[20:23], v2 offset:3072
v_exp_f32 v90, v90
v_mfma_f32_16x16x32_bf16 a[72:75], v[48:51], v[112:115], a[72:75]
buffer_load_dwordx4 v1, s[4:7], s57 offen offset:2048 sc1 lds
v_exp_f32 v91, v91
v_mfma_f32_16x16x32_bf16 a[104:107], v[48:51], v[116:119], a[104:107]
v_exp_f32 v92, v92
v_mfma_f32_16x16x32_bf16 a[12:15], v[52:55], v[104:107], a[12:15]
ds_read_b128 v[24:27], v2 offset:4096
v_cvt_pk_bf16_f32 v129, v90, v91
v_mfma_f32_16x16x32_bf16 a[44:47], v[52:55], v[108:111], a[44:47]
v_exp_f32 v93, v93
v_mfma_f32_16x16x32_bf16 a[76:79], v[52:55], v[112:115], a[76:79]
buffer_load_dwordx4 v1, s[4:7], s57 offen offset:3072 sc1 lds
v_cvt_pk_bf16_f32 v130, v92, v93
v_mfma_f32_16x16x32_bf16 a[108:111], v[52:55], v[116:119], a[108:111]
ds_read_b128 v[28:31], v2 offset:5120
s_add_u32 s57, s57, 0x4000
v_exp_f32 v94, v94
v_mfma_f32_16x16x32_bf16 a[16:19], v[56:59], v[104:107], a[16:19]
v_exp_f32 v95, v95
v_mfma_f32_16x16x32_bf16 a[48:51], v[56:59], v[108:111], a[48:51]
s_add_u32 m0, s60, 16384
v_cvt_pk_bf16_f32 v131, v94, v95
v_mfma_f32_16x16x32_bf16 a[80:83], v[56:59], v[112:115], a[80:83]
ds_read_b128 v[32:35], v2 offset:6144
buffer_load_dwordx4 v1, s[4:7], s58 offen offset:0 sc1 lds
v_exp_f32 v96, v96
v_mfma_f32_16x16x32_bf16 a[112:115], v[56:59], v[116:119], a[112:115]
v_exp_f32 v97, v97
v_mfma_f32_16x16x32_bf16 a[20:23], v[60:63], v[104:107], a[20:23]
v_exp_f32 v98, v98
v_mfma_f32_16x16x32_bf16 a[52:55], v[60:63], v[108:111], a[52:55]
ds_read_b128 v[36:39], v2 offset:7168
v_cvt_pk_bf16_f32 v132, v96, v97
v_mfma_f32_16x16x32_bf16 a[84:87], v[60:63], v[112:115], a[84:87]
buffer_load_dwordx4 v1, s[4:7], s58 offen offset:1024 sc1 lds
v_exp_f32 v99, v99
v_mfma_f32_16x16x32_bf16 a[116:119], v[60:63], v[116:119], a[116:119]
v_exp_f32 v100, v100
v_mfma_f32_16x16x32_bf16 a[24:27], v[64:67], v[104:107], a[24:27]
v_exp_f32 v101, v101
v_mfma_f32_16x16x32_bf16 a[56:59], v[64:67], v[108:111], a[56:59]
v_cvt_pk_bf16_f32 v133, v98, v99
v_cvt_pk_bf16_f32 v134, v100, v101
v_mfma_f32_16x16x32_bf16 a[88:91], v[64:67], v[112:115], a[88:91]
buffer_load_dwordx4 v1, s[4:7], s58 offen offset:2048 sc1 lds
v_mfma_f32_16x16x32_bf16 a[120:123], v[64:67], v[116:119], a[120:123]
v_exp_f32 v102, v102
v_mfma_f32_16x16x32_bf16 a[28:31], v[68:71], v[104:107], a[28:31]
v_exp_f32 v103, v103
v_mfma_f32_16x16x32_bf16 a[60:63], v[68:71], v[108:111], a[60:63]
v_cvt_pk_bf16_f32 v135, v102, v103
v_mfma_f32_16x16x32_bf16 a[92:95], v[68:71], v[112:115], a[92:95]
buffer_load_dwordx4 v1, s[4:7], s58 offen offset:3072 sc1 lds
v_mfma_f32_16x16x32_bf16 a[124:127], v[68:71], v[116:119], a[124:127]
s_add_u32 s58, s58, 0x4000
v_mfma_f32_16x16x32_bf16 a[128:131], v[136:139], v[104:107], a[128:131]
v_mfma_f32_16x16x32_bf16 a[132:135], v[136:139], v[108:111], a[132:135]
v_mfma_f32_16x16x32_bf16 a[136:139], v[136:139], v[112:115], a[136:139]
v_mfma_f32_16x16x32_bf16 a[140:143], v[136:139], v[116:119], a[140:143]
s_waitcnt lgkmcnt(0)
v_mfma_f32_16x16x32_bf16 v[72:75], v[8:11], a[144:147], 0
ds_read_b128 v[40:43], v3 offset:24576
v_mfma_f32_16x16x32_bf16 v[72:75], v[12:15], a[148:151], v[72:75]
v_mfma_f32_16x16x32_bf16 v[72:75], v[16:19], a[152:155], v[72:75]
v_mfma_f32_16x16x32_bf16 v[72:75], v[20:23], a[156:159], v[72:75]
ds_read_b128 v[44:47], v3 offset:25600
v_mfma_f32_16x16x32_bf16 v[76:79], v[24:27], a[144:147], 0
v_mfma_f32_16x16x32_bf16 v[76:79], v[28:31], a[148:151], v[76:79]
v_mfma_f32_16x16x32_bf16 v[76:79], v[32:35], a[152:155], v[76:79]
ds_read_b128 v[48:51], v3 offset:26624
v_mfma_f32_16x16x32_bf16 v[76:79], v[36:39], a[156:159], v[76:79]
v_mfma_f32_16x16x32_bf16 v[80:83], v[8:11], a[160:163], 0
v_mfma_f32_16x16x32_bf16 v[80:83], v[12:15], a[164:167], v[80:83]
ds_read_b128 v[52:55], v3 offset:27648
v_mfma_f32_16x16x32_bf16 v[80:83], v[16:19], a[168:171], v[80:83]
v_mfma_f32_16x16x32_bf16 v[80:83], v[20:23], a[172:175], v[80:83]
v_mfma_f32_16x16x32_bf16 v[84:87], v[24:27], a[160:163], 0
ds_read_b128 v[56:59], v3 offset:28672
v_mfma_f32_16x16x32_bf16 v[84:87], v[28:31], a[164:167], v[84:87]
v_mfma_f32_16x16x32_bf16 v[84:87], v[32:35], a[168:171], v[84:87]
v_exp_f32 v72, v72
v_mfma_f32_16x16x32_bf16 v[84:87], v[36:39], a[172:175], v[84:87]
ds_read_b128 v[60:63], v3 offset:29696
v_exp_f32 v73, v73
v_mfma_f32_16x16x32_bf16 v[88:91], v[8:11], a[176:179], 0
v_exp_f32 v74, v74
v_mfma_f32_16x16x32_bf16 v[88:91], v[12:15], a[180:183], v[88:91]
v_exp_f32 v75, v75
v_mfma_f32_16x16x32_bf16 v[88:91], v[16:19], a[184:187], v[88:91]
ds_read_b128 v[64:67], v3 offset:30720
v_cvt_pk_bf16_f32 v104, v72, v73
v_mfma_f32_16x16x32_bf16 v[88:91], v[20:23], a[188:191], v[88:91]
v_exp_f32 v76, v76
v_mfma_f32_16x16x32_bf16 v[92:95], v[24:27], a[176:179], 0
v_exp_f32 v77, v77
v_mfma_f32_16x16x32_bf16 v[92:95], v[28:31], a[180:183], v[92:95]
ds_read_b128 v[68:71], v3 offset:31744
v_cvt_pk_bf16_f32 v105, v74, v75
v_mfma_f32_16x16x32_bf16 v[92:95], v[32:35], a[184:187], v[92:95]
v_exp_f32 v78, v78
v_mfma_f32_16x16x32_bf16 v[92:95], v[36:39], a[188:191], v[92:95]
s_waitcnt vmcnt(8)
v_and_b32 v240, v240, v241
v_mfma_f32_16x16x32_bf16 v[96:99], v[8:11], a[192:195], 0
v_and_b32 v242, v242, v243
v_cvt_pk_bf16_f32 v106, v76, v77
v_exp_f32 v79, v79
v_mfma_f32_16x16x32_bf16 v[96:99], v[12:15], a[196:199], v[96:99]
v_and_b32 v240, v240, v242
v_cvt_pk_bf16_f32 v107, v78, v79
v_mfma_f32_16x16x32_bf16 v[96:99], v[16:19], a[200:203], v[96:99]
v_exp_f32 v80, v80
v_mfma_f32_16x16x32_bf16 v[96:99], v[20:23], a[204:207], v[96:99]
v_readfirstlane_b32 s72, v240
v_exp_f32 v81, v81
v_mfma_f32_16x16x32_bf16 v[100:103], v[24:27], a[192:195], 0
s_and_b32 s72, s72, s68
v_cvt_pk_bf16_f32 v108, v80, v81
v_mfma_f32_16x16x32_bf16 v[100:103], v[28:31], a[196:199], v[100:103]
s_cmp_eq_u32 s72, s68
s_cbranch_scc0 L_spin_P4
L_back_P4:
v_exp_f32 v82, v82
v_mfma_f32_16x16x32_bf16 v[100:103], v[32:35], a[200:203], v[100:103]
v_exp_f32 v83, v83
v_mfma_f32_16x16x32_bf16 v[100:103], v[36:39], a[204:207], v[100:103]
v_exp_f32 v84, v84
s_waitcnt vmcnt(17) lgkmcnt(0)
s_barrier
v_mfma_f32_16x16x32_bf16 a[0:3], v[40:43], v[120:123], a[0:3]
ds_read_b128 v[8:11], v2 offset:8192
v_cvt_pk_bf16_f32 v109, v82, v83
v_mfma_f32_16x16x32_bf16 a[32:35], v[40:43], v[124:127], a[32:35]
s_add_u32 m0, s59, 0
v_exp_f32 v85, v85
v_mfma_f32_16x16x32_bf16 a[64:67], v[40:43], v[128:131], a[64:67]
buffer_load_dwordx4 v1, s[4:7], s57 offen offset:0 sc1 lds
v_cvt_pk_bf16_f32 v110, v84, v85
v_mfma_f32_16x16x32_bf16 a[96:99], v[40:43], v[132:135], a[96:99]
ds_read_b128 v[12:15], v2 offset:9216
v_exp_f32 v86, v86
v_mfma_f32_16x16x32_bf16 a[4:7], v[44:47], v[120:123], a[4:7]
v_exp_f32 v87, v87
v_mfma_f32_16x16x32_bf16 a[36:39], v[44:47], v[124:127], a[36:39]
v_exp_f32 v88, v88
v_mfma_f32_16x16x32_bf16 a[68:71], v[44:47], v[128:131], a[68:71]
ds_read_b128 v[16:19], v2 offset:10240
buffer_load_dwordx4 v1, s[4:7], s57 offen offset:1024 sc1 lds
v_mfma_f32_16x16x32_bf16 a[100:103], v[44:47], v[132:135], a[100:103]
v_exp_f32 v89, v89
v_mfma_f32_16x16x32_bf16 a[8:11], v[48:51], v[120:123], a[8:11]
v_cvt_pk_bf16_f32 v111, v86, v87
v_cvt_pk_bf16_f32 v112, v88, v89
v_mfma_f32_16x16x32_bf16 a[40:43], v[48:51], v[124:127], a[40:43]
ds_read_b128 v[20:23], v2 offset:11264
v_exp_f32 v90, v90
v_mfma_f32_16x16x32_bf16 a[72:75], v[48:51], v[128:131], a[72:75]
buffer_load_dwordx4 v1, s[4:7], s57 offen offset:2048 sc1 lds
v_exp_f32 v91, v91
v_mfma_f32_16x16x32_bf16 a[104:107], v[48:51], v[132:135], a[104:107]
v_exp_f32 v92, v92
v_mfma_f32_16x16x32_bf16 a[12:15], v[52:55], v[120:123], a[12:15]
ds_read_b128 v[24:27], v2 offset:12288
v_cvt_pk_bf16_f32 v113, v90, v91
v_mfma_f32_16x16x32_bf16 a[44:47], v[52:55], v[124:127], a[44:47]
v_exp_f32 v93, v93
v_mfma_f32_16x16x32_bf16 a[76:79], v[52:55], v[128:131], a[76:79]
buffer_load_dwordx4 v1, s[4:7], s57 offen offset:3072 sc1 lds
v_cvt_pk_bf16_f32 v114, v92, v93
v_mfma_f32_16x16x32_bf16 a[108:111], v[52:55], v[132:135], a[108:111]
ds_read_b128 v[28:31], v2 offset:13312
s_add_u32 s57, s57, 0x4000
v_exp_f32 v94, v94
v_mfma_f32_16x16x32_bf16 a[16:19], v[56:59], v[120:123], a[16:19]
v_exp_f32 v95, v95
v_mfma_f32_16x16x32_bf16 a[48:51], v[56:59], v[124:127], a[48:51]
s_add_u32 m0, s60, 24576
v_cvt_pk_bf16_f32 v115, v94, v95
v_mfma_f32_16x16x32_bf16 a[80:83], v[56:59], v[128:131], a[80:83]
ds_read_b128 v[32:35], v2 offset:14336
buffer_load_dwordx4 v1, s[4:7], s58 offen offset:0 sc1 lds
v_exp_f32 v96, v96
v_mfma_f32_16x16x32_bf16 a[112:115], v[56:59], v[132:135], a[112:115]
v_exp_f32 v97, v97
v_mfma_f32_16x16x32_bf16 a[20:23], v[60:63], v[120:123], a[20:23]
v_exp_f32 v98, v98
v_mfma_f32_16x16x32_bf16 a[52:55], v[60:63], v[124:127], a[52:55]
ds_read_b128 v[36:39], v2 offset:15360
v_cvt_pk_bf16_f32 v116, v96, v97
v_mfma_f32_16x16x32_bf16 a[84:87], v[60:63], v[128:131], a[84:87]
buffer_load_dwordx4 v1, s[4:7], s58 offen offset:1024 sc1 lds
v_exp_f32 v99, v99
v_mfma_f32_16x16x32_bf16 a[116:119], v[60:63], v[132:135], a[116:119]
v_exp_f32 v100, v100
v_mfma_f32_16x16x32_bf16 a[24:27], v[64:67], v[120:123], a[24:27]
v_exp_f32 v101, v101
v_mfma_f32_16x16x32_bf16 a[56:59], v[64:67], v[124:127], a[56:59]
v_cvt_pk_bf16_f32 v117, v98, v99
v_cvt_pk_bf16_f32 v118, v100, v101
v_mfma_f32_16x16x32_bf16 a[88:91], v[64:67], v[128:131], a[88:91]
buffer_load_dwordx4 v1, s[4:7], s58 offen offset:2048 sc1 lds
v_mfma_f32_16x16x32_bf16 a[120:123], v[64:67], v[132:135], a[120:123]
v_exp_f32 v102, v102
v_mfma_f32_16x16x32_bf16 a[28:31], v[68:71], v[120:123], a[28:31]
v_exp_f32 v103, v103
v_mfma_f32_16x16x32_bf16 a[60:63], v[68:71], v[124:127], a[60:63]
v_cvt_pk_bf16_f32 v119, v102, v103
v_mfma_f32_16x16x32_bf16 a[92:95], v[68:71], v[128:131], a[92:95]
buffer_load_dwordx4 v1, s[4:7], s58 offen offset:3072 sc1 lds
v_mfma_f32_16x16x32_bf16 a[124:127], v[68:71], v[132:135], a[124:127]
s_add_u32 s58, s58, 0x4000
v_mfma_f32_16x16x32_bf16 a[128:131], v[136:139], v[120:123], a[128:131]
v_mfma_f32_16x16x32_bf16 a[132:135], v[136:139], v[124:127], a[132:135]
v_mfma_f32_16x16x32_bf16 a[136:139], v[136:139], v[128:131], a[136:139]
v_mfma_f32_16x16x32_bf16 a[140:143], v[136:139], v[132:135], a[140:143]
s_waitcnt lgkmcnt(0)
v_mfma_f32_16x16x32_bf16 v[72:75], v[8:11], a[144:147], 0
ds_read_b128 v[40:43], v3 offset:0
v_mfma_f32_16x16x32_bf16 v[72:75], v[12:15], a[148:151], v[72:75]
v_mfma_f32_16x16x32_bf16 v[72:75], v[16:19], a[152:155], v[72:75]
v_mfma_f32_16x16x32_bf16 v[72:75], v[20:23], a[156:159], v[72:75]
ds_read_b128 v[44:47], v3 offset:1024
v_mfma_f32_16x16x32_bf16 v[76:79], v[24:27], a[144:147], 0
v_mfma_f32_16x16x32_bf16 v[76:79], v[28:31], a[148:151], v[76:79]
v_mfma_f32_16x16x32_bf16 v[76:79], v[32:35], a[152:155], v[76:79]
ds_read_b128 v[48:51], v3 offset:2048
v_mfma_f32_16x16x32_bf16 v[76:79], v[36:39], a[156:159], v[76:79]
v_mfma_f32_16x16x32_bf16 v[80:83], v[8:11], a[160:163], 0
v_mfma_f32_16x16x32_bf16 v[80:83], v[12:15], a[164:167], v[80:83]
ds_read_b128 v[52:55], v3 offset:3072
v_mfma_f32_16x16x32_bf16 v[80:83], v[16:19], a[168:171], v[80:83]
v_mfma_f32_16x16x32_bf16 v[80:83], v[20:23], a[172:175], v[80:83]
v_mfma_f32_16x16x32_bf16 v[84:87], v[24:27], a[160:163], 0
ds_read_b128 v[56:59], v3 offset:4096
v_mfma_f32_16x16x32_bf16 v[84:87], v[28:31], a[164:167], v[84:87]
v_mfma_f32_16x16x32_bf16 v[84:87], v[32:35], a[168:171], v[84:87]
v_exp_f32 v72, v72
v_mfma_f32_16x16x32_bf16 v[84:87], v[36:39], a[172:175], v[84:87]
ds_read_b128 v[60:63], v3 offset:5120
v_exp_f32 v73, v73
v_mfma_f32_16x16x32_bf16 v[88:91], v[8:11], a[176:179], 0
v_exp_f32 v74, v74
v_mfma_f32_16x16x32_bf16 v[88:91], v[12:15], a[180:183], v[88:91]
v_exp_f32 v75, v75
v_mfma_f32_16x16x32_bf16 v[88:91], v[16:19], a[184:187], v[88:91]
ds_read_b128 v[64:67], v3 offset:6144
v_cvt_pk_bf16_f32 v120, v72, v73
v_mfma_f32_16x16x32_bf16 v[88:91], v[20:23], a[188:191], v[88:91]
v_exp_f32 v76, v76
v_mfma_f32_16x16x32_bf16 v[92:95], v[24:27], a[176:179], 0
v_exp_f32 v77, v77
v_mfma_f32_16x16x32_bf16 v[92:95], v[28:31], a[180:183], v[92:95]
ds_read_b128 v[68:71], v3 offset:7168
v_cvt_pk_bf16_f32 v121, v74, v75
v_mfma_f32_16x16x32_bf16 v[92:95], v[32:35], a[184:187], v[92:95]
v_exp_f32 v78, v78
v_mfma_f32_16x16x32_bf16 v[92:95], v[36:39], a[188:191], v[92:95]
v_exp_f32 v79, v79
v_mfma_f32_16x16x32_bf16 v[96:99], v[8:11], a[192:195], 0
v_cvt_pk_bf16_f32 v122, v76, v77
v_cvt_pk_bf16_f32 v123, v78, v79
v_mfma_f32_16x16x32_bf16 v[96:99], v[12:15], a[196:199], v[96:99]
v_exp_f32 v80, v80
v_mfma_f32_16x16x32_bf16 v[96:99], v[16:19], a[200:203], v[96:99]
v_exp_f32 v81, v81
v_mfma_f32_16x16x32_bf16 v[96:99], v[20:23], a[204:207], v[96:99]
v_exp_f32 v82, v82
v_mfma_f32_16x16x32_bf16 v[100:103], v[24:27], a[192:195], 0
v_exp_f32 v83, v83
v_mfma_f32_16x16x32_bf16 v[100:103], v[28:31], a[196:199], v[100:103]
v_cvt_pk_bf16_f32 v124, v80, v81
v_cvt_pk_bf16_f32 v125, v82, v83
v_mfma_f32_16x16x32_bf16 v[100:103], v[32:35], a[200:203], v[100:103]
v_exp_f32 v84, v84
v_mfma_f32_16x16x32_bf16 v[100:103], v[36:39], a[204:207], v[100:103]
v_exp_f32 v85, v85
s_waitcnt vmcnt(17) lgkmcnt(0)
s_barrier
v_mfma_f32_16x16x32_bf16 a[0:3], v[40:43], v[104:107], a[0:3]
ds_read_b128 v[8:11], v2 offset:16384
v_cvt_pk_bf16_f32 v126, v84, v85
v_mfma_f32_16x16x32_bf16 a[32:35], v[40:43], v[108:111], a[32:35]
s_add_u32 m0, s59, 8192
v_mfma_f32_16x16x32_bf16 a[64:67], v[40:43], v[112:115], a[64:67]
buffer_load_dwordx4 v1, s[4:7], s57 offen offset:0 sc1 lds
v_mfma_f32_16x16x32_bf16 a[96:99], v[40:43], v[116:119], a[96:99]
ds_read_b128 v[12:15], v2 offset:17408
v_exp_f32 v86, v86
v_mfma_f32_16x16x32_bf16 a[4:7], v[44:47], v[104:107], a[4:7]
v_exp_f32 v87, v87
v_mfma_f32_16x16x32_bf16 a[36:39], v[44:47], v[108:111], a[36:39]
v_exp_f32 v88, v88
v_mfma_f32_16x16x32_bf16 a[68:71], v[44:47], v[112:115], a[68:71]
ds_read_b128 v[16:19], v2 offset:18432
buffer_load_dwordx4 v1, s[4:7], s57 offen offset:1024 sc1 lds
v_mfma_f32_16x16x32_bf16 a[100:103], v[44:47], v[116:119], a[100:103]
v_exp_f32 v89, v89
v_mfma_f32_16x16x32_bf16 a[8:11], v[48:51], v[104:107], a[8:11]
v_cvt_pk_bf16_f32 v127, v86, v87
v_cvt_pk_bf16_f32 v128, v88, v89
v_mfma_f32_16x16x32_bf16 a[40:43], v[48:51], v[108:111], a[40:43]
ds_read_b128 v[20:23], v2 offset:19456
v_exp_f32 v90, v90
v_mfma_f32_16x16x32_bf16 a[72:75], v[48:51], v[112:115], a[72:75]
buffer_load_dwordx4 v1, s[4:7], s57 offen offset:2048 sc1 lds
v_exp_f32 v91, v91
v_mfma_f32_16x16x32_bf16 a[104:107], v[48:51], v[116:119], a[104:107]
v_exp_f32 v92, v92
v_mfma_f32_16x16x32_bf16 a[12:15], v[52:55], v[104:107], a[12:15]
ds_read_b128 v[24:27], v2 offset:20480
v_cvt_pk_bf16_f32 v129, v90, v91
v_mfma_f32_16x16x32_bf16 a[44:47], v[52:55], v[108:111], a[44:47]
v_exp_f32 v93, v93
v_mfma_f32_16x16x32_bf16 a[76:79], v[52:55], v[112:115], a[76:79]
buffer_load_dwordx4 v1, s[4:7], s57 offen offset:3072 sc1 lds
v_cvt_pk_bf16_f32 v130, v92, v93
v_mfma_f32_16x16x32_bf16 a[108:111], v[52:55], v[116:119], a[108:111]
ds_read_b128 v[28:31], v2 offset:21504
s_add_u32 s57, s57, 0x4000
v_exp_f32 v94, v94
v_mfma_f32_16x16x32_bf16 a[16:19], v[56:59], v[104:107], a[16:19]
v_exp_f32 v95, v95
v_mfma_f32_16x16x32_bf16 a[48:51], v[56:59], v[108:111], a[48:51]
s_add_u32 m0, s60, 0
v_cvt_pk_bf16_f32 v131, v94, v95
v_mfma_f32_16x16x32_bf16 a[80:83], v[56:59], v[112:115], a[80:83]
ds_read_b128 v[32:35], v2 offset:22528
buffer_load_dwordx4 v1, s[4:7], s58 offen offset:0 sc1 lds
v_exp_f32 v96, v96
v_mfma_f32_16x16x32_bf16 a[112:115], v[56:59], v[116:119], a[112:115]
v_exp_f32 v97, v97
v_mfma_f32_16x16x32_bf16 a[20:23], v[60:63], v[104:107], a[20:23]
v_exp_f32 v98, v98
v_mfma_f32_16x16x32_bf16 a[52:55], v[60:63], v[108:111], a[52:55]
ds_read_b128 v[36:39], v2 offset:23552
v_cvt_pk_bf16_f32 v132, v96, v97
v_mfma_f32_16x16x32_bf16 a[84:87], v[60:63], v[112:115], a[84:87]
buffer_load_dwordx4 v1, s[4:7], s58 offen offset:1024 sc1 lds
v_exp_f32 v99, v99
v_mfma_f32_16x16x32_bf16 a[116:119], v[60:63], v[116:119], a[116:119]
v_exp_f32 v100, v100
v_mfma_f32_16x16x32_bf16 a[24:27], v[64:67], v[104:107], a[24:27]
v_exp_f32 v101, v101
v_mfma_f32_16x16x32_bf16 a[56:59], v[64:67], v[108:111], a[56:59]
v_cvt_pk_bf16_f32 v133, v98, v99
v_cvt_pk_bf16_f32 v134, v100, v101
v_mfma_f32_16x16x32_bf16 a[88:91], v[64:67], v[112:115], a[88:91]
buffer_load_dwordx4 v1, s[4:7], s58 offen offset:2048 sc1 lds
v_mfma_f32_16x16x32_bf16 a[120:123], v[64:67], v[116:119], a[120:123]
v_exp_f32 v102, v102
v_mfma_f32_16x16x32_bf16 a[28:31], v[68:71], v[104:107], a[28:31]
v_exp_f32 v103, v103
v_mfma_f32_16x16x32_bf16 a[60:63], v[68:71], v[108:111], a[60:63]
v_cvt_pk_bf16_f32 v135, v102, v103
v_mfma_f32_16x16x32_bf16 a[92:95], v[68:71], v[112:115], a[92:95]
buffer_load_dwordx4 v1, s[4:7], s58 offen offset:3072 sc1 lds
v_mfma_f32_16x16x32_bf16 a[124:127], v[68:71], v[116:119], a[124:127]
s_add_u32 s58, s58, 0x4000
v_mfma_f32_16x16x32_bf16 a[128:131], v[136:139], v[104:107], a[128:131]
v_mfma_f32_16x16x32_bf16 a[132:135], v[136:139], v[108:111], a[132:135]
v_mfma_f32_16x16x32_bf16 a[136:139], v[136:139], v[112:115], a[136:139]
v_mfma_f32_16x16x32_bf16 a[140:143], v[136:139], v[116:119], a[140:143]
s_waitcnt lgkmcnt(0)
v_mfma_f32_16x16x32_bf16 v[72:75], v[8:11], a[144:147], 0
ds_read_b128 v[40:43], v3 offset:8192
v_mfma_f32_16x16x32_bf16 v[72:75], v[12:15], a[148:151], v[72:75]
v_mfma_f32_16x16x32_bf16 v[72:75], v[16:19], a[152:155], v[72:75]
v_mfma_f32_16x16x32_bf16 v[72:75], v[20:23], a[156:159], v[72:75]
ds_read_b128 v[44:47], v3 offset:9216
v_mfma_f32_16x16x32_bf16 v[76:79], v[24:27], a[144:147], 0
v_mfma_f32_16x16x32_bf16 v[76:79], v[28:31], a[148:151], v[76:79]
v_mfma_f32_16x16x32_bf16 v[76:79], v[32:35], a[152:155], v[76:79]
ds_read_b128 v[48:51], v3 offset:10240
v_mfma_f32_16x16x32_bf16 v[76:79], v[36:39], a[156:159], v[76:79]
v_mfma_f32_16x16x32_bf16 v[80:83], v[8:11], a[160:163], 0
v_mfma_f32_16x16x32_bf16 v[80:83], v[12:15], a[164:167], v[80:83]
ds_read_b128 v[52:55], v3 offset:11264
v_mfma_f32_16x16x32_bf16 v[80:83], v[16:19], a[168:171], v[80:83]
v_mfma_f32_16x16x32_bf16 v[80:83], v[20:23], a[172:175], v[80:83]
v_mfma_f32_16x16x32_bf16 v[84:87], v[24:27], a[160:163], 0
ds_read_b128 v[56:59], v3 offset:12288
v_mfma_f32_16x16x32_bf16 v[84:87], v[28:31], a[164:167], v[84:87]
v_mfma_f32_16x16x32_bf16 v[84:87], v[32:35], a[168:171], v[84:87]
v_exp_f32 v72, v72
v_mfma_f32_16x16x32_bf16 v[84:87], v[36:39], a[172:175], v[84:87]
ds_read_b128 v[60:63], v3 offset:13312
v_exp_f32 v73, v73
v_mfma_f32_16x16x32_bf16 v[88:91], v[8:11], a[176:179], 0
v_exp_f32 v74, v74
v_mfma_f32_16x16x32_bf16 v[88:91], v[12:15], a[180:183], v[88:91]
v_exp_f32 v75, v75
v_mfma_f32_16x16x32_bf16 v[88:91], v[16:19], a[184:187], v[88:91]
ds_read_b128 v[64:67], v3 offset:14336
v_cvt_pk_bf16_f32 v104, v72, v73
v_mfma_f32_16x16x32_bf16 v[88:91], v[20:23], a[188:191], v[88:91]
v_exp_f32 v76, v76
v_mfma_f32_16x16x32_bf16 v[92:95], v[24:27], a[176:179], 0
v_exp_f32 v77, v77
v_mfma_f32_16x16x32_bf16 v[92:95], v[28:31], a[180:183], v[92:95]
ds_read_b128 v[68:71], v3 offset:15360
v_cvt_pk_bf16_f32 v105, v74, v75
v_mfma_f32_16x16x32_bf16 v[92:95], v[32:35], a[184:187], v[92:95]
v_exp_f32 v78, v78
v_mfma_f32_16x16x32_bf16 v[92:95], v[36:39], a[188:191], v[92:95]
v_exp_f32 v79, v79
v_mfma_f32_16x16x32_bf16 v[96:99], v[8:11], a[192:195], 0
v_cvt_pk_bf16_f32 v106, v76, v77
v_cvt_pk_bf16_f32 v107, v78, v79
v_mfma_f32_16x16x32_bf16 v[96:99], v[12:15], a[196:199], v[96:99]
v_exp_f32 v80, v80
v_mfma_f32_16x16x32_bf16 v[96:99], v[16:19], a[200:203], v[96:99]
v_exp_f32 v81, v81
v_mfma_f32_16x16x32_bf16 v[96:99], v[20:23], a[204:207], v[96:99]
v_exp_f32 v82, v82
v_mfma_f32_16x16x32_bf16 v[100:103], v[24:27], a[192:195], 0
v_exp_f32 v83, v83
v_mfma_f32_16x16x32_bf16 v[100:103], v[28:31], a[196:199], v[100:103]
v_cvt_pk_bf16_f32 v108, v80, v81
v_cvt_pk_bf16_f32 v109, v82, v83
v_mfma_f32_16x16x32_bf16 v[100:103], v[32:35], a[200:203], v[100:103]
v_exp_f32 v84, v84
v_mfma_f32_16x16x32_bf16 v[100:103], v[36:39], a[204:207], v[100:103]
v_exp_f32 v85, v85
s_waitcnt vmcnt(16) lgkmcnt(0)
s_barrier
v_mfma_f32_16x16x32_bf16 a[0:3], v[40:43], v[120:123], a[0:3]
ds_read_b128 v[8:11], v2 offset:24576
v_cvt_pk_bf16_f32 v110, v84, v85
v_mfma_f32_16x16x32_bf16 a[32:35], v[40:43], v[124:127], a[32:35]
s_add_u32 m0, s59, 16384
v_mfma_f32_16x16x32_bf16 a[64:67], v[40:43], v[128:131], a[64:67]
buffer_load_dwordx4 v1, s[4:7], s57 offen offset:0 sc1 lds
v_mfma_f32_16x16x32_bf16 a[96:99], v[40:43], v[132:135], a[96:99]
ds_read_b128 v[12:15], v2 offset:25600
v_exp_f32 v86, v86
v_mfma_f32_16x16x32_bf16 a[4:7], v[44:47], v[120:123], a[4:7]
v_exp_f32 v87, v87
v_mfma_f32_16x16x32_bf16 a[36:39], v[44:47], v[124:127], a[36:39]
v_exp_f32 v88, v88
v_mfma_f32_16x16x32_bf16 a[68:71], v[44:47], v[128:131], a[68:71]
ds_read_b128 v[16:19], v2 offset:26624
buffer_load_dwordx4 v1, s[4:7], s57 offen offset:1024 sc1 lds
v_mfma_f32_16x16x32_bf16 a[100:103], v[44:47], v[132:135], a[100:103]
v_exp_f32 v89, v89
v_mfma_f32_16x16x32_bf16 a[8:11], v[48:51], v[120:123], a[8:11]
v_cvt_pk_bf16_f32 v111, v86, v87
v_cvt_pk_bf16_f32 v112, v88, v89
v_mfma_f32_16x16x32_bf16 a[40:43], v[48:51], v[124:127], a[40:43]
ds_read_b128 v[20:23], v2 offset:27648
v_exp_f32 v90, v90
v_mfma_f32_16x16x32_bf16 a[72:75], v[48:51], v[128:131], a[72:75]
buffer_load_dwordx4 v1, s[4:7], s57 offen offset:2048 sc1 lds
v_exp_f32 v91, v91
v_mfma_f32_16x16x32_bf16 a[104:107], v[48:51], v[132:135], a[104:107]
v_exp_f32 v92, v92
v_mfma_f32_16x16x32_bf16 a[12:15], v[52:55], v[120:123], a[12:15]
ds_read_b128 v[24:27], v2 offset:28672
v_cvt_pk_bf16_f32 v113, v90, v91
v_mfma_f32_16x16x32_bf16 a[44:47], v[52:55], v[124:127], a[44:47]
v_exp_f32 v93, v93
v_mfma_f32_16x16x32_bf16 a[76:79], v[52:55], v[128:131], a[76:79]
buffer_load_dwordx4 v1, s[4:7], s57 offen offset:3072 sc1 lds
v_cvt_pk_bf16_f32 v114, v92, v93
v_mfma_f32_16x16x32_bf16 a[108:111], v[52:55], v[132:135], a[108:111]
ds_read_b128 v[28:31], v2 offset:29696
s_add_u32 s57, s57, 0x4000
v_exp_f32 v94, v94
v_mfma_f32_16x16x32_bf16 a[16:19], v[56:59], v[120:123], a[16:19]
v_exp_f32 v95, v95
v_mfma_f32_16x16x32_bf16 a[48:51], v[56:59], v[124:127], a[48:51]
s_add_u32 m0, s60, 8192
v_cvt_pk_bf16_f32 v115, v94, v95
v_mfma_f32_16x16x32_bf16 a[80:83], v[56:59], v[128:131], a[80:83]
ds_read_b128 v[32:35], v2 offset:30720
buffer_load_dwordx4 v1, s[4:7], s58 offen offset:0 sc1 lds
v_exp_f32 v96, v96
v_mfma_f32_16x16x32_bf16 a[112:115], v[56:59], v[132:135], a[112:115]
v_exp_f32 v97, v97
v_mfma_f32_16x16x32_bf16 a[20:23], v[60:63], v[120:123], a[20:23]
v_exp_f32 v98, v98
v_mfma_f32_16x16x32_bf16 a[52:55], v[60:63], v[124:127], a[52:55]
ds_read_b128 v[36:39], v2 offset:31744
v_cvt_pk_bf16_f32 v116, v96, v97
v_mfma_f32_16x16x32_bf16 a[84:87], v[60:63], v[128:131], a[84:87]
buffer_load_dwordx4 v1, s[4:7], s58 offen offset:1024 sc1 lds
v_exp_f32 v99, v99
v_mfma_f32_16x16x32_bf16 a[116:119], v[60:63], v[132:135], a[116:119]
v_exp_f32 v100, v100
v_mfma_f32_16x16x32_bf16 a[24:27], v[64:67], v[120:123], a[24:27]
v_exp_f32 v101, v101
v_mfma_f32_16x16x32_bf16 a[56:59], v[64:67], v[124:127], a[56:59]
v_cvt_pk_bf16_f32 v117, v98, v99
v_cvt_pk_bf16_f32 v118, v100, v101
v_mfma_f32_16x16x32_bf16 a[88:91], v[64:67], v[128:131], a[88:91]
buffer_load_dwordx4 v1, s[4:7], s58 offen offset:2048 sc1 lds
v_mfma_f32_16x16x32_bf16 a[120:123], v[64:67], v[132:135], a[120:123]
v_exp_f32 v102, v102
v_mfma_f32_16x16x32_bf16 a[28:31], v[68:71], v[120:123], a[28:31]
v_exp_f32 v103, v103
v_mfma_f32_16x16x32_bf16 a[60:63], v[68:71], v[124:127], a[60:63]
v_cvt_pk_bf16_f32 v119, v102, v103
v_mfma_f32_16x16x32_bf16 a[92:95], v[68:71], v[128:131], a[92:95]
buffer_load_dwordx4 v1, s[4:7], s58 offen offset:3072 sc1 lds
v_mfma_f32_16x16x32_bf16 a[124:127], v[68:71], v[132:135], a[124:127]
s_add_u32 s58, s58, 0x4000
v_mfma_f32_16x16x32_bf16 a[128:131], v[136:139], v[120:123], a[128:131]
v_mfma_f32_16x16x32_bf16 a[132:135], v[136:139], v[124:127], a[132:135]
v_mfma_f32_16x16x32_bf16 a[136:139], v[136:139], v[128:131], a[136:139]
v_mfma_f32_16x16x32_bf16 a[140:143], v[136:139], v[132:135], a[140:143]
s_waitcnt lgkmcnt(0)
v_mfma_f32_16x16x32_bf16 v[72:75], v[8:11], a[144:147], 0
ds_read_b128 v[40:43], v3 offset:16384
v_mfma_f32_16x16x32_bf16 v[72:75], v[12:15], a[148:151], v[72:75]
v_mfma_f32_16x16x32_bf16 v[72:75], v[16:19], a[152:155], v[72:75]
v_mfma_f32_16x16x32_bf16 v[72:75], v[20:23], a[156:159], v[72:75]
ds_read_b128 v[44:47], v3 offset:17408
v_mfma_f32_16x16x32_bf16 v[76:79], v[24:27], a[144:147], 0
v_mfma_f32_16x16x32_bf16 v[76:79], v[28:31], a[148:151], v[76:79]
v_mfma_f32_16x16x32_bf16 v[76:79], v[32:35], a[152:155], v[76:79]
ds_read_b128 v[48:51], v3 offset:18432
v_mfma_f32_16x16x32_bf16 v[76:79], v[36:39], a[156:159], v[76:79]
v_mfma_f32_16x16x32_bf16 v[80:83], v[8:11], a[160:163], 0
v_mfma_f32_16x16x32_bf16 v[80:83], v[12:15], a[164:167], v[80:83]
ds_read_b128 v[52:55], v3 offset:19456
v_mfma_f32_16x16x32_bf16 v[80:83], v[16:19], a[168:171], v[80:83]
v_mfma_f32_16x16x32_bf16 v[80:83], v[20:23], a[172:175], v[80:83]
v_mfma_f32_16x16x32_bf16 v[84:87], v[24:27], a[160:163], 0
ds_read_b128 v[56:59], v3 offset:20480
v_mfma_f32_16x16x32_bf16 v[84:87], v[28:31], a[164:167], v[84:87]
v_mfma_f32_16x16x32_bf16 v[84:87], v[32:35], a[168:171], v[84:87]
v_exp_f32 v72, v72
v_mfma_f32_16x16x32_bf16 v[84:87], v[36:39], a[172:175], v[84:87]
ds_read_b128 v[60:63], v3 offset:21504
v_exp_f32 v73, v73
v_mfma_f32_16x16x32_bf16 v[88:91], v[8:11], a[176:179], 0
v_exp_f32 v74, v74
v_mfma_f32_16x16x32_bf16 v[88:91], v[12:15], a[180:183], v[88:91]
v_exp_f32 v75, v75
v_mfma_f32_16x16x32_bf16 v[88:91], v[16:19], a[184:187], v[88:91]
ds_read_b128 v[64:67], v3 offset:22528
v_cvt_pk_bf16_f32 v120, v72, v73
v_mfma_f32_16x16x32_bf16 v[88:91], v[20:23], a[188:191], v[88:91]
v_exp_f32 v76, v76
v_mfma_f32_16x16x32_bf16 v[92:95], v[24:27], a[176:179], 0
v_exp_f32 v77, v77
v_mfma_f32_16x16x32_bf16 v[92:95], v[28:31], a[180:183], v[92:95]
ds_read_b128 v[68:71], v3 offset:23552
v_cvt_pk_bf16_f32 v121, v74, v75
v_mfma_f32_16x16x32_bf16 v[92:95], v[32:35], a[184:187], v[92:95]
v_exp_f32 v78, v78
v_mfma_f32_16x16x32_bf16 v[92:95], v[36:39], a[188:191], v[92:95]
v_exp_f32 v79, v79
v_mfma_f32_16x16x32_bf16 v[96:99], v[8:11], a[192:195], 0
v_cvt_pk_bf16_f32 v122, v76, v77
v_cvt_pk_bf16_f32 v123, v78, v79
v_mfma_f32_16x16x32_bf16 v[96:99], v[12:15], a[196:199], v[96:99]
v_exp_f32 v80, v80
v_mfma_f32_16x16x32_bf16 v[96:99], v[16:19], a[200:203], v[96:99]
v_exp_f32 v81, v81
v_mfma_f32_16x16x32_bf16 v[96:99], v[20:23], a[204:207], v[96:99]
v_exp_f32 v82, v82
v_mfma_f32_16x16x32_bf16 v[100:103], v[24:27], a[192:195], 0
v_exp_f32 v83, v83
v_mfma_f32_16x16x32_bf16 v[100:103], v[28:31], a[196:199], v[100:103]
v_cvt_pk_bf16_f32 v124, v80, v81
v_cvt_pk_bf16_f32 v125, v82, v83
v_mfma_f32_16x16x32_bf16 v[100:103], v[32:35], a[200:203], v[100:103]
v_exp_f32 v84, v84
v_mfma_f32_16x16x32_bf16 v[100:103], v[36:39], a[204:207], v[100:103]
v_exp_f32 v85, v85
s_waitcnt vmcnt(16) lgkmcnt(0)
s_barrier
v_mfma_f32_16x16x32_bf16 a[0:3], v[40:43], v[104:107], a[0:3]
ds_read_b128 v[8:11], v2 offset:0
v_cvt_pk_bf16_f32 v126, v84, v85
v_mfma_f32_16x16x32_bf16 a[32:35], v[40:43], v[108:111], a[32:35]
s_add_u32 m0, s59, 24576
v_mfma_f32_16x16x32_bf16 a[64:67], v[40:43], v[112:115], a[64:67]
buffer_load_dwordx4 v1, s[4:7], s57 offen offset:0 sc1 lds
v_mfma_f32_16x16x32_bf16 a[96:99], v[40:43], v[116:119], a[96:99]
ds_read_b128 v[12:15], v2 offset:1024
v_exp_f32 v86, v86
v_mfma_f32_16x16x32_bf16 a[4:7], v[44:47], v[104:107], a[4:7]
v_exp_f32 v87, v87
v_mfma_f32_16x16x32_bf16 a[36:39], v[44:47], v[108:111], a[36:39]
v_exp_f32 v88, v88
v_mfma_f32_16x16x32_bf16 a[68:71], v[44:47], v[112:115], a[68:71]
ds_read_b128 v[16:19], v2 offset:2048
buffer_load_dwordx4 v1, s[4:7], s57 offen offset:1024 sc1 lds
v_mfma_f32_16x16x32_bf16 a[100:103], v[44:47], v[116:119], a[100:103]
v_exp_f32 v89, v89
v_mfma_f32_16x16x32_bf16 a[8:11], v[48:51], v[104:107], a[8:11]
v_cvt_pk_bf16_f32 v127, v86, v87
v_cvt_pk_bf16_f32 v128, v88, v89
v_mfma_f32_16x16x32_bf16 a[40:43], v[48:51], v[108:111], a[40:43]
ds_read_b128 v[20:23], v2 offset:3072
v_exp_f32 v90, v90
v_mfma_f32_16x16x32_bf16 a[72:75], v[48:51], v[112:115], a[72:75]
buffer_load_dwordx4 v1, s[4:7], s57 offen offset:2048 sc1 lds
v_exp_f32 v91, v91
v_mfma_f32_16x16x32_bf16 a[104:107], v[48:51], v[116:119], a[104:107]
v_exp_f32 v92, v92
v_mfma_f32_16x16x32_bf16 a[12:15], v[52:55], v[104:107], a[12:15]
ds_read_b128 v[24:27], v2 offset:4096
v_cvt_pk_bf16_f32 v129, v90, v91
v_mfma_f32_16x16x32_bf16 a[44:47], v[52:55], v[108:111], a[44:47]
v_exp_f32 v93, v93
v_mfma_f32_16x16x32_bf16 a[76:79], v[52:55], v[112:115], a[76:79]
buffer_load_dwordx4 v1, s[4:7], s57 offen offset:3072 sc1 lds
v_cvt_pk_bf16_f32 v130, v92, v93
v_mfma_f32_16x16x32_bf16 a[108:111], v[52:55], v[116:119], a[108:111]
ds_read_b128 v[28:31], v2 offset:5120
s_add_u32 s57, s57, 0x4000
v_exp_f32 v94, v94
v_mfma_f32_16x16x32_bf16 a[16:19], v[56:59], v[104:107], a[16:19]
v_exp_f32 v95, v95
v_mfma_f32_16x16x32_bf16 a[48:51], v[56:59], v[108:111], a[48:51]
s_add_u32 m0, s60, 16384
v_cvt_pk_bf16_f32 v131, v94, v95
v_mfma_f32_16x16x32_bf16 a[80:83], v[56:59], v[112:115], a[80:83]
ds_read_b128 v[32:35], v2 offset:6144
buffer_load_dwordx4 v1, s[4:7], s58 offen offset:0 sc1 lds
v_exp_f32 v96, v96
v_mfma_f32_16x16x32_bf16 a[112:115], v[56:59], v[116:119], a[112:115]
v_exp_f32 v97, v97
v_mfma_f32_16x16x32_bf16 a[20:23], v[60:63], v[104:107], a[20:23]
v_exp_f32 v98, v98
v_mfma_f32_16x16x32_bf16 a[52:55], v[60:63], v[108:111], a[52:55]
ds_read_b128 v[36:39], v2 offset:7168
v_cvt_pk_bf16_f32 v132, v96, v97
v_mfma_f32_16x16x32_bf16 a[84:87], v[60:63], v[112:115], a[84:87]
buffer_load_dwordx4 v1, s[4:7], s58 offen offset:1024 sc1 lds
v_exp_f32 v99, v99
v_mfma_f32_16x16x32_bf16 a[116:119], v[60:63], v[116:119], a[116:119]
v_exp_f32 v100, v100
v_mfma_f32_16x16x32_bf16 a[24:27], v[64:67], v[104:107], a[24:27]
v_exp_f32 v101, v101
v_mfma_f32_16x16x32_bf16 a[56:59], v[64:67], v[108:111], a[56:59]
v_cvt_pk_bf16_f32 v133, v98, v99
v_cvt_pk_bf16_f32 v134, v100, v101
v_mfma_f32_16x16x32_bf16 a[88:91], v[64:67], v[112:115], a[88:91]
buffer_load_dwordx4 v1, s[4:7], s58 offen offset:2048 sc1 lds
v_mfma_f32_16x16x32_bf16 a[120:123], v[64:67], v[116:119], a[120:123]
v_exp_f32 v102, v102
v_mfma_f32_16x16x32_bf16 a[28:31], v[68:71], v[104:107], a[28:31]
v_exp_f32 v103, v103
v_mfma_f32_16x16x32_bf16 a[60:63], v[68:71], v[108:111], a[60:63]
v_cvt_pk_bf16_f32 v135, v102, v103
v_mfma_f32_16x16x32_bf16 a[92:95], v[68:71], v[112:115], a[92:95]
buffer_load_dwordx4 v1, s[4:7], s58 offen offset:3072 sc1 lds
v_mfma_f32_16x16x32_bf16 a[124:127], v[68:71], v[116:119], a[124:127]
s_add_u32 s58, s58, 0x4000
v_mfma_f32_16x16x32_bf16 a[128:131], v[136:139], v[104:107], a[128:131]
v_mfma_f32_16x16x32_bf16 a[132:135], v[136:139], v[108:111], a[132:135]
v_mfma_f32_16x16x32_bf16 a[136:139], v[136:139], v[112:115], a[136:139]
v_mfma_f32_16x16x32_bf16 a[140:143], v[136:139], v[116:119], a[140:143]
s_mov_b32 s68, 0
s_mov_b32 s70, 0x7f000000
s_add_u32 s61, s61, 1
s_cmp_lt_u32 s61, 4
s_cbranch_scc1 L_plain
ds_read_b128 v[40:43], v3 offset:24576
ds_read_b128 v[44:47], v3 offset:25600
ds_read_b128 v[48:51], v3 offset:26624
ds_read_b128 v[52:55], v3 offset:27648
ds_read_b128 v[56:59], v3 offset:28672
ds_read_b128 v[60:63], v3 offset:29696
ds_read_b128 v[64:67], v3 offset:30720
ds_read_b128 v[68:71], v3 offset:31744
s_lshl_b32 s72, s52, 14
v_add_u32 v4, s72, v1
s_xor_b32 s73, s52, 2
s_lshl_b32 s73, s73, 14
v_add_u32 v5, s73, v1
v_lshrrev_b32 v72, 1, v1
s_lshl_b32 s72, s52, 9
s_add_u32 s72, s72, 0x10000
v_add_u32 v73, s72, v72
s_lshl_b32 s73, s52, 9
s_xor_b32 s73, s73, 0x400
s_add_u32 s73, s73, 0x10000
v_add_u32 v74, s73, v72
s_waitcnt lgkmcnt(0)
v_mfma_f32_16x16x32_bf16 a[64:67], v[40:43], v[128:131], a[64:67]
v_mfma_f32_16x16x32_bf16 a[68:71], v[44:47], v[128:131], a[68:71]
v_mfma_f32_16x16x32_bf16 a[72:75], v[48:51], v[128:131], a[72:75]
v_mfma_f32_16x16x32_bf16 a[76:79], v[52:55], v[128:131], a[76:79]
v_mfma_f32_16x16x32_bf16 a[80:83], v[56:59], v[128:131], a[80:83]
v_mfma_f32_16x16x32_bf16 a[84:87], v[60:63], v[128:131], a[84:87]
v_mfma_f32_16x16x32_bf16 a[88:91], v[64:67], v[128:131], a[88:91]
v_mfma_f32_16x16x32_bf16 a[92:95], v[68:71], v[128:131], a[92:95]
v_mfma_f32_16x16x32_bf16 a[136:139], v[136:139], v[128:131], a[136:139]
v_mfma_f32_16x16x32_bf16 a[96:99], v[40:43], v[132:135], a[96:99]
v_mfma_f32_16x16x32_bf16 a[100:103], v[44:47], v[132:135], a[100:103]
v_mfma_f32_16x16x32_bf16 a[104:107], v[48:51], v[132:135], a[104:107]
v_mfma_f32_16x16x32_bf16 a[108:111], v[52:55], v[132:135], a[108:111]
v_mfma_f32_16x16x32_bf16 a[112:115], v[56:59], v[132:135], a[112:115]
v_mfma_f32_16x16x32_bf16 a[116:119], v[60:63], v[132:135], a[116:119]
v_mfma_f32_16x16x32_bf16 a[120:123], v[64:67], v[132:135], a[120:123]
v_mfma_f32_16x16x32_bf16 a[124:127], v[68:71], v[132:135], a[124:127]
v_mfma_f32_16x16x32_bf16 a[140:143], v[136:139], v[132:135], a[140:143]
s_waitcnt vmcnt(0)
s_barrier
v_mfma_f32_16x16x32_bf16 a[0:3], v[40:43], v[120:123], a[0:3]
v_mfma_f32_16x16x32_bf16 a[4:7], v[44:47], v[120:123], a[4:7]
v_mfma_f32_16x16x32_bf16 a[8:11], v[48:51], v[120:123], a[8:11]
ds_write_b128 v4, a[64:67] offset:0
v_mfma_f32_16x16x32_bf16 a[12:15], v[52:55], v[120:123], a[12:15]
ds_write_b128 v4, a[68:71] offset:1024
v_mfma_f32_16x16x32_bf16 a[16:19], v[56:59], v[120:123], a[16:19]
ds_write_b128 v4, a[72:75] offset:2048
v_mfma_f32_16x16x32_bf16 a[20:23], v[60:63], v[120:123], a[20:23]
ds_write_b128 v4, a[76:79] offset:3072
v_mfma_f32_16x16x32_bf16 a[24:27], v[64:67], v[120:123], a[24:27]
ds_write_b128 v4, a[80:83] offset:4096
v_mfma_f32_16x16x32_bf16 a[28:31], v[68:71], v[120:123], a[28:31]
ds_write_b128 v4, a[84:87] offset:5120
v_mfma_f32_16x16x32_bf16 a[128:131], v[136:139], v[120:123], a[128:131]
v_mfma_f32_16x16x32_bf16 a[32:35], v[40:43], v[124:127], a[32:35]
ds_write_b128 v4, a[88:91] offset:6144
v_mfma_f32_16x16x32_bf16 a[36:39], v[44:47], v[124:127], a[36:39]
ds_write_b128 v4, a[92:95] offset:7168
v_mfma_f32_16x16x32_bf16 a[40:43], v[48:51], v[124:127], a[40:43]
ds_write_b128 v4, a[96:99] offset:8192
v_mfma_f32_16x16x32_bf16 a[44:47], v[52:55], v[124:127], a[44:47]
ds_write_b128 v4, a[100:103] offset:9216
v_mfma_f32_16x16x32_bf16 a[48:51], v[56:59], v[124:127], a[48:51]
ds_write_b128 v4, a[104:107] offset:10240
v_mfma_f32_16x16x32_bf16 a[52:55], v[60:63], v[124:127], a[52:55]
ds_write_b128 v4, a[108:111] offset:11264
v_mfma_f32_16x16x32_bf16 a[56:59], v[64:67], v[124:127], a[56:59]
ds_write_b128 v4, a[112:115] offset:12288
v_mfma_f32_16x16x32_bf16 a[60:63], v[68:71], v[124:127], a[60:63]
ds_write_b128 v4, a[116:119] offset:13312
v_mfma_f32_16x16x32_bf16 a[132:135], v[136:139], v[124:127], a[132:135]
ds_write_b128 v4, a[120:123] offset:14336
ds_write_b128 v4, a[124:127] offset:15360
v_accvgpr_read_b32 v6, a136
v_accvgpr_read_b32 v7, a140
s_nop 1
ds_write_b64 v73, v[6:7]
v_accvgpr_read_b32 v140, a0
v_accvgpr_read_b32 v141, a1
v_accvgpr_read_b32 v142, a2
v_accvgpr_read_b32 v143, a3
v_accvgpr_read_b32 v144, a4
v_accvgpr_read_b32 v145, a5
v_accvgpr_read_b32 v146, a6
v_accvgpr_read_b32 v147, a7
v_accvgpr_read_b32 v148, a8
v_accvgpr_read_b32 v149, a9
v_accvgpr_read_b32 v150, a10
v_accvgpr_read_b32 v151, a11
v_accvgpr_read_b32 v152, a12
v_accvgpr_read_b32 v153, a13
v_accvgpr_read_b32 v154, a14
v_accvgpr_read_b32 v155, a15
v_accvgpr_read_b32 v156, a16
v_accvgpr_read_b32 v157, a17
v_accvgpr_read_b32 v158, a18
v_accvgpr_read_b32 v159, a19
v_accvgpr_read_b32 v160, a20
v_accvgpr_read_b32 v161, a21
v_accvgpr_read_b32 v162, a22
v_accvgpr_read_b32 v163, a23
v_accvgpr_read_b32 v164, a24
v_accvgpr_read_b32 v165, a25
v_accvgpr_read_b32 v166, a26
v_accvgpr_read_b32 v167, a27
v_accvgpr_read_b32 v168, a28
v_accvgpr_read_b32 v169, a29
v_accvgpr_read_b32 v170, a30
v_accvgpr_read_b32 v171, a31
v_accvgpr_read_b32 v172, a32
v_accvgpr_read_b32 v173, a33
v_accvgpr_read_b32 v174, a34
v_accvgpr_read_b32 v175, a35
v_accvgpr_read_b32 v176, a36
v_accvgpr_read_b32 v177, a37
v_accvgpr_read_b32 v178, a38
v_accvgpr_read_b32 v179, a39
v_accvgpr_read_b32 v180, a40
v_accvgpr_read_b32 v181, a41
v_accvgpr_read_b32 v182, a42
v_accvgpr_read_b32 v183, a43
v_accvgpr_read_b32 v184, a44
v_accvgpr_read_b32 v185, a45
v_accvgpr_read_b32 v186, a46
v_accvgpr_read_b32 v187, a47
v_accvgpr_read_b32 v188, a48
v_accvgpr_read_b32 v189, a49
v_accvgpr_read_b32 v190, a50
v_accvgpr_read_b32 v191, a51
v_accvgpr_read_b32 v192, a52
v_accvgpr_read_b32 v193, a53
v_accvgpr_read_b32 v194, a54
v_accvgpr_read_b32 v195, a55
v_accvgpr_read_b32 v196, a56
v_accvgpr_read_b32 v197, a57
v_accvgpr_read_b32 v198, a58
v_accvgpr_read_b32 v199, a59
v_accvgpr_read_b32 v200, a60
v_accvgpr_read_b32 v201, a61
v_accvgpr_read_b32 v202, a62
v_accvgpr_read_b32 v203, a63
v_accvgpr_read_b32 v76, a128
v_accvgpr_read_b32 v77, a132
v_and_b32 v80, 15, v0
v_lshlrev_b32 v80, 8, v80
v_lshrrev_b32 v81, 4, v0
v_lshl_add_u32 v80, v81, 4, v80
s_lshl_b32 s72, s56, 15
s_lshl_b32 s73, s53, 14
s_add_u32 s72, s72, s73
s_lshl_b32 s73, s54, 13
s_add_u32 s72, s72, s73
s_add_u32 s73, s72, 0x1000
s_waitcnt lgkmcnt(0)
s_barrier
ds_read_b64 v[6:7], v74
ds_read_b128 v[8:11], v5 offset:0
ds_read_b128 v[12:15], v5 offset:1024
ds_read_b128 v[16:19], v5 offset:2048
ds_read_b128 v[20:23], v5 offset:3072
ds_read_b128 v[24:27], v5 offset:4096
ds_read_b128 v[28:31], v5 offset:5120
ds_read_b128 v[32:35], v5 offset:6144
ds_read_b128 v[36:39], v5 offset:7168
ds_read_b128 v[40:43], v5 offset:8192
ds_read_b128 v[44:47], v5 offset:9216
ds_read_b128 v[48:51], v5 offset:10240
ds_read_b128 v[52:55], v5 offset:11264
ds_read_b128 v[56:59], v5 offset:12288
ds_read_b128 v[60:63], v5 offset:13312
ds_read_b128 v[64:67], v5 offset:14336
ds_read_b128 v[68:71], v5 offset:15360
v_mov_b32 v75, 0x2b800000
v_mov_b32 v78, 0x53800000
s_waitcnt lgkmcnt(15)
v_add_f32 v6, v6, v76
v_add_f32 v7, v7, v77
v_cmp_lt_f32 s[40:41], v75, v6
v_cmp_gt_f32 s[42:43], v78, v6
v_cmp_lt_f32 s[44:45], v75, v7
v_cmp_gt_f32 s[46:47], v78, v7
v_rcp_f32 v6, v6
v_rcp_f32 v7, v7
s_nop 3
s_and_b64 s[40:41], s[40:41], s[42:43]
s_and_b64 s[44:45], s[44:45], s[46:47]
s_and_b64 s[40:41], s[40:41], s[44:45]
s_cmp_eq_u64 s[40:41], -1
s_cbranch_scc0 A_exact
v_mov_b32 v72, v6
v_mov_b32 v73, v6
v_mov_b32 v74, v7
v_mov_b32 v75, v7
s_waitcnt lgkmcnt(12)
v_pk_add_f32 v[140:141], v[140:141], v[8:9]
v_pk_add_f32 v[142:143], v[142:143], v[10:11]
v_pk_add_f32 v[144:145], v[144:145], v[12:13]
v_pk_add_f32 v[146:147], v[146:147], v[14:15]
v_pk_add_f32 v[148:149], v[148:149], v[16:17]
v_pk_add_f32 v[150:151], v[150:151], v[18:19]
v_pk_add_f32 v[152:153], v[152:153], v[20:21]
v_pk_add_f32 v[154:155], v[154:155], v[22:23]
v_pk_mul_f32 v[140:141], v[140:141], v[72:73]
v_pk_mul_f32 v[142:143], v[142:143], v[72:73]
v_pk_mul_f32 v[144:145], v[144:145], v[72:73]
v_pk_mul_f32 v[146:147], v[146:147], v[72:73]
v_pk_mul_f32 v[148:149], v[148:149], v[72:73]
v_pk_mul_f32 v[150:151], v[150:151], v[72:73]
v_pk_mul_f32 v[152:153], v[152:153], v[72:73]
v_pk_mul_f32 v[154:155], v[154:155], v[72:73]
v_cvt_pk_bf16_f32 v84, v140, v144
v_cvt_pk_bf16_f32 v85, v148, v152
v_cvt_pk_bf16_f32 v86, v141, v145
v_cvt_pk_bf16_f32 v87, v149, v153
buffer_store_dwordx4 v[84:87], v80, s[36:39], s72 offen offset:0
v_cvt_pk_bf16_f32 v88, v142, v146
v_cvt_pk_bf16_f32 v89, v150, v154
v_cvt_pk_bf16_f32 v90, v143, v147
v_cvt_pk_bf16_f32 v91, v151, v155
buffer_store_dwordx4 v[88:91], v80, s[36:39], s72 offen offset:64
s_waitcnt lgkmcnt(8)
v_pk_add_f32 v[156:157], v[156:157], v[24:25]
v_pk_add_f32 v[158:159], v[158:159], v[26:27]
v_pk_add_f32 v[160:161], v[160:161], v[28:29]
v_pk_add_f32 v[162:163], v[162:163], v[30:31]
v_pk_add_f32 v[164:165], v[164:165], v[32:33]
v_pk_add_f32 v[166:167], v[166:167], v[34:35]
v_pk_add_f32 v[168:169], v[168:169], v[36:37]
v_pk_add_f32 v[170:171], v[170:171], v[38:39]
v_pk_mul_f32 v[156:157], v[156:157], v[72:73]
v_pk_mul_f32 v[158:159], v[158:159], v[72:73]
v_pk_mul_f32 v[160:161], v[160:161], v[72:73]
v_pk_mul_f32 v[162:163], v[162:163], v[72:73]
v_pk_mul_f32 v[164:165], v[164:165], v[72:73]
v_pk_mul_f32 v[166:167], v[166:167], v[72:73]
v_pk_mul_f32 v[168:169], v[168:169], v[72:73]
v_pk_mul_f32 v[170:171], v[170:171], v[72:73]
v_cvt_pk_bf16_f32 v92, v156, v160
v_cvt_pk_bf16_f32 v93, v164, v168
v_cvt_pk_bf16_f32 v94, v157, v161
v_cvt_pk_bf16_f32 v95, v165, v169
buffer_store_dwordx4 v[92:95], v80, s[36:39], s72 offen offset:128
v_cvt_pk_bf16_f32 v96, v158, v162
v_cvt_pk_bf16_f32 v97, v166, v170
v_cvt_pk_bf16_f32 v98, v159, v163
v_cvt_pk_bf16_f32 v99, v167, v171
buffer_store_dwordx4 v[96:99], v80, s[36:39], s72 offen offset:192
s_waitcnt lgkmcnt(4)
v_pk_add_f32 v[172:173], v[172:173], v[40:41]
v_pk_add_f32 v[174:175], v[174:175], v[42:43]
v_pk_add_f32 v[176:177], v[176:177], v[44:45]
v_pk_add_f32 v[178:179], v[178:179], v[46:47]
v_pk_add_f32 v[180:181], v[180:181], v[48:49]
v_pk_add_f32 v[182:183], v[182:183], v[50:51]
v_pk_add_f32 v[184:185], v[184:185], v[52:53]
v_pk_add_f32 v[186:187], v[186:187], v[54:55]
v_pk_mul_f32 v[172:173], v[172:173], v[74:75]
v_pk_mul_f32 v[174:175], v[174:175], v[74:75]
v_pk_mul_f32 v[176:177], v[176:177], v[74:75]
v_pk_mul_f32 v[178:179], v[178:179], v[74:75]
v_pk_mul_f32 v[180:181], v[180:181], v[74:75]
v_pk_mul_f32 v[182:183], v[182:183], v[74:75]
v_pk_mul_f32 v[184:185], v[184:185], v[74:75]
v_pk_mul_f32 v[186:187], v[186:187], v[74:75]
v_cvt_pk_bf16_f32 v100, v172, v176
v_cvt_pk_bf16_f32 v101, v180, v184
v_cvt_pk_bf16_f32 v102, v173, v177
v_cvt_pk_bf16_f32 v103, v181, v185
buffer_store_dwordx4 v[100:103], v80, s[36:39], s73 offen offset:0
v_cvt_pk_bf16_f32 v104, v174, v178
v_cvt_pk_bf16_f32 v105, v182, v186
v_cvt_pk_bf16_f32 v106, v175, v179
v_cvt_pk_bf16_f32 v107, v183, v187
buffer_store_dwordx4 v[104:107], v80, s[36:39], s73 offen offset:64
s_waitcnt lgkmcnt(0)
v_pk_add_f32 v[188:189], v[188:189], v[56:57]
v_pk_add_f32 v[190:191], v[190:191], v[58:59]
v_pk_add_f32 v[192:193], v[192:193], v[60:61]
v_pk_add_f32 v[194:195], v[194:195], v[62:63]
v_pk_add_f32 v[196:197], v[196:197], v[64:65]
v_pk_add_f32 v[198:199], v[198:199], v[66:67]
v_pk_add_f32 v[200:201], v[200:201], v[68:69]
v_pk_add_f32 v[202:203], v[202:203], v[70:71]
v_pk_mul_f32 v[188:189], v[188:189], v[74:75]
v_pk_mul_f32 v[190:191], v[190:191], v[74:75]
v_pk_mul_f32 v[192:193], v[192:193], v[74:75]
v_pk_mul_f32 v[194:195], v[194:195], v[74:75]
v_pk_mul_f32 v[196:197], v[196:197], v[74:75]
v_pk_mul_f32 v[198:199], v[198:199], v[74:75]
v_pk_mul_f32 v[200:201], v[200:201], v[74:75]
v_pk_mul_f32 v[202:203], v[202:203], v[74:75]
v_cvt_pk_bf16_f32 v108, v188, v192
v_cvt_pk_bf16_f32 v109, v196, v200
v_cvt_pk_bf16_f32 v110, v189, v193
v_cvt_pk_bf16_f32 v111, v197, v201
buffer_store_dwordx4 v[108:111], v80, s[36:39], s73 offen offset:128
v_cvt_pk_bf16_f32 v112, v190, v194
v_cvt_pk_bf16_f32 v113, v198, v202
v_cvt_pk_bf16_f32 v114, v191, v195
v_cvt_pk_bf16_f32 v115, v199, v203
buffer_store_dwordx4 v[112:115], v80, s[36:39], s73 offen offset:192
s_endpgm
A_store:
v_and_b32 v4, 15, v0
v_lshlrev_b32 v4, 8, v4
v_lshrrev_b32 v5, 4, v0
v_lshl_add_u32 v4, v5, 4, v4
s_lshl_b32 s72, s56, 15
s_lshl_b32 s73, s53, 14
s_add_u32 s72, s72, s73
s_lshl_b32 s73, s54, 13
s_add_u32 s72, s72, s73
s_add_u32 s73, s72, 0x1000
v_mov_b32 v72, v6
v_mov_b32 v73, v6
v_mov_b32 v74, v7
v_mov_b32 v75, v7
v_pk_mul_f32 v[140:141], v[140:141], v[72:73]
v_pk_mul_f32 v[142:143], v[142:143], v[72:73]
v_pk_mul_f32 v[144:145], v[144:145], v[72:73]
v_pk_mul_f32 v[146:147], v[146:147], v[72:73]
v_pk_mul_f32 v[148:149], v[148:149], v[72:73]
v_pk_mul_f32 v[150:151], v[150:151], v[72:73]
v_pk_mul_f32 v[152:153], v[152:153], v[72:73]
v_pk_mul_f32 v[154:155], v[154:155], v[72:73]
v_pk_mul_f32 v[156:157], v[156:157], v[72:73]
v_pk_mul_f32 v[158:159], v[158:159], v[72:73]
v_pk_mul_f32 v[160:161], v[160:161], v[72:73]
v_pk_mul_f32 v[162:163], v[162:163], v[72:73]
v_pk_mul_f32 v[164:165], v[164:165], v[72:73]
v_pk_mul_f32 v[166:167], v[166:167], v[72:73]
v_pk_mul_f32 v[168:169], v[168:169], v[72:73]
v_pk_mul_f32 v[170:171], v[170:171], v[72:73]
v_cvt_pk_bf16_f32 v8, v140, v144
v_cvt_pk_bf16_f32 v9, v148, v152
v_cvt_pk_bf16_f32 v10, v141, v145
v_cvt_pk_bf16_f32 v11, v149, v153
buffer_store_dwordx4 v[8:11], v4, s[36:39], s72 offen offset:0
v_cvt_pk_bf16_f32 v12, v142, v146
v_cvt_pk_bf16_f32 v13, v150, v154
v_cvt_pk_bf16_f32 v14, v143, v147
v_cvt_pk_bf16_f32 v15, v151, v155
buffer_store_dwordx4 v[12:15], v4, s[36:39], s72 offen offset:64
v_cvt_pk_bf16_f32 v16, v156, v160
v_cvt_pk_bf16_f32 v17, v164, v168
v_cvt_pk_bf16_f32 v18, v157, v161
v_cvt_pk_bf16_f32 v19, v165, v169
buffer_store_dwordx4 v[16:19], v4, s[36:39], s72 offen offset:128
v_cvt_pk_bf16_f32 v20, v158, v162
v_cvt_pk_bf16_f32 v21, v166, v170
v_cvt_pk_bf16_f32 v22, v159, v163
v_cvt_pk_bf16_f32 v23, v167, v171
buffer_store_dwordx4 v[20:23], v4, s[36:39], s72 offen offset:192
v_pk_mul_f32 v[172:173], v[172:173], v[74:75]
v_pk_mul_f32 v[174:175], v[174:175], v[74:75]
v_pk_mul_f32 v[176:177], v[176:177], v[74:75]
v_pk_mul_f32 v[178:179], v[178:179], v[74:75]
v_pk_mul_f32 v[180:181], v[180:181], v[74:75]
v_pk_mul_f32 v[182:183], v[182:183], v[74:75]
v_pk_mul_f32 v[184:185], v[184:185], v[74:75]
v_pk_mul_f32 v[186:187], v[186:187], v[74:75]
v_pk_mul_f32 v[188:189], v[188:189], v[74:75]
v_pk_mul_f32 v[190:191], v[190:191], v[74:75]
v_pk_mul_f32 v[192:193], v[192:193], v[74:75]
v_pk_mul_f32 v[194:195], v[194:195], v[74:75]
v_pk_mul_f32 v[196:197], v[196:197], v[74:75]
v_pk_mul_f32 v[198:199], v[198:199], v[74:75]
v_pk_mul_f32 v[200:201], v[200:201], v[74:75]
v_pk_mul_f32 v[202:203], v[202:203], v[74:75]
v_cvt_pk_bf16_f32 v24, v172, v176
v_cvt_pk_bf16_f32 v25, v180, v184
v_cvt_pk_bf16_f32 v26, v173, v177
v_cvt_pk_bf16_f32 v27, v181, v185
buffer_store_dwordx4 v[24:27], v4, s[36:39], s73 offen offset:0
v_cvt_pk_bf16_f32 v28, v174, v178
v_cvt_pk_bf16_f32 v29, v182, v186
v_cvt_pk_bf16_f32 v30, v175, v179
v_cvt_pk_bf16_f32 v31, v183, v187
buffer_store_dwordx4 v[28:31], v4, s[36:39], s73 offen offset:64
v_cvt_pk_bf16_f32 v32, v188, v192
v_cvt_pk_bf16_f32 v33, v196, v200
v_cvt_pk_bf16_f32 v34, v189, v193
v_cvt_pk_bf16_f32 v35, v197, v201
buffer_store_dwordx4 v[32:35], v4, s[36:39], s73 offen offset:128
v_cvt_pk_bf16_f32 v36, v190, v194
v_cvt_pk_bf16_f32 v37, v198, v202
v_cvt_pk_bf16_f32 v38, v191, v195
v_cvt_pk_bf16_f32 v39, v199, v203
buffer_store_dwordx4 v[36:39], v4, s[36:39], s73 offen offset:192
s_endpgm
A_exact:
s_waitcnt lgkmcnt(0)
v_mov_b32 v76, 0xff800000
v_mov_b32 v80, 0xff800000
s_mov_b32 s48, 0
s_mov_b32 s44, 0
s_add_u32 s45, s44, 0x1000
A_x1:
buffer_load_dwordx4 v[8:11], v1, s[12:15], s44 offen offset:0 sc1
buffer_load_dwordx4 v[12:15], v1, s[12:15], s44 offen offset:1024 sc1
buffer_load_dwordx4 v[16:19], v1, s[12:15], s44 offen offset:2048 sc1
buffer_load_dwordx4 v[20:23], v1, s[12:15], s44 offen offset:3072 sc1
buffer_load_dwordx4 v[24:27], v1, s[12:15], s45 offen offset:0 sc1
buffer_load_dwordx4 v[28:31], v1, s[12:15], s45 offen offset:1024 sc1
buffer_load_dwordx4 v[32:35], v1, s[12:15], s45 offen offset:2048 sc1
buffer_load_dwordx4 v[36:39], v1, s[12:15], s45 offen offset:3072 sc1
s_waitcnt vmcnt(0)
v_mfma_f32_16x16x32_bf16 v[84:87], v[8:11], a[144:147], 0
v_mfma_f32_16x16x32_bf16 v[84:87], v[12:15], a[148:151], v[84:87]
v_mfma_f32_16x16x32_bf16 v[84:87], v[16:19], a[152:155], v[84:87]
v_mfma_f32_16x16x32_bf16 v[84:87], v[20:23], a[156:159], v[84:87]
v_mfma_f32_16x16x32_bf16 v[88:91], v[24:27], a[144:147], 0
v_mfma_f32_16x16x32_bf16 v[88:91], v[28:31], a[148:151], v[88:91]
v_mfma_f32_16x16x32_bf16 v[88:91], v[32:35], a[152:155], v[88:91]
v_mfma_f32_16x16x32_bf16 v[88:91], v[36:39], a[156:159], v[88:91]
s_nop 7
s_nop 7
v_max_f32 v76, v76, v84
v_max_f32 v76, v76, v85
v_max_f32 v76, v76, v86
v_max_f32 v76, v76, v87
v_max_f32 v76, v76, v88
v_max_f32 v76, v76, v89
v_max_f32 v76, v76, v90
v_max_f32 v76, v76, v91
s_nop 1
v_mfma_f32_16x16x32_bf16 v[84:87], v[8:11], a[160:163], 0
v_mfma_f32_16x16x32_bf16 v[84:87], v[12:15], a[164:167], v[84:87]
v_mfma_f32_16x16x32_bf16 v[84:87], v[16:19], a[168:171], v[84:87]
v_mfma_f32_16x16x32_bf16 v[84:87], v[20:23], a[172:175], v[84:87]
v_mfma_f32_16x16x32_bf16 v[88:91], v[24:27], a[160:163], 0
v_mfma_f32_16x16x32_bf16 v[88:91], v[28:31], a[164:167], v[88:91]
v_mfma_f32_16x16x32_bf16 v[88:91], v[32:35], a[168:171], v[88:91]
v_mfma_f32_16x16x32_bf16 v[88:91], v[36:39], a[172:175], v[88:91]
s_nop 7
s_nop 7
v_max_f32 v80, v80, v84
v_max_f32 v80, v80, v85
v_max_f32 v80, v80, v86
v_max_f32 v80, v80, v87
v_max_f32 v80, v80, v88
v_max_f32 v80, v80, v89
v_max_f32 v80, v80, v90
v_max_f32 v80, v80, v91
s_nop 1
s_add_u32 s44, s44, 0x4000
s_add_u32 s45, s44, 0x1000
s_add_u32 s48, s48, 1
s_cmp_lt_u32 s48, 64
s_cbranch_scc1 A_x1
v_xor_b32 v4, 16, v0
v_lshlrev_b32 v4, 2, v4
v_xor_b32 v5, 32, v0
v_lshlrev_b32 v5, 2, v5
ds_bpermute_b32 v6, v4, v76
s_waitcnt lgkmcnt(0)
v_max_f32 v76, v76, v6
ds_bpermute_b32 v6, v5, v76
s_waitcnt lgkmcnt(0)
v_max_f32 v76, v76, v6
v_xor_b32 v76, 0x80000000, v76
v_mov_b32 v77, v76
v_mov_b32 v78, v76
v_mov_b32 v79, v76
ds_bpermute_b32 v6, v4, v80
s_waitcnt lgkmcnt(0)
v_max_f32 v80, v80, v6
ds_bpermute_b32 v6, v5, v80
s_waitcnt lgkmcnt(0)
v_max_f32 v80, v80, v6
v_xor_b32 v80, 0x80000000, v80
v_mov_b32 v81, v80
v_mov_b32 v82, v80
v_mov_b32 v83, v80
v_accvgpr_write_b32 a0, 0
v_accvgpr_write_b32 a1, 0
v_accvgpr_write_b32 a2, 0
v_accvgpr_write_b32 a3, 0
v_accvgpr_write_b32 a4, 0
v_accvgpr_write_b32 a5, 0
v_accvgpr_write_b32 a6, 0
v_accvgpr_write_b32 a7, 0
v_accvgpr_write_b32 a8, 0
v_accvgpr_write_b32 a9, 0
v_accvgpr_write_b32 a10, 0
v_accvgpr_write_b32 a11, 0
v_accvgpr_write_b32 a12, 0
v_accvgpr_write_b32 a13, 0
v_accvgpr_write_b32 a14, 0
v_accvgpr_write_b32 a15, 0
v_accvgpr_write_b32 a16, 0
v_accvgpr_write_b32 a17, 0
v_accvgpr_write_b32 a18, 0
v_accvgpr_write_b32 a19, 0
v_accvgpr_write_b32 a20, 0
v_accvgpr_write_b32 a21, 0
v_accvgpr_write_b32 a22, 0
v_accvgpr_write_b32 a23, 0
v_accvgpr_write_b32 a24, 0
v_accvgpr_write_b32 a25, 0
v_accvgpr_write_b32 a26, 0
v_accvgpr_write_b32 a27, 0
v_accvgpr_write_b32 a28, 0
v_accvgpr_write_b32 a29, 0
v_accvgpr_write_b32 a30, 0
v_accvgpr_write_b32 a31, 0
v_accvgpr_write_b32 a32, 0
v_accvgpr_write_b32 a33, 0
v_accvgpr_write_b32 a34, 0
v_accvgpr_write_b32 a35, 0
v_accvgpr_write_b32 a36, 0
v_accvgpr_write_b32 a37, 0
v_accvgpr_write_b32 a38, 0
v_accvgpr_write_b32 a39, 0
v_accvgpr_write_b32 a40, 0
v_accvgpr_write_b32 a41, 0
v_accvgpr_write_b32 a42, 0
v_accvgpr_write_b32 a43, 0
v_accvgpr_write_b32 a44, 0
v_accvgpr_write_b32 a45, 0
v_accvgpr_write_b32 a46, 0
v_accvgpr_write_b32 a47, 0
v_accvgpr_write_b32 a48, 0
v_accvgpr_write_b32 a49, 0
v_accvgpr_write_b32 a50, 0
v_accvgpr_write_b32 a51, 0
v_accvgpr_write_b32 a52, 0
v_accvgpr_write_b32 a53, 0
v_accvgpr_write_b32 a54, 0
v_accvgpr_write_b32 a55, 0
v_accvgpr_write_b32 a56, 0
v_accvgpr_write_b32 a57, 0
v_accvgpr_write_b32 a58, 0
v_accvgpr_write_b32 a59, 0
v_accvgpr_write_b32 a60, 0
v_accvgpr_write_b32 a61, 0
v_accvgpr_write_b32 a62, 0
v_accvgpr_write_b32 a63, 0
v_accvgpr_write_b32 a128, 0
v_accvgpr_write_b32 a129, 0
v_accvgpr_write_b32 a130, 0
v_accvgpr_write_b32 a131, 0
v_accvgpr_write_b32 a132, 0
v_accvgpr_write_b32 a133, 0
v_accvgpr_write_b32 a134, 0
v_accvgpr_write_b32 a135, 0
s_mov_b32 s48, 0
s_mov_b32 s44, 0
A_x2:
s_add_u32 s45, s44, 0x1000
s_add_u32 s46, s44, 0x2000
s_add_u32 s47, s44, 0x3000
buffer_load_dwordx4 v[8:11], v1, s[12:15], s44 offen offset:0 sc1
buffer_load_dwordx4 v[12:15], v1, s[12:15], s44 offen offset:1024 sc1
buffer_load_dwordx4 v[16:19], v1, s[12:15], s44 offen offset:2048 sc1
buffer_load_dwordx4 v[20:23], v1, s[12:15], s44 offen offset:3072 sc1
buffer_load_dwordx4 v[24:27], v1, s[12:15], s45 offen offset:0 sc1
buffer_load_dwordx4 v[28:31], v1, s[12:15], s45 offen offset:1024 sc1
buffer_load_dwordx4 v[32:35], v1, s[12:15], s45 offen offset:2048 sc1
buffer_load_dwordx4 v[36:39], v1, s[12:15], s45 offen offset:3072 sc1
buffer_load_dwordx4 v[40:43], v1, s[12:15], s46 offen offset:0 sc1
buffer_load_dwordx4 v[44:47], v1, s[12:15], s46 offen offset:1024 sc1
buffer_load_dwordx4 v[48:51], v1, s[12:15], s46 offen offset:2048 sc1
buffer_load_dwordx4 v[52:55], v1, s[12:15], s46 offen offset:3072 sc1
buffer_load_dwordx4 v[56:59], v1, s[12:15], s47 offen offset:0 sc1
buffer_load_dwordx4 v[60:63], v1, s[12:15], s47 offen offset:1024 sc1
buffer_load_dwordx4 v[64:67], v1, s[12:15], s47 offen offset:2048 sc1
buffer_load_dwordx4 v[68:71], v1, s[12:15], s47 offen offset:3072 sc1
s_waitcnt vmcnt(0)
v_mfma_f32_16x16x32_bf16 v[84:87], v[8:11], a[144:147], v[76:79]
v_mfma_f32_16x16x32_bf16 v[84:87], v[12:15], a[148:151], v[84:87]
v_mfma_f32_16x16x32_bf16 v[84:87], v[16:19], a[152:155], v[84:87]
v_mfma_f32_16x16x32_bf16 v[84:87], v[20:23], a[156:159], v[84:87]
v_mfma_f32_16x16x32_bf16 v[88:91], v[24:27], a[144:147], v[76:79]
v_mfma_f32_16x16x32_bf16 v[88:91], v[28:31], a[148:151], v[88:91]
v_mfma_f32_16x16x32_bf16 v[88:91], v[32:35], a[152:155], v[88:91]
v_mfma_f32_16x16x32_bf16 v[88:91], v[36:39], a[156:159], v[88:91]
s_nop 7
s_nop 7
v_exp_f32 v84, v84
v_exp_f32 v85, v85
v_exp_f32 v86, v86
v_exp_f32 v87, v87
v_exp_f32 v88, v88
v_exp_f32 v89, v89
v_exp_f32 v90, v90
v_exp_f32 v91, v91
s_nop 1
v_cvt_pk_bf16_f32 v92, v84, v85
v_cvt_pk_bf16_f32 v93, v86, v87
v_cvt_pk_bf16_f32 v94, v88, v89
v_cvt_pk_bf16_f32 v95, v90, v91
s_nop 3
v_mfma_f32_16x16x32_bf16 a[0:3], v[40:43], v[92:95], a[0:3]
v_mfma_f32_16x16x32_bf16 a[4:7], v[44:47], v[92:95], a[4:7]
v_mfma_f32_16x16x32_bf16 a[8:11], v[48:51], v[92:95], a[8:11]
v_mfma_f32_16x16x32_bf16 a[12:15], v[52:55], v[92:95], a[12:15]
v_mfma_f32_16x16x32_bf16 a[16:19], v[56:59], v[92:95], a[16:19]
v_mfma_f32_16x16x32_bf16 a[20:23], v[60:63], v[92:95], a[20:23]
v_mfma_f32_16x16x32_bf16 a[24:27], v[64:67], v[92:95], a[24:27]
v_mfma_f32_16x16x32_bf16 a[28:31], v[68:71], v[92:95], a[28:31]
v_mfma_f32_16x16x32_bf16 a[128:131], v[136:139], v[92:95], a[128:131]
s_nop 7
s_nop 7
v_mfma_f32_16x16x32_bf16 v[84:87], v[8:11], a[160:163], v[80:83]
v_mfma_f32_16x16x32_bf16 v[84:87], v[12:15], a[164:167], v[84:87]
v_mfma_f32_16x16x32_bf16 v[84:87], v[16:19], a[168:171], v[84:87]
v_mfma_f32_16x16x32_bf16 v[84:87], v[20:23], a[172:175], v[84:87]
v_mfma_f32_16x16x32_bf16 v[88:91], v[24:27], a[160:163], v[80:83]
v_mfma_f32_16x16x32_bf16 v[88:91], v[28:31], a[164:167], v[88:91]
v_mfma_f32_16x16x32_bf16 v[88:91], v[32:35], a[168:171], v[88:91]
v_mfma_f32_16x16x32_bf16 v[88:91], v[36:39], a[172:175], v[88:91]
s_nop 7
s_nop 7
v_exp_f32 v84, v84
v_exp_f32 v85, v85
v_exp_f32 v86, v86
v_exp_f32 v87, v87
v_exp_f32 v88, v88
v_exp_f32 v89, v89
v_exp_f32 v90, v90
v_exp_f32 v91, v91
s_nop 1
v_cvt_pk_bf16_f32 v92, v84, v85
v_cvt_pk_bf16_f32 v93, v86, v87
v_cvt_pk_bf16_f32 v94, v88, v89
v_cvt_pk_bf16_f32 v95, v90, v91
s_nop 3
v_mfma_f32_16x16x32_bf16 a[32:35], v[40:43], v[92:95], a[32:35]
v_mfma_f32_16x16x32_bf16 a[36:39], v[44:47], v[92:95], a[36:39]
v_mfma_f32_16x16x32_bf16 a[40:43], v[48:51], v[92:95], a[40:43]
v_mfma_f32_16x16x32_bf16 a[44:47], v[52:55], v[92:95], a[44:47]
v_mfma_f32_16x16x32_bf16 a[48:51], v[56:59], v[92:95], a[48:51]
v_mfma_f32_16x16x32_bf16 a[52:55], v[60:63], v[92:95], a[52:55]
v_mfma_f32_16x16x32_bf16 a[56:59], v[64:67], v[92:95], a[56:59]
v_mfma_f32_16x16x32_bf16 a[60:63], v[68:71], v[92:95], a[60:63]
v_mfma_f32_16x16x32_bf16 a[132:135], v[136:139], v[92:95], a[132:135]
s_nop 7
s_nop 7
s_add_u32 s44, s44, 0x4000
s_add_u32 s48, s48, 1
s_cmp_lt_u32 s48, 64
s_cbranch_scc1 A_x2
s_nop 7
s_nop 7
v_accvgpr_read_b32 v140, a0
v_accvgpr_read_b32 v141, a1
v_accvgpr_read_b32 v142, a2
v_accvgpr_read_b32 v143, a3
v_accvgpr_read_b32 v144, a4
v_accvgpr_read_b32 v145, a5
v_accvgpr_read_b32 v146, a6
v_accvgpr_read_b32 v147, a7
v_accvgpr_read_b32 v148, a8
v_accvgpr_read_b32 v149, a9
v_accvgpr_read_b32 v150, a10
v_accvgpr_read_b32 v151, a11
v_accvgpr_read_b32 v152, a12
v_accvgpr_read_b32 v153, a13
v_accvgpr_read_b32 v154, a14
v_accvgpr_read_b32 v155, a15
v_accvgpr_read_b32 v156, a16
v_accvgpr_read_b32 v157, a17
v_accvgpr_read_b32 v158, a18
v_accvgpr_read_b32 v159, a19
v_accvgpr_read_b32 v160, a20
v_accvgpr_read_b32 v161, a21
v_accvgpr_read_b32 v162, a22
v_accvgpr_read_b32 v163, a23
v_accvgpr_read_b32 v164, a24
v_accvgpr_read_b32 v165, a25
v_accvgpr_read_b32 v166, a26
v_accvgpr_read_b32 v167, a27
v_accvgpr_read_b32 v168, a28
v_accvgpr_read_b32 v169, a29
v_accvgpr_read_b32 v170, a30
v_accvgpr_read_b32 v171, a31
v_accvgpr_read_b32 v172, a32
v_accvgpr_read_b32 v173, a33
v_accvgpr_read_b32 v174, a34
v_accvgpr_read_b32 v175, a35
v_accvgpr_read_b32 v176, a36
v_accvgpr_read_b32 v177, a37
v_accvgpr_read_b32 v178, a38
v_accvgpr_read_b32 v179, a39
v_accvgpr_read_b32 v180, a40
v_accvgpr_read_b32 v181, a41
v_accvgpr_read_b32 v182, a42
v_accvgpr_read_b32 v183, a43
v_accvgpr_read_b32 v184, a44
v_accvgpr_read_b32 v185, a45
v_accvgpr_read_b32 v186, a46
v_accvgpr_read_b32 v187, a47
v_accvgpr_read_b32 v188, a48
v_accvgpr_read_b32 v189, a49
v_accvgpr_read_b32 v190, a50
v_accvgpr_read_b32 v191, a51
v_accvgpr_read_b32 v192, a52
v_accvgpr_read_b32 v193, a53
v_accvgpr_read_b32 v194, a54
v_accvgpr_read_b32 v195, a55
v_accvgpr_read_b32 v196, a56
v_accvgpr_read_b32 v197, a57
v_accvgpr_read_b32 v198, a58
v_accvgpr_read_b32 v199, a59
v_accvgpr_read_b32 v200, a60
v_accvgpr_read_b32 v201, a61
v_accvgpr_read_b32 v202, a62
v_accvgpr_read_b32 v203, a63
v_accvgpr_read_b32 v6, a128
v_accvgpr_read_b32 v7, a132
s_nop 1
v_rcp_f32 v6, v6
v_rcp_f32 v7, v7
s_nop 1
s_branch A_store
L_spin_pK:
s_mov_b32 s73, 0
L_spinl_pK:
buffer_load_dwordx4 v[240:243], off, s[32:35], s70 sc1
s_waitcnt vmcnt(0)
v_and_b32 v240, v240, v241
v_and_b32 v242, v242, v243
v_and_b32 v240, v240, v242
s_nop 1
v_readfirstlane_b32 s72, v240
s_and_b32 s72, s72, s68
s_cmp_eq_u32 s72, s68
s_cbranch_scc1 L_back_pK
s_add_u32 s73, s73, 1
s_cmp_lt_u32 s73, 0x4000
s_cbranch_scc0 L_back_pK
s_sleep 1
s_branch L_spinl_pK
L_spin_K4:
s_mov_b32 s73, 0
L_spinl_K4:
buffer_load_dwordx4 v[240:243], off, s[32:35], s70 sc1
s_waitcnt vmcnt(0)
v_and_b32 v240, v240, v241
v_and_b32 v242, v242, v243
v_and_b32 v240, v240, v242
s_nop 1
v_readfirstlane_b32 s72, v240
s_and_b32 s72, s72, s68
s_cmp_eq_u32 s72, s68
s_cbranch_scc1 L_back_K4
s_add_u32 s73, s73, 1
s_cmp_lt_u32 s73, 0x4000
s_cbranch_scc0 L_back_K4
s_sleep 1
s_branch L_spinl_K4
L_spin_pV:
s_mov_b32 s73, 0
L_spinl_pV:
buffer_load_dwordx4 v[240:243], off, s[32:35], s70 sc1
s_waitcnt vmcnt(0)
v_and_b32 v240, v240, v241
v_and_b32 v242, v242, v243
v_and_b32 v240, v240, v242
s_nop 1
v_readfirstlane_b32 s72, v240
s_and_b32 s72, s72, s68
s_cmp_eq_u32 s72, s68
s_cbranch_scc1 L_back_pV
s_add_u32 s73, s73, 1
s_cmp_lt_u32 s73, 0x4000
s_cbranch_scc0 L_back_pV
s_sleep 1
s_branch L_spinl_pV
L_spin_V4:
s_mov_b32 s73, 0
L_spinl_V4:
buffer_load_dwordx4 v[240:243], off, s[32:35], s70 sc1
s_waitcnt vmcnt(0)
v_and_b32 v240, v240, v241
v_and_b32 v242, v242, v243
v_and_b32 v240, v240, v242
s_nop 1
v_readfirstlane_b32 s72, v240
s_and_b32 s72, s72, s68
s_cmp_eq_u32 s72, s68
s_cbranch_scc1 L_back_V4
s_add_u32 s73, s73, 1
s_cmp_lt_u32 s73, 0x4000
s_cbranch_scc0 L_back_V4
s_sleep 1
s_branch L_spinl_V4
L_spin_P4:
s_mov_b32 s73, 0
L_spinl_P4:
buffer_load_dwordx4 v[240:243], off, s[32:35], s70 sc1
s_waitcnt vmcnt(0)
v_and_b32 v240, v240, v241
v_and_b32 v242, v242, v243
v_and_b32 v240, v240, v242
s_nop 1
v_readfirstlane_b32 s72, v240
s_and_b32 s72, s72, s68
s_cmp_eq_u32 s72, s68
s_cbranch_scc1 L_back_P4
s_add_u32 s73, s73, 1
s_cmp_lt_u32 s73, 0x4000
s_cbranch_scc0 L_back_P4
s_sleep 1
s_branch L_spinl_P4
A_end:
s_endpgm
.section .rodata,"a"
.p2align 6
.amdhsa_kernel standalone__kv_cache_quant_pre_rope_vs_post_rope__prompt_kernel
  .amdhsa_next_free_vgpr 512
  .amdhsa_next_free_sgpr 102
  .amdhsa_accum_offset 256
  .amdhsa_group_segment_fixed_size 0
  .amdhsa_kernarg_size 112
  .amdhsa_user_sgpr_count 2
  .amdhsa_user_sgpr_kernarg_segment_ptr 1
  .amdhsa_system_sgpr_workgroup_id_x 1
.end_amdhsa_kernel
```
